```python
import torch

def _softmax(x, axis=-1):
    return torch.softmax(x, dim=axis)
def _gelu(x):
    return torch.nn.functional.gelu(x, approximate="tanh")
def _silu(x):
    return torch.nn.functional.silu(x)
def _sigmoid(x):
    return torch.sigmoid(x)
def _layernorm(x, axis=-1, eps=1e-5):
    m = x.mean(dim=axis, keepdim=True)
    v = x.var(dim=axis, keepdim=True, unbiased=False)
    return (x - m) / torch.sqrt(v + eps)
def _scatter_add(tgt, idx, src, axis=0):
    return tgt.clone().index_add_(axis, idx, src)
def _segment_sum(src, seg, n):
    out = torch.zeros((n,) + src.shape[1:], dtype=src.dtype)
    return out.index_add_(0, seg, src)
def _pad(x, pw):
    flat = tuple(v for pair in reversed(pw) for v in pair)
    return torch.nn.functional.pad(x, flat)

kernel_name = 'concat_heads__mha_block_cached__mha_block_cached__near_ridge'

def setup_inputs():

    _w = (lambda a: (lambda t: t.to(torch.bfloat16) if t.is_floating_point() else t)(torch.as_tensor(a)))
    def _A_setup():
        B, Sq, D = 8, 112, 512
        H, Sk, Dh = 32, 512, 128
        return {
            "x": _w((lambda *s: torch.randn(*s, dtype=torch.bfloat16) * 0.8)(B, Sq, D)),
            "k_cache": _w((lambda *s: torch.randn(*s, dtype=torch.bfloat16) * 0.8)(B, H, Sk, Dh)),
            "v_cache": _w((lambda *s: torch.randn(*s, dtype=torch.bfloat16) * 0.05)(B, H, Sk, Dh)),
            "wq": _w((lambda *s: torch.randn(*s, dtype=torch.bfloat16) * 0.8)(D, H * Dh) * (D ** -0.5)),
            "wo": _w((lambda *s: torch.randn(*s, dtype=torch.bfloat16) * 0.05)(H * Dh, D) * ((H * Dh) ** -0.5)),
        }
    _A_in = _A_setup()

    def _B_setup():
        B, Sq, D = 8, 112, 512
        H, Sk, Dh = 32, 512, 128
        return {
            "x": _w((lambda *s: torch.randn(*s, dtype=torch.bfloat16) * 0.8)(B, Sq, D)),
            "k_cache": _w((lambda *s: torch.randn(*s, dtype=torch.bfloat16) * 0.8)(B, H, Sk, Dh)),
            "v_cache": _w((lambda *s: torch.randn(*s, dtype=torch.bfloat16) * 0.05)(B, H, Sk, Dh)),
            "wq": _w((lambda *s: torch.randn(*s, dtype=torch.bfloat16) * 0.8)(D, H * Dh) * (D ** -0.5)),
            "wo": _w((lambda *s: torch.randn(*s, dtype=torch.bfloat16) * 0.05)(H * Dh, D) * ((H * Dh) ** -0.5)),
        }
    _B_in = _B_setup()

    return {
        "A_x": _A_in["x"],
        "A_k_cache": _A_in["k_cache"],
        "A_v_cache": _A_in["v_cache"],
        "A_wq": _A_in["wq"],
        "A_wo": _A_in["wo"],
        "B_x": _B_in["x"],
        "B_k_cache": _B_in["k_cache"],
        "B_v_cache": _B_in["v_cache"],
        "B_wq": _B_in["wq"],
        "B_wo": _B_in["wo"],
    }

def reference(A_x, A_k_cache, A_v_cache, A_wq, A_wo, B_x, B_k_cache, B_v_cache, B_wq, B_wo):
    def _A_ref(x, k_cache, v_cache, wq, wo):
        B, Sq, D = x.shape
        H, Dh = 32, 128
        q = (lambda x, *d: x.permute(*d))((x @ wq).reshape(B, Sq, H, Dh), 0, 2, 1, 3)
        scores = torch.einsum("bhqd,bhkd->bhqk", q, k_cache) * (Dh ** -0.5)
        p = _softmax(scores, axis=-1)
        o = torch.einsum("bhqk,bhkd->bhqd", p, v_cache)
        return (lambda x, *d: x.permute(*d))(o, 0, 2, 1, 3).reshape(B, Sq, H * Dh) @ wo

    def _B_ref(x, k_cache, v_cache, wq, wo):
        B, Sq, D = x.shape
        H, Dh = 32, 128
        q = (lambda x, *d: x.permute(*d))((x @ wq).reshape(B, Sq, H, Dh), 0, 2, 1, 3)
        scores = torch.einsum("bhqd,bhkd->bhqk", q, k_cache) * (Dh ** -0.5)
        p = _softmax(scores, axis=-1)
        o = torch.einsum("bhqk,bhkd->bhqd", p, v_cache)
        return (lambda x, *d: x.permute(*d))(o, 0, 2, 1, 3).reshape(B, Sq, H * Dh) @ wo

    a = _A_ref(A_x, A_k_cache, A_v_cache, A_wq, A_wo)
    b = _B_ref(B_x, B_k_cache, B_v_cache, B_wq, B_wo)
    return torch.concatenate([a, b], axis=-1)
```

```asm
; @launch grid=(256,1,1) block=(512,1,1) lds=163840
.amdgcn_target "amdgcn-amd-amdhsa--gfx950"
.text
.globl concat_heads__mha_block_cached__mha_block_cached__near_ridge_kernel
.p2align 8
.type concat_heads__mha_block_cached__mha_block_cached__near_ridge_kernel,@function
concat_heads__mha_block_cached__mha_block_cached__near_ridge_kernel:
s_cmp_ge_u32 s2, 256
s_cbranch_scc1 L_end
s_getpc_b64 s[6:7]
L_cpf:
v_lshrrev_b32 v2, 6, v0
v_and_b32 v3, 15, v0
s_lshr_b32 s5, s2, 3
s_lshl_b32 s5, s5, 4
v_add_u32 v3, s5, v3
v_lshlrev_b32 v3, 7, v3
v_lshlrev_b32 v2, 16, v2
v_add_u32 v3, v3, v2
v_cmp_gt_u32 vcc, 59648, v3
v_mov_b32_e64 v5, s7
v_add_co_u32 v4, s[8:9], s6, v3
v_addc_co_u32 v5, s[8:9], 0, v5, s[8:9]
s_nop 0
s_and_saveexec_b64 s[8:9], vcc
s_cbranch_execz L_cpf2
global_load_dword v255, v[4:5], off
L_cpf2:
s_mov_b64 exec, -1
s_cmp_ge_u32 s2, 256
s_cbranch_scc1 L_end
s_load_dwordx8 s[68:75], s[0:1], 0
s_nop 0
s_load_dwordx2 s[76:77], s[0:1], 32
s_load_dwordx8 s[80:87], s[0:1], 40
s_load_dwordx2 s[88:89], s[0:1], 72
s_load_dwordx2 s[90:91], s[0:1], 80
s_load_dwordx4 s[92:95], s[0:1], 88
v_lshrrev_b32 v2, 6, v0
v_and_b32 v1, 63, v0
v_readfirstlane_b32 s3, v2
s_and_b32 s54, s2, 3
s_lshr_b32 s50, s2, 3
s_and_b32 s55, s50, 3
s_lshr_b32 s56, s50, 2
s_bfe_u32 s57, s2, 0x10002
s_and_b32 s58, s3, 3
s_lshl_b32 s36, s58, 12
s_lshl_b32 s51, s54, 3
s_mul_i32 s53, s55, 2
s_add_u32 s51, s51, s53
s_lshl_b32 s52, s56, 5
s_add_u32 s52, s52, s51
s_lshl_b32 s37, s52, 17
s_add_u32 s37, s37, s36
s_lshl_b32 s38, s51, 8
s_lshl_b32 s53, s58, 17
s_add_u32 s38, s38, s53
s_lshl_b32 s39, s58, 15
s_lshl_b32 s52, s56, 5
s_lshl_b32 s53, s54, 3
s_add_u32 s52, s52, s53
s_add_u32 s52, s52, s55
s_lshl_b32 s53, s57, 8
s_add_u32 s52, s52, s53
s_lshl_b32 s44, s52, 15
s_lshl_b32 s53, s58, 13
s_add_u32 s44, s44, s53
s_add_u32 s50, s55, 0
s_and_b32 s50, s50, 3
s_sub_i32 s53, s50, s55
s_lshl_b32 s53, s53, 15
s_add_u32 s45, s44, s53
s_lshl_b32 s53, s54, 3
s_mul_i32 s50, s50, 2
s_add_u32 s53, s53, s50
s_lshl_b32 s40, s53, 17
s_lshl_b32 s53, s55, 8
s_add_u32 s40, s40, s53
s_lshl_b32 s53, s58, 14
s_add_u32 s40, s40, s53
s_add_u32 s50, s55, 1
s_and_b32 s50, s50, 3
s_sub_i32 s53, s50, s55
s_lshl_b32 s53, s53, 15
s_add_u32 s46, s44, s53
s_lshl_b32 s53, s54, 3
s_mul_i32 s50, s50, 2
s_add_u32 s53, s53, s50
s_lshl_b32 s41, s53, 17
s_lshl_b32 s53, s55, 8
s_add_u32 s41, s41, s53
s_lshl_b32 s53, s58, 14
s_add_u32 s41, s41, s53
s_add_u32 s50, s55, 2
s_and_b32 s50, s50, 3
s_sub_i32 s53, s50, s55
s_lshl_b32 s53, s53, 15
s_add_u32 s47, s44, s53
s_lshl_b32 s53, s54, 3
s_mul_i32 s50, s50, 2
s_add_u32 s53, s53, s50
s_lshl_b32 s42, s53, 17
s_lshl_b32 s53, s55, 8
s_add_u32 s42, s42, s53
s_lshl_b32 s53, s58, 14
s_add_u32 s42, s42, s53
s_add_u32 s50, s55, 3
s_and_b32 s50, s50, 3
s_sub_i32 s53, s50, s55
s_lshl_b32 s53, s53, 15
s_add_u32 s48, s44, s53
s_lshl_b32 s53, s54, 3
s_mul_i32 s50, s50, 2
s_add_u32 s53, s53, s50
s_lshl_b32 s43, s53, 17
s_lshl_b32 s53, s55, 8
s_add_u32 s43, s43, s53
s_lshl_b32 s53, s58, 14
s_add_u32 s43, s43, s53
s_lshl_b32 s50, s57, 3
s_add_u32 s50, s50, s56
s_lshl_b32 s50, s50, 2
s_add_u32 s50, s50, s55
s_lshl_b32 s59, s50, 18
s_add_u32 s59, s59, 16777216
s_mov_b32 s49, 0x3e0293ee
v_lshrrev_b32 v136, 1, v1
v_min_u32 v136, 15, v136
v_lshlrev_b32 v136, 13, v136
v_and_b32 v137, 1, v1
v_lshlrev_b32 v137, 7, v137
v_add_u32 v136, v136, v137
s_lshl_b32 s96, s56, 19
s_add_u32 s96, s96, s38
v_lshrrev_b32 v148, 3, v1
v_min_u32 v148, 6, v148
v_lshlrev_b32 v148, 10, v148
v_and_b32 v149, 7, v1
v_lshlrev_b32 v149, 7, v149
v_add_u32_e64 v148, v148, v149
s_mul_i32 s97, s55, 28672
s_mul_i32 s53, s58, 7168
s_add_u32 s97, s97, s53
s_mov_b32 s18, 0x400000
s_mov_b32 s19, 0x20000
s_mov_b32 s22, 0x1c000
s_mov_b32 s23, 0x20000
s_mul_i32 s50, s56, 114688
s_cmp_eq_u32 s57, 0
s_waitcnt lgkmcnt(0)
s_cselect_b32 s16, s74, s86
s_cselect_b32 s17, s75, s87
s_cselect_b32 s20, s68, s80
s_cselect_b32 s21, s69, s81
s_add_u32 s20, s20, s50
s_addc_u32 s21, s21, 0
s_cmp_ge_u32 s3, 4
s_cbranch_scc1 L_nopf
buffer_load_dword v138, v136, s[16:19], s96 offen
buffer_load_dword v150, v148, s[20:23], s97 offen
L_nopf:
s_cmp_eq_u32 s57, 0
s_cselect_b32 s8, s70, s82
s_cselect_b32 s9, s71, s83
s_mov_b32 s10, 0x2000000
s_mov_b32 s11, 0x20000
s_cselect_b32 s12, s72, s84
s_cselect_b32 s13, s73, s85
s_mov_b32 s14, 0x2000000
s_mov_b32 s15, 0x20000
s_cselect_b32 s24, s76, s88
s_cselect_b32 s25, s77, s89
s_mov_b32 s26, 0x400000
s_mov_b32 s27, 0x20000
s_mov_b32 s32, s90
s_mov_b32 s33, s91
s_mov_b32 s34, 0x1c0000
s_mov_b32 s35, 0x20000
s_mov_b32 s28, s94
s_mov_b32 s29, s95
s_mov_b32 s30, 0x10000000
s_nop 0
s_mov_b32 s31, 0x20000
s_add_u32 s28, s28, 0xc800000
s_addc_u32 s29, s29, 0
s_mov_b32 s30, 0x3800000
s_mov_b32 s60, s92
s_mov_b32 s61, s93
s_mov_b32 s4, 4000000
s_cmp_ge_u32 s3, 4
s_cbranch_scc1 L_pj
s_barrier
v_mov_b32_e64 v156, 0
buffer_load_dword v157, v156, s[28:31], s44 offen
s_lshr_b32 s52, s44, 3
s_add_u32 s52, s52, 33554432
buffer_load_dword v158, v156, s[28:31], s52 offen
buffer_load_dword v159, v156, s[28:31], s59 offen
s_sub_u32 s52, s59, 16777216
s_lshr_b32 s52, s52, 2
s_add_u32 s52, s52, 37748736
buffer_load_dword v160, v156, s[28:31], s52 offen
s_mul_i32 s52, s56, 229376
buffer_load_dword v161, v156, s[32:35], s52 offen
v_lshrrev_b32 v15, 4, v1
v_and_b32 v16, 7, v1
v_xor_b32 v16, v15, v16
v_lshlrev_b32 v16, 4, v16
v_lshrrev_b32 v15, 3, v1
v_lshlrev_b32 v22, 10, v15
v_add_u32 v22, v22, v16
v_xor_b32 v23, 64, v22
v_lshrrev_b32 v15, 4, v1
v_lshlrev_b32 v17, 2, v15
v_and_b32 v16, 15, v1
v_xor_b32 v16, v17, v16
v_lshlrev_b32 v16, 4, v16
v_lshlrev_b32 v21, 13, v15
v_add_u32 v21, v21, v16
s_or_b32 s52, s2, s3
s_cmp_lg_u32 s52, 0
s_cbranch_scc1 LS1
s_memrealtime s[62:63]
s_waitcnt lgkmcnt(0)
s_or_b32 s62, s62, 1
v_mov_b32 v24, s62
v_mov_b32 v25, s63
v_mov_b32 v18, 0
s_mov_b64 exec, 1
global_store_dwordx2 v18, v[24:25], s[60:61] sc1
s_mov_b64 exec, -1
s_nop 1
LS1:
v_and_b32 v15, 31, v1
v_lshlrev_b32 v2, 8, v15
v_lshrrev_b32 v15, 5, v1
v_and_b32 v16, 15, v1
v_xor_b32 v15, v15, v16
v_lshlrev_b32 v15, 4, v15
v_add_u32 v2, v2, v15
v_xor_b32 v3, 32, v2
v_xor_b32_e64 v4, 64, v2
v_xor_b32 v5, 96, v2
v_xor_b32 v6, 128, v2
v_xor_b32 v7, 160, v2
v_xor_b32 v8, 192, v2
v_xor_b32 v9, 224, v2
v_lshrrev_b32 v15, 5, v1
v_lshlrev_b32 v10, 10, v15
v_bfe_u32 v15, v1, 2, 2
v_lshlrev_b32 v16, 8, v15
v_add_u32 v10, v10, v16
v_lshlrev_b32 v16, 6, v15
v_add_u32 v10, v10, v16
v_bfe_u32 v15, v1, 4, 1
v_lshlrev_b32 v16, 5, v15
v_add_u32 v10, v10, v16
v_bfe_u32 v15, v1, 1, 1
v_lshlrev_b32 v16, 4, v15
v_add_u32 v10, v10, v16
v_and_b32 v15, 1, v1
v_lshlrev_b32 v16, 3, v15
v_add_u32 v10, v10, v16
v_xor_b32 v11, 64, v10
v_xor_b32 v12, 128, v10
v_xor_b32 v13, 192, v10
v_add_u32 v10, 0xc000, v10
v_add_u32 v11, 0xc000, v11
v_add_u32 v12, 0xc000, v12
v_add_u32 v13, 0xc000, v13
v_lshrrev_b32 v15, 4, v1
v_and_b32 v16, 15, v1
v_xor_b32 v16, v15, v16
v_lshlrev_b32 v16, 4, v16
v_lshlrev_b32 v128, 8, v15
v_add_u32 v128, v128, v16
v_xor_b32_e64 v129, 64, v128
v_xor_b32 v130, 128, v128
v_xor_b32 v131, 192, v128
v_lshrrev_b32 v15, 4, v1
v_lshlrev_b32 v17, 2, v15
v_and_b32 v16, 15, v1
v_xor_b32 v16, v17, v16
v_lshlrev_b32 v16, 4, v16
v_lshlrev_b32 v132, 8, v15
v_add_u32 v132, v132, v16
v_lshlrev_b32 v19, 4, v1
s_lshl_b32 s52, s58, 13
s_add_u32 s52, s52, 98304
v_add_u32 v20, s52, v19
s_cmp_eq_u32 s58, 3
s_cselect_b32 s53, 0x40000000, 0
v_lshlrev_b32 v15, 26, v1
v_and_b32 v15, s53, v15
v_or_b32 v19, v19, v15
s_barrier
s_add_u32 m0, s36, 98304
s_add_u32 s50, s39, 256
buffer_load_dwordx4 v22, s[20:23], s50 offen offset:0 lds
s_add_u32 s51, s39, 7424
buffer_load_dwordx4 v23, s[20:23], s51 offen offset:1024 lds
s_add_u32 s50, s39, 14592
buffer_load_dwordx4 v22, s[20:23], s50 offen offset:2048 lds
s_add_u32 s51, s39, 21760
buffer_load_dwordx4 v23, s[20:23], s51 offen offset:3072 lds
s_add_u32 m0, s36, 114688
s_add_u32 s50, s38, 1048576
buffer_load_dwordx4 v21, s[16:19], s50 offen offset:0 lds
s_add_u32 s51, s38, 1080320
buffer_load_dwordx4 v21, s[16:19], s51 offen offset:1024 lds
s_add_u32 s50, s38, 1112064
buffer_load_dwordx4 v21, s[16:19], s50 offen offset:2048 lds
s_add_u32 s51, s38, 1143808
buffer_load_dwordx4 v21, s[16:19], s51 offen offset:3072 lds
s_add_u32 m0, s36, 131072
s_add_u32 s50, s39, 384
buffer_load_dwordx4 v22, s[20:23], s50 offen offset:0 lds
s_add_u32 s51, s39, 7552
buffer_load_dwordx4 v23, s[20:23], s51 offen offset:1024 lds
s_add_u32 s50, s39, 14720
buffer_load_dwordx4 v22, s[20:23], s50 offen offset:2048 lds
s_add_u32 s51, s39, 21888
buffer_load_dwordx4 v23, s[20:23], s51 offen offset:3072 lds
s_add_u32 m0, s36, 147456
s_add_u32 s50, s38, 1572864
buffer_load_dwordx4 v21, s[16:19], s50 offen offset:0 lds
s_add_u32 s51, s38, 1604608
buffer_load_dwordx4 v21, s[16:19], s51 offen offset:1024 lds
s_add_u32 s50, s38, 1636352
buffer_load_dwordx4 v21, s[16:19], s50 offen offset:2048 lds
s_add_u32 s51, s38, 1668096
buffer_load_dwordx4 v21, s[16:19], s51 offen offset:3072 lds
v_and_b32 v140, 15, v1
v_lshlrev_b32 v140, 13, v140
v_bfe_u32 v141, v1, 4, 1
v_lshlrev_b32 v141, 7, v141
v_add_u32 v140, v140, v141
s_lshl_b32 s52, s54, 3
s_mul_i32 s53, s55, 2
s_add_u32 s52, s52, s53
s_add_u32 s52, s52, 1
s_lshl_b32 s52, s52, 8
s_lshl_b32 s53, s56, 19
s_add_u32 s52, s52, s53
s_lshl_b32 s53, s58, 17
s_add_u32 s52, s52, s53
buffer_load_dword v142, v140, s[16:19], s52 offen
s_barrier
s_add_u32 m0, s36, 32768
s_add_u32 s50, s39, 512
buffer_load_dwordx4 v22, s[20:23], s50 offen offset:0 lds
s_add_u32 s51, s39, 7680
buffer_load_dwordx4 v23, s[20:23], s51 offen offset:1024 lds
s_add_u32 s50, s39, 14848
buffer_load_dwordx4 v22, s[20:23], s50 offen offset:2048 lds
s_add_u32 s51, s39, 22016
buffer_load_dwordx4 v23, s[20:23], s51 offen offset:3072 lds
s_add_u32 m0, s36, 49152
s_add_u32 s50, s38, 2097152
buffer_load_dwordx4 v21, s[16:19], s50 offen offset:0 lds
s_add_u32 s51, s38, 2128896
buffer_load_dwordx4 v21, s[16:19], s51 offen offset:1024 lds
s_add_u32 s50, s38, 2160640
buffer_load_dwordx4 v21, s[16:19], s50 offen offset:2048 lds
s_add_u32 s51, s38, 2192384
buffer_load_dwordx4 v21, s[16:19], s51 offen offset:3072 lds
s_waitcnt vmcnt(21)
s_waitcnt vmcnt(17)
s_barrier
s_add_u32 m0, s36, 65536
s_add_u32 s50, s39, 640
buffer_load_dwordx4 v22, s[20:23], s50 offen offset:0 lds
s_add_u32 s51, s39, 7808
buffer_load_dwordx4 v23, s[20:23], s51 offen offset:1024 lds
s_nop 0
s_add_u32 s50, s39, 14976
buffer_load_dwordx4 v22, s[20:23], s50 offen offset:2048 lds
s_add_u32 s51, s39, 22144
buffer_load_dwordx4 v23, s[20:23], s51 offen offset:3072 lds
s_add_u32 m0, s36, 81920
s_add_u32 s50, s38, 2621440
buffer_load_dwordx4 v21, s[16:19], s50 offen offset:0 lds
s_add_u32 s51, s38, 2653184
buffer_load_dwordx4 v21, s[16:19], s51 offen offset:1024 lds
s_add_u32 s50, s38, 2684928
buffer_load_dwordx4 v21, s[16:19], s50 offen offset:2048 lds
s_add_u32 s51, s38, 2716672
buffer_load_dwordx4 v21, s[16:19], s51 offen offset:3072 lds
v_mov_b32 v26, 0
global_load_dwordx2 v[24:25], v26, s[60:61] sc1
s_waitcnt vmcnt(22)
s_waitcnt vmcnt(18)
s_barrier
s_add_u32 m0, s36, 98304
s_add_u32 s50, s39, 768
buffer_load_dwordx4 v22, s[20:23], s50 offen offset:0 lds
s_add_u32 s51, s39, 7936
buffer_load_dwordx4 v23, s[20:23], s51 offen offset:1024 lds
s_add_u32 s50, s39, 15104
buffer_load_dwordx4 v22, s[20:23], s50 offen offset:2048 lds
s_add_u32 s51, s39, 22272
buffer_load_dwordx4 v23, s[20:23], s51 offen offset:3072 lds
s_add_u32 m0, s36, 114688
s_add_u32 s50, s38, 3145728
buffer_load_dwordx4 v21, s[16:19], s50 offen offset:0 lds
s_add_u32 s51, s38, 3177472
buffer_load_dwordx4 v21, s[16:19], s51 offen offset:1024 lds
s_add_u32 s50, s38, 3209216
buffer_load_dwordx4 v21, s[16:19], s50 offen offset:2048 lds
s_add_u32 s51, s38, 3240960
buffer_load_dwordx4 v21, s[16:19], s51 offen offset:3072 lds
s_add_u32 s50, s37, 0
s_add_u32 m0, s36, 0
s_nop 0
buffer_load_dwordx4 v128, s[8:11], s50 offen offset:0 nt lds
buffer_load_dwordx4 v129, s[8:11], s50 offen offset:1024 nt lds
buffer_load_dwordx4 v130, s[8:11], s50 offen offset:2048 nt lds
buffer_load_dwordx4 v131, s[8:11], s50 offen offset:3072 nt lds
s_waitcnt vmcnt(25)
s_waitcnt vmcnt(21)
s_barrier
s_add_u32 m0, s36, 131072
s_add_u32 s50, s39, 896
buffer_load_dwordx4 v22, s[20:23], s50 offen offset:0 lds
s_add_u32 s51, s39, 8064
buffer_load_dwordx4 v23, s[20:23], s51 offen offset:1024 lds
s_add_u32 s50, s39, 15232
buffer_load_dwordx4 v22, s[20:23], s50 offen offset:2048 lds
s_add_u32 s51, s39, 22400
buffer_load_dwordx4 v23, s[20:23], s51 offen offset:3072 lds
s_add_u32 m0, s36, 147456
s_add_u32 s50, s38, 3670016
buffer_load_dwordx4 v21, s[16:19], s50 offen offset:0 lds
s_add_u32 s51, s38, 3701760
buffer_load_dwordx4 v21, s[16:19], s51 offen offset:1024 lds
s_add_u32 s50, s38, 3733504
buffer_load_dwordx4 v21, s[16:19], s50 offen offset:2048 lds
s_add_u32 s51, s38, 3765248
buffer_load_dwordx4 v21, s[16:19], s51 offen offset:3072 lds
s_waitcnt vmcnt(25)
s_waitcnt vmcnt(21)
s_barrier
s_add_u32 s50, s37, 16384
s_add_u32 m0, s36, 16384
s_nop 0
buffer_load_dwordx4 v128, s[8:11], s50 offen offset:0 nt lds
buffer_load_dwordx4 v129, s[8:11], s50 offen offset:1024 nt lds
buffer_load_dwordx4 v130, s[8:11], s50 offen offset:2048 nt lds
buffer_load_dwordx4 v131, s[8:11], s50 offen offset:3072 nt lds
s_waitcnt vmcnt(20)
s_waitcnt vmcnt(16)
s_barrier
s_add_u32 s50, s37, 0
s_add_u32 m0, s36, 49152
s_nop 0
buffer_load_dwordx4 v132, s[12:15], s50 offen offset:0 nt lds
s_nop 0
buffer_load_dwordx4 v132, s[12:15], s50 offen offset:1024 nt lds
buffer_load_dwordx4 v132, s[12:15], s50 offen offset:2048 nt lds
buffer_load_dwordx4 v132, s[12:15], s50 offen offset:3072 nt lds
s_waitcnt vmcnt(12)
s_waitcnt vmcnt(8)
s_barrier
s_add_u32 s50, s37, 32768
s_add_u32 m0, s36, 32768
s_nop 0
buffer_load_dwordx4 v128, s[8:11], s50 offen offset:0 nt lds
buffer_load_dwordx4 v129, s[8:11], s50 offen offset:1024 nt lds
buffer_load_dwordx4 v130, s[8:11], s50 offen offset:2048 nt lds
buffer_load_dwordx4 v131, s[8:11], s50 offen offset:3072 nt lds
v_readfirstlane_b32 s62, v24
s_nop 3
s_cmp_eq_u32 s62, 0
s_cbranch_scc1 LN2
LM3:
s_barrier
s_getreg_b32 s5, hwreg(HW_REG_XCC_ID)
s_and_b32 s5, s5, 15
s_lshl_b32 s5, s5, 1
s_add_u32 s5, s5, s62
s_nop 0
s_sub_u32 s52, s59, 16777216
s_lshr_b32 s52, s52, 2
s_lshl_b32 s50, s54, 14
s_add_u32 s52, s52, s50
s_add_u32 s52, s52, 37750784
v_mov_b32 v26, 0
v_mov_b32 v24, s5
s_cmp_eq_u32 s58, 0
s_cselect_b64 exec, 1, 0
buffer_store_dword v24, v26, s[28:31], s52 offen sc1
s_mov_b64 exec, -1
ds_read_b128 v[32:35], v20 offset:0
ds_read_b128 v[36:39], v20 offset:1024
ds_read_b128 v[40:43], v20 offset:2048
ds_read_b128 v[44:47], v20 offset:3072
ds_read_b128 v[48:51], v20 offset:4096
ds_read_b128 v[52:55], v20 offset:5120
ds_read_b128 v[56:59], v20 offset:6144
ds_read_b128 v[60:63], v20 offset:7168
ds_read_b128 v[208:211], v2 offset:0
ds_read_b128 v[212:215], v2 offset:8192
ds_read_b128 v[216:219], v3 offset:0
ds_read_b128 v[220:223], v3 offset:8192
ds_read_b128 v[224:227], v4 offset:0
ds_read_b128 v[228:231], v4 offset:8192
ds_read_b128 v[232:235], v5 offset:0
s_waitcnt lgkmcnt(5)
v_mfma_f32_32x32x16_bf16 v[64:79], v[208:211], v[32:35], 0
s_nop 0
ds_read_b128 v[236:239], v5 offset:8192
v_mfma_f32_32x32x16_bf16 v[80:95], v[212:215], v[32:35], 0
ds_read_b128 v[208:211], v6 offset:0
s_waitcnt lgkmcnt(5)
v_mfma_f32_32x32x16_bf16 v[64:79], v[216:219], v[36:39], v[64:79]
ds_read_b128 v[212:215], v6 offset:8192
v_mfma_f32_32x32x16_bf16 v[80:95], v[220:223], v[36:39], v[80:95]
ds_read_b128 v[216:219], v7 offset:0
s_waitcnt lgkmcnt(5)
v_mfma_f32_32x32x16_bf16 v[64:79], v[224:227], v[40:43], v[64:79]
ds_read_b128 v[220:223], v7 offset:8192
v_mfma_f32_32x32x16_bf16 v[80:95], v[228:231], v[40:43], v[80:95]
ds_read_b128 v[224:227], v8 offset:0
s_waitcnt lgkmcnt(5)
v_mfma_f32_32x32x16_bf16 v[64:79], v[232:235], v[44:47], v[64:79]
ds_read_b128 v[228:231], v8 offset:8192
v_mfma_f32_32x32x16_bf16 v[80:95], v[236:239], v[44:47], v[80:95]
s_nop 0
ds_read_b128 v[232:235], v9 offset:0
s_waitcnt lgkmcnt(5)
v_mfma_f32_32x32x16_bf16 v[64:79], v[208:211], v[48:51], v[64:79]
ds_read_b128 v[236:239], v9 offset:8192
v_mfma_f32_32x32x16_bf16 v[80:95], v[212:215], v[48:51], v[80:95]
s_waitcnt lgkmcnt(4)
v_mfma_f32_32x32x16_bf16 v[64:79], v[216:219], v[52:55], v[64:79]
v_mfma_f32_32x32x16_bf16 v[80:95], v[220:223], v[52:55], v[80:95]
s_waitcnt vmcnt(9)
s_waitcnt lgkmcnt(0)
s_barrier
ds_read_b128 v[208:211], v2 offset:16384
ds_read_b128 v[212:215], v2 offset:24576
ds_read_b128 v[216:219], v3 offset:16384
v_mfma_f32_32x32x16_bf16 v[64:79], v[224:227], v[56:59], v[64:79]
ds_read_b128 v[220:223], v3 offset:24576
v_mfma_f32_32x32x16_bf16 v[80:95], v[228:231], v[56:59], v[80:95]
ds_read_b128 v[224:227], v4 offset:16384
s_nop 0
v_mfma_f32_32x32x16_bf16 v[64:79], v[232:235], v[60:63], v[64:79]
ds_read_b128 v[228:231], v4 offset:24576
v_mfma_f32_32x32x16_bf16 v[80:95], v[236:239], v[60:63], v[80:95]
ds_read_b128 v[232:235], v5 offset:16384
s_nop 8
v_max3_f32 v15, v64, v65, v66
s_nop 0
v_max3_f32 v16, v79, v80, v81
v_max3_f32 v15, v15, v67, v68
v_max3_f32 v16, v16, v82, v83
v_max3_f32 v15, v15, v69, v70
v_max3_f32 v16, v16, v84, v85
v_max3_f32 v15, v15, v71, v72
v_max3_f32 v16, v16, v86, v87
v_max3_f32 v15, v15, v73, v74
v_max3_f32 v16, v16, v88, v89
v_max3_f32 v15, v15, v75, v76
v_max3_f32 v16, v16, v90, v91
v_max3_f32 v15, v15, v77, v78
v_max3_f32 v16, v16, v92, v93
v_max3_f32 v15, v15, v94, v95
v_max_f32 v15, v15, v16
v_mov_b32 v16, v15
s_nop 1
v_permlane32_swap_b32 v15, v16
v_max_f32 v15, v15, v16
s_cmp_eq_u32 s58, 3
s_cselect_b32 vcc_lo, 0xffff, -1
s_cselect_b32 vcc_hi, 0xffff, -1
v_mov_b32 v17, 0x7149f2ca
v_cndmask_b32 v15, v17, v15, vcc
v_mul_f32 v240, -1.0, v15
v_mul_f32 v241, -1.0, v15
v_mul_f32 v242, -1.0, v15
v_mul_f32 v243, -1.0, v15
v_mul_f32 v244, -1.0, v15
v_mul_f32 v245, -1.0, v15
v_mul_f32 v246, -1.0, v15
v_mul_f32 v247, -1.0, v15
v_mul_f32 v248, -1.0, v15
v_mul_f32 v249, -1.0, v15
v_mul_f32 v250, -1.0, v15
v_mul_f32 v251, -1.0, v15
v_mul_f32 v252, -1.0, v15
v_mul_f32 v253, -1.0, v15
v_mul_f32 v254, -1.0, v15
v_mul_f32 v255, -1.0, v15
s_waitcnt lgkmcnt(5)
s_nop 0
v_mfma_f32_32x32x16_bf16 v[96:111], v[208:211], v[32:35], v[240:255]
ds_read_b128 v[236:239], v5 offset:24576
v_add_f32 v64, v64, v240
v_add_f32 v65, v65, v240
v_exp_f32 v64, v64
v_add_f32_e64 v66, v66, v240
v_mfma_f32_32x32x16_bf16 v[112:127], v[212:215], v[32:35], v[240:255]
ds_read_b128 v[208:211], v6 offset:16384
v_exp_f32 v65, v65
v_mov_b32 v14, v64
v_add_f32 v67, v67, v240
v_exp_f32 v66, v66
v_add_f32 v14, v14, v65
s_waitcnt lgkmcnt(5)
v_mfma_f32_32x32x16_bf16 v[96:111], v[216:219], v[36:39], v[96:111]
ds_read_b128 v[212:215], v6 offset:24576
v_cvt_pk_bf16_f32 v192, v64, v65
v_add_f32 v68, v68, v240
v_exp_f32 v67, v67
v_add_f32 v14, v14, v66
v_add_f32 v69, v69, v240
v_mfma_f32_32x32x16_bf16 v[112:127], v[220:223], v[36:39], v[112:127]
ds_read_b128 v[216:219], v7 offset:16384
v_exp_f32 v68, v68
v_add_f32 v14, v14, v67
v_cvt_pk_bf16_f32 v193, v66, v67
v_add_f32 v70, v70, v240
s_waitcnt lgkmcnt(5)
v_mfma_f32_32x32x16_bf16 v[96:111], v[224:227], v[40:43], v[96:111]
ds_read_b128 v[220:223], v7 offset:24576
v_exp_f32 v69, v69
v_add_f32 v14, v14, v68
v_add_f32 v71, v71, v240
v_exp_f32 v70, v70
v_add_f32 v14, v14, v69
v_mfma_f32_32x32x16_bf16 v[112:127], v[228:231], v[40:43], v[112:127]
ds_read_b128 v[224:227], v8 offset:16384
v_cvt_pk_bf16_f32 v194, v68, v69
v_add_f32 v72, v72, v240
v_exp_f32 v71, v71
v_add_f32 v14, v14, v70
v_add_f32 v73, v73, v240
s_waitcnt lgkmcnt(5)
v_mfma_f32_32x32x16_bf16 v[96:111], v[232:235], v[44:47], v[96:111]
ds_read_b128 v[228:231], v8 offset:24576
v_exp_f32 v72, v72
v_add_f32 v14, v14, v71
v_cvt_pk_bf16_f32 v195, v70, v71
v_add_f32 v74, v74, v240
v_mfma_f32_32x32x16_bf16 v[112:127], v[236:239], v[44:47], v[112:127]
ds_read_b128 v[232:235], v9 offset:16384
v_exp_f32 v73, v73
v_add_f32 v14, v14, v72
v_add_f32 v75, v75, v240
v_exp_f32 v74, v74
v_add_f32 v14, v14, v73
s_waitcnt lgkmcnt(5)
v_mfma_f32_32x32x16_bf16 v[96:111], v[208:211], v[48:51], v[96:111]
ds_read_b128 v[236:239], v9 offset:24576
v_cvt_pk_bf16_f32 v196, v72, v73
v_add_f32 v76, v76, v240
v_exp_f32 v75, v75
v_add_f32 v14, v14, v74
v_add_f32_e64 v77, v77, v240
v_mfma_f32_32x32x16_bf16 v[112:127], v[212:215], v[48:51], v[112:127]
v_exp_f32 v76, v76
v_add_f32 v14, v14, v75
v_cvt_pk_bf16_f32 v197, v74, v75
v_add_f32 v78, v78, v240
s_waitcnt lgkmcnt(4)
v_mfma_f32_32x32x16_bf16 v[96:111], v[216:219], v[52:55], v[96:111]
v_exp_f32 v77, v77
v_add_f32 v14, v14, v76
v_add_f32 v79, v79, v240
v_exp_f32 v78, v78
v_add_f32_e64 v14, v14, v77
v_mfma_f32_32x32x16_bf16 v[112:127], v[220:223], v[52:55], v[112:127]
v_cvt_pk_bf16_f32 v198, v76, v77
v_exp_f32 v79, v79
v_add_f32 v14, v14, v78
v_add_f32 v14, v14, v79
v_cvt_pk_bf16_f32 v199, v78, v79
s_waitcnt vmcnt(5)
s_waitcnt lgkmcnt(0)
s_barrier
ds_read_b64_tr_b16 v[208:209], v10 offset:0
ds_read_b64_tr_b16 v[210:211], v10 offset:2048
ds_read_b64_tr_b16 v[212:213], v11 offset:0
ds_read_b64_tr_b16 v[214:215], v11 offset:2048
ds_read_b64_tr_b16 v[216:217], v12 offset:0
ds_read_b64_tr_b16 v[218:219], v12 offset:2048
v_mfma_f32_32x32x16_bf16 v[96:111], v[224:227], v[56:59], v[96:111]
ds_read_b64_tr_b16 v[220:221], v13 offset:0
ds_read_b64_tr_b16 v[222:223], v13 offset:2048
v_add_f32 v80, v80, v240
v_add_f32 v81, v81, v240
v_exp_f32 v80, v80
v_mfma_f32_32x32x16_bf16 v[112:127], v[228:231], v[56:59], v[112:127]
ds_read_b64_tr_b16 v[224:225], v10 offset:4096
ds_read_b64_tr_b16 v[226:227], v10 offset:6144
v_add_f32 v82, v82, v240
v_exp_f32 v81, v81
v_add_f32 v14, v14, v80
v_add_f32_e64 v83, v83, v240
v_mfma_f32_32x32x16_bf16 v[96:111], v[232:235], v[60:63], v[96:111]
ds_read_b64_tr_b16 v[228:229], v11 offset:4096
ds_read_b64_tr_b16 v[230:231], v11 offset:6144
v_exp_f32 v82, v82
v_add_f32 v14, v14, v81
v_cvt_pk_bf16_f32 v200, v80, v81
v_mfma_f32_32x32x16_bf16 v[112:127], v[236:239], v[60:63], v[112:127]
ds_read_b64_tr_b16 v[232:233], v12 offset:4096
ds_read_b64_tr_b16 v[234:235], v12 offset:6144
v_add_f32 v84, v84, v240
v_exp_f32 v83, v83
v_add_f32 v14, v14, v82
v_add_f32 v85, v85, v240
s_waitcnt lgkmcnt(10)
v_mfma_f32_32x32x16_bf16 v[128:143], v[208:211], v[192:195], 0
ds_read_b64_tr_b16 v[236:237], v13 offset:4096
ds_read_b64_tr_b16 v[238:239], v13 offset:6144
v_exp_f32 v84, v84
v_add_f32_e64 v14, v14, v83
v_cvt_pk_bf16_f32 v201, v82, v83
v_mfma_f32_32x32x16_bf16 v[144:159], v[212:215], v[192:195], 0
ds_read_b64_tr_b16 v[208:209], v10 offset:8192
ds_read_b64_tr_b16 v[210:211], v10 offset:10240
v_add_f32 v86, v86, v240
v_exp_f32 v85, v85
v_add_f32 v14, v14, v84
v_add_f32 v87, v87, v240
s_waitcnt lgkmcnt(10)
v_mfma_f32_32x32x16_bf16 v[160:175], v[216:219], v[192:195], 0
ds_read_b64_tr_b16 v[212:213], v11 offset:8192
ds_read_b64_tr_b16 v[214:215], v11 offset:10240
v_exp_f32 v86, v86
v_add_f32_e64 v14, v14, v85
v_cvt_pk_bf16_f32 v202, v84, v85
v_mfma_f32_32x32x16_bf16 v[176:191], v[220:223], v[192:195], 0
ds_read_b64_tr_b16 v[216:217], v12 offset:8192
ds_read_b64_tr_b16 v[218:219], v12 offset:10240
v_add_f32 v88, v88, v240
v_exp_f32 v87, v87
v_add_f32 v14, v14, v86
v_add_f32_e64 v89, v89, v240
s_waitcnt lgkmcnt(10)
v_mfma_f32_32x32x16_bf16 v[128:143], v[224:227], v[196:199], v[128:143]
ds_read_b64_tr_b16 v[220:221], v13 offset:8192
ds_read_b64_tr_b16 v[222:223], v13 offset:10240
v_exp_f32 v88, v88
v_add_f32 v14, v14, v87
v_cvt_pk_bf16_f32 v203, v86, v87
v_mfma_f32_32x32x16_bf16 v[144:159], v[228:231], v[196:199], v[144:159]
ds_read_b64_tr_b16 v[224:225], v10 offset:12288
ds_read_b64_tr_b16 v[226:227], v10 offset:14336
v_add_f32 v90, v90, v240
v_exp_f32 v89, v89
v_add_f32 v14, v14, v88
v_add_f32 v91, v91, v240
s_waitcnt lgkmcnt(10)
v_mfma_f32_32x32x16_bf16 v[160:175], v[232:235], v[196:199], v[160:175]
ds_read_b64_tr_b16 v[228:229], v11 offset:12288
ds_read_b64_tr_b16 v[230:231], v11 offset:14336
v_exp_f32 v90, v90
v_add_f32_e64 v14, v14, v89
v_cvt_pk_bf16_f32 v204, v88, v89
v_mfma_f32_32x32x16_bf16 v[176:191], v[236:239], v[196:199], v[176:191]
ds_read_b64_tr_b16 v[232:233], v12 offset:12288
ds_read_b64_tr_b16 v[234:235], v12 offset:14336
v_add_f32 v92, v92, v240
v_exp_f32 v91, v91
v_add_f32 v14, v14, v90
v_add_f32 v93, v93, v240
s_waitcnt lgkmcnt(10)
v_mfma_f32_32x32x16_bf16 v[128:143], v[208:211], v[200:203], v[128:143]
ds_read_b64_tr_b16 v[236:237], v13 offset:12288
ds_read_b64_tr_b16 v[238:239], v13 offset:14336
v_exp_f32 v92, v92
v_add_f32 v14, v14, v91
v_cvt_pk_bf16_f32 v205, v90, v91
v_mfma_f32_32x32x16_bf16 v[144:159], v[212:215], v[200:203], v[144:159]
v_add_f32 v94, v94, v240
v_exp_f32 v93, v93
v_add_f32 v14, v14, v92
v_add_f32 v95, v95, v240
s_waitcnt lgkmcnt(8)
v_mfma_f32_32x32x16_bf16 v[160:175], v[216:219], v[200:203], v[160:175]
v_exp_f32 v94, v94
v_add_f32 v14, v14, v93
v_cvt_pk_bf16_f32 v206, v92, v93
v_mfma_f32_32x32x16_bf16 v[176:191], v[220:223], v[200:203], v[176:191]
v_exp_f32 v95, v95
v_add_f32 v14, v14, v94
v_add_f32 v14, v14, v95
v_cvt_pk_bf16_f32 v207, v94, v95
s_waitcnt vmcnt(1)
s_waitcnt lgkmcnt(0)
s_barrier
ds_read_b128 v[208:211], v2 offset:32768
ds_read_b128 v[212:215], v2 offset:40960
ds_read_b128 v[216:219], v3 offset:32768
v_mfma_f32_32x32x16_bf16 v[128:143], v[224:227], v[204:207], v[128:143]
ds_read_b128 v[220:223], v3 offset:40960
v_max3_f32 v15, v96, v97, v98
v_max3_f32 v16, v111, v112, v113
v_max3_f32 v15, v15, v99, v100
v_max3_f32 v16, v16, v114, v115
v_mfma_f32_32x32x16_bf16 v[144:159], v[228:231], v[204:207], v[144:159]
ds_read_b128 v[224:227], v4 offset:32768
v_max3_f32 v15, v15, v101, v102
v_max3_f32 v16, v16, v116, v117
v_max3_f32 v15, v15, v103, v104
v_max3_f32 v16, v16, v118, v119
v_max3_f32 v15, v15, v105, v106
v_mfma_f32_32x32x16_bf16 v[160:175], v[232:235], v[204:207], v[160:175]
ds_read_b128 v[228:231], v4 offset:40960
v_max3_f32 v16, v16, v120, v121
v_max3_f32 v15, v15, v107, v108
v_max3_f32 v16, v16, v122, v123
v_max3_f32 v15, v15, v109, v110
v_max3_f32 v16, v16, v124, v125
v_mfma_f32_32x32x16_bf16 v[176:191], v[236:239], v[204:207], v[176:191]
ds_read_b128 v[232:235], v5 offset:32768
v_max3_f32 v15, v15, v126, v127
v_max_f32 v15, v15, v16
v_mov_b32 v16, v15
s_nop 1
v_permlane32_swap_b32 v15, v16
v_max_f32 v15, v15, v16
v_cmp_lt_f32 vcc, 0x41000000, v15
s_nop 4
s_cbranch_vccnz LX4
LB5:
s_waitcnt lgkmcnt(5)
v_mfma_f32_32x32x16_bf16 v[64:79], v[208:211], v[32:35], v[240:255]
ds_read_b128 v[236:239], v5 offset:40960
v_exp_f32 v96, v96
v_exp_f32 v97, v97
v_exp_f32_e64 v98, v98
v_mfma_f32_32x32x16_bf16 v[80:95], v[212:215], v[32:35], v[240:255]
ds_read_b128 v[208:211], v6 offset:32768
v_add_f32 v14, v14, v96
v_exp_f32 v99, v99
v_add_f32 v14, v14, v97
s_waitcnt lgkmcnt(5)
v_mfma_f32_32x32x16_bf16 v[64:79], v[216:219], v[36:39], v[64:79]
ds_read_b128 v[212:215], v6 offset:40960
v_cvt_pk_bf16_f32 v192, v96, v97
v_exp_f32 v100, v100
v_add_f32 v14, v14, v98
v_exp_f32 v101, v101
v_mfma_f32_32x32x16_bf16 v[80:95], v[220:223], v[36:39], v[80:95]
ds_read_b128 v[216:219], v7 offset:32768
v_add_f32 v14, v14, v99
v_cvt_pk_bf16_f32 v193, v98, v99
v_exp_f32 v102, v102
s_waitcnt lgkmcnt(5)
v_mfma_f32_32x32x16_bf16 v[64:79], v[224:227], v[40:43], v[64:79]
ds_read_b128 v[220:223], v7 offset:40960
v_add_f32 v14, v14, v100
v_exp_f32 v103, v103
v_add_f32 v14, v14, v101
v_mfma_f32_32x32x16_bf16 v[80:95], v[228:231], v[40:43], v[80:95]
ds_read_b128 v[224:227], v8 offset:32768
v_cvt_pk_bf16_f32 v194, v100, v101
v_exp_f32 v104, v104
v_add_f32 v14, v14, v102
v_exp_f32 v105, v105
s_waitcnt lgkmcnt(5)
v_mfma_f32_32x32x16_bf16 v[64:79], v[232:235], v[44:47], v[64:79]
ds_read_b128 v[228:231], v8 offset:40960
v_add_f32 v14, v14, v103
v_cvt_pk_bf16_f32 v195, v102, v103
v_exp_f32 v106, v106
v_mfma_f32_32x32x16_bf16 v[80:95], v[236:239], v[44:47], v[80:95]
ds_read_b128 v[232:235], v9 offset:32768
v_add_f32 v14, v14, v104
v_exp_f32 v107, v107
v_add_f32_e64 v14, v14, v105
s_waitcnt lgkmcnt(5)
v_mfma_f32_32x32x16_bf16 v[64:79], v[208:211], v[48:51], v[64:79]
ds_read_b128 v[236:239], v9 offset:40960
v_cvt_pk_bf16_f32 v196, v104, v105
v_exp_f32 v108, v108
v_add_f32 v14, v14, v106
v_exp_f32 v109, v109
v_mfma_f32_32x32x16_bf16 v[80:95], v[212:215], v[48:51], v[80:95]
v_add_f32 v14, v14, v107
v_cvt_pk_bf16_f32 v197, v106, v107
v_exp_f32 v110, v110
s_waitcnt lgkmcnt(4)
v_mfma_f32_32x32x16_bf16 v[64:79], v[216:219], v[52:55], v[64:79]
v_add_f32 v14, v14, v108
v_exp_f32 v111, v111
v_add_f32 v14, v14, v109
v_mfma_f32_32x32x16_bf16 v[80:95], v[220:223], v[52:55], v[80:95]
v_cvt_pk_bf16_f32 v198, v108, v109
v_add_f32 v14, v14, v110
v_add_f32_e64 v14, v14, v111
v_cvt_pk_bf16_f32 v199, v110, v111
s_waitcnt lgkmcnt(0)
s_barrier
ds_read_b64_tr_b16 v[208:209], v10 offset:16384
ds_read_b64_tr_b16 v[210:211], v10 offset:18432
ds_read_b64_tr_b16 v[212:213], v11 offset:16384
ds_read_b64_tr_b16 v[214:215], v11 offset:18432
ds_read_b64_tr_b16 v[216:217], v12 offset:16384
ds_read_b64_tr_b16 v[218:219], v12 offset:18432
v_mfma_f32_32x32x16_bf16 v[64:79], v[224:227], v[56:59], v[64:79]
ds_read_b64_tr_b16 v[220:221], v13 offset:16384
ds_read_b64_tr_b16 v[222:223], v13 offset:18432
v_exp_f32 v112, v112
v_exp_f32 v113, v113
v_mfma_f32_32x32x16_bf16 v[80:95], v[228:231], v[56:59], v[80:95]
ds_read_b64_tr_b16 v[224:225], v10 offset:20480
ds_read_b64_tr_b16 v[226:227], v10 offset:22528
v_exp_f32 v114, v114
v_add_f32 v14, v14, v112
v_exp_f32 v115, v115
v_mfma_f32_32x32x16_bf16 v[64:79], v[232:235], v[60:63], v[64:79]
ds_read_b64_tr_b16 v[228:229], v11 offset:20480
ds_read_b64_tr_b16 v[230:231], v11 offset:22528
v_add_f32 v14, v14, v113
v_cvt_pk_bf16_f32 v200, v112, v113
v_mfma_f32_32x32x16_bf16 v[80:95], v[236:239], v[60:63], v[80:95]
ds_read_b64_tr_b16 v[232:233], v12 offset:20480
ds_read_b64_tr_b16 v[234:235], v12 offset:22528
v_exp_f32 v116, v116
v_add_f32 v14, v14, v114
v_exp_f32 v117, v117
s_waitcnt lgkmcnt(10)
v_mfma_f32_32x32x16_bf16 v[128:143], v[208:211], v[192:195], v[128:143]
ds_read_b64_tr_b16 v[236:237], v13 offset:20480
ds_read_b64_tr_b16 v[238:239], v13 offset:22528
v_add_f32 v14, v14, v115
v_cvt_pk_bf16_f32 v201, v114, v115
v_mfma_f32_32x32x16_bf16 v[144:159], v[212:215], v[192:195], v[144:159]
ds_read_b64_tr_b16 v[208:209], v10 offset:24576
ds_read_b64_tr_b16 v[210:211], v10 offset:26624
v_exp_f32 v118, v118
v_add_f32 v14, v14, v116
v_exp_f32_e64 v119, v119
s_waitcnt lgkmcnt(10)
v_mfma_f32_32x32x16_bf16 v[160:175], v[216:219], v[192:195], v[160:175]
ds_read_b64_tr_b16 v[212:213], v11 offset:24576
ds_read_b64_tr_b16 v[214:215], v11 offset:26624
v_add_f32 v14, v14, v117
v_cvt_pk_bf16_f32 v202, v116, v117
v_mfma_f32_32x32x16_bf16 v[176:191], v[220:223], v[192:195], v[176:191]
ds_read_b64_tr_b16 v[216:217], v12 offset:24576
ds_read_b64_tr_b16 v[218:219], v12 offset:26624
v_exp_f32 v120, v120
v_add_f32 v14, v14, v118
v_exp_f32 v121, v121
s_waitcnt lgkmcnt(10)
v_mfma_f32_32x32x16_bf16 v[128:143], v[224:227], v[196:199], v[128:143]
ds_read_b64_tr_b16 v[220:221], v13 offset:24576
ds_read_b64_tr_b16 v[222:223], v13 offset:26624
v_add_f32 v14, v14, v119
v_cvt_pk_bf16_f32 v203, v118, v119
v_mfma_f32_32x32x16_bf16 v[144:159], v[228:231], v[196:199], v[144:159]
ds_read_b64_tr_b16 v[224:225], v10 offset:28672
ds_read_b64_tr_b16 v[226:227], v10 offset:30720
v_exp_f32 v122, v122
v_add_f32 v14, v14, v120
v_exp_f32 v123, v123
s_waitcnt lgkmcnt(10)
v_mfma_f32_32x32x16_bf16 v[160:175], v[232:235], v[196:199], v[160:175]
ds_read_b64_tr_b16 v[228:229], v11 offset:28672
ds_read_b64_tr_b16 v[230:231], v11 offset:30720
v_add_f32_e64 v14, v14, v121
v_cvt_pk_bf16_f32 v204, v120, v121
v_mfma_f32_32x32x16_bf16 v[176:191], v[236:239], v[196:199], v[176:191]
ds_read_b64_tr_b16 v[232:233], v12 offset:28672
ds_read_b64_tr_b16 v[234:235], v12 offset:30720
v_exp_f32 v124, v124
v_add_f32 v14, v14, v122
v_exp_f32 v125, v125
s_waitcnt lgkmcnt(10)
v_mfma_f32_32x32x16_bf16 v[128:143], v[208:211], v[200:203], v[128:143]
ds_read_b64_tr_b16 v[236:237], v13 offset:28672
ds_read_b64_tr_b16 v[238:239], v13 offset:30720
v_add_f32 v14, v14, v123
v_cvt_pk_bf16_f32 v205, v122, v123
v_mfma_f32_32x32x16_bf16 v[144:159], v[212:215], v[200:203], v[144:159]
v_exp_f32 v126, v126
v_add_f32 v14, v14, v124
v_exp_f32 v127, v127
s_waitcnt lgkmcnt(8)
v_mfma_f32_32x32x16_bf16 v[160:175], v[216:219], v[200:203], v[160:175]
v_add_f32 v14, v14, v125
v_cvt_pk_bf16_f32 v206, v124, v125
v_mfma_f32_32x32x16_bf16 v[176:191], v[220:223], v[200:203], v[176:191]
v_add_f32 v14, v14, v126
v_add_f32 v14, v14, v127
v_cvt_pk_bf16_f32 v207, v126, v127
s_waitcnt lgkmcnt(0)
s_barrier
ds_read_b128 v[208:211], v2 offset:0
ds_read_b128 v[212:215], v2 offset:8192
ds_read_b128 v[216:219], v3 offset:0
v_mfma_f32_32x32x16_bf16 v[128:143], v[224:227], v[204:207], v[128:143]
ds_read_b128 v[220:223], v3 offset:8192
v_max3_f32 v15, v64, v65, v66
v_max3_f32 v16, v79, v80, v81
v_max3_f32 v15, v15, v67, v68
v_max3_f32 v16, v16, v82, v83
v_mfma_f32_32x32x16_bf16 v[144:159], v[228:231], v[204:207], v[144:159]
ds_read_b128 v[224:227], v4 offset:0
v_max3_f32 v15, v15, v69, v70
v_max3_f32 v16, v16, v84, v85
v_max3_f32 v15, v15, v71, v72
v_max3_f32 v16, v16, v86, v87
v_max3_f32 v15, v15, v73, v74
v_mfma_f32_32x32x16_bf16 v[160:175], v[232:235], v[204:207], v[160:175]
ds_read_b128 v[228:231], v4 offset:8192
v_max3_f32 v16, v16, v88, v89
v_max3_f32 v15, v15, v75, v76
v_max3_f32 v16, v16, v90, v91
v_max3_f32 v15, v15, v77, v78
v_max3_f32 v16, v16, v92, v93
v_mfma_f32_32x32x16_bf16 v[176:191], v[236:239], v[204:207], v[176:191]
ds_read_b128 v[232:235], v5 offset:0
v_max3_f32 v15, v15, v94, v95
v_max_f32 v15, v15, v16
v_mov_b32 v16, v15
s_nop 1
v_permlane32_swap_b32 v15, v16
v_max_f32_e64 v15, v15, v16
v_cmp_lt_f32 vcc, 0x41000000, v15
s_nop 4
s_cbranch_vccnz LX6
LB7:
s_waitcnt lgkmcnt(5)
v_mfma_f32_32x32x16_bf16 v[96:111], v[208:211], v[32:35], v[240:255]
ds_read_b128 v[236:239], v5 offset:8192
v_exp_f32 v64, v64
v_exp_f32 v65, v65
v_exp_f32 v66, v66
v_mfma_f32_32x32x16_bf16 v[112:127], v[212:215], v[32:35], v[240:255]
ds_read_b128 v[208:211], v6 offset:0
v_add_f32 v14, v14, v64
v_exp_f32 v67, v67
v_add_f32 v14, v14, v65
s_waitcnt lgkmcnt(5)
v_mfma_f32_32x32x16_bf16 v[96:111], v[216:219], v[36:39], v[96:111]
ds_read_b128 v[212:215], v6 offset:8192
v_cvt_pk_bf16_f32 v192, v64, v65
v_exp_f32 v68, v68
v_add_f32 v14, v14, v66
v_exp_f32_e64 v69, v69
v_mfma_f32_32x32x16_bf16 v[112:127], v[220:223], v[36:39], v[112:127]
ds_read_b128 v[216:219], v7 offset:0
v_add_f32 v14, v14, v67
v_cvt_pk_bf16_f32 v193, v66, v67
v_exp_f32 v70, v70
s_waitcnt lgkmcnt(5)
v_mfma_f32_32x32x16_bf16 v[96:111], v[224:227], v[40:43], v[96:111]
ds_read_b128 v[220:223], v7 offset:8192
v_add_f32 v14, v14, v68
v_exp_f32 v71, v71
v_add_f32 v14, v14, v69
v_mfma_f32_32x32x16_bf16 v[112:127], v[228:231], v[40:43], v[112:127]
ds_read_b128 v[224:227], v8 offset:0
v_cvt_pk_bf16_f32 v194, v68, v69
v_exp_f32 v72, v72
v_add_f32 v14, v14, v70
v_exp_f32 v73, v73
s_waitcnt lgkmcnt(5)
v_mfma_f32_32x32x16_bf16 v[96:111], v[232:235], v[44:47], v[96:111]
ds_read_b128 v[228:231], v8 offset:8192
v_add_f32 v14, v14, v71
v_cvt_pk_bf16_f32 v195, v70, v71
v_exp_f32 v74, v74
v_mfma_f32_32x32x16_bf16 v[112:127], v[236:239], v[44:47], v[112:127]
ds_read_b128 v[232:235], v9 offset:0
v_add_f32 v14, v14, v72
v_exp_f32 v75, v75
v_add_f32 v14, v14, v73
s_waitcnt lgkmcnt(5)
v_mfma_f32_32x32x16_bf16 v[96:111], v[208:211], v[48:51], v[96:111]
ds_read_b128 v[236:239], v9 offset:8192
v_cvt_pk_bf16_f32 v196, v72, v73
v_exp_f32 v76, v76
v_add_f32 v14, v14, v74
v_exp_f32 v77, v77
v_mfma_f32_32x32x16_bf16 v[112:127], v[212:215], v[48:51], v[112:127]
v_add_f32 v14, v14, v75
v_cvt_pk_bf16_f32 v197, v74, v75
v_exp_f32 v78, v78
s_waitcnt lgkmcnt(4)
v_mfma_f32_32x32x16_bf16 v[96:111], v[216:219], v[52:55], v[96:111]
v_add_f32 v14, v14, v76
v_exp_f32 v79, v79
v_add_f32_e64 v14, v14, v77
v_mfma_f32_32x32x16_bf16 v[112:127], v[220:223], v[52:55], v[112:127]
v_cvt_pk_bf16_f32 v198, v76, v77
v_add_f32 v14, v14, v78
v_add_f32 v14, v14, v79
v_cvt_pk_bf16_f32 v199, v78, v79
s_waitcnt lgkmcnt(0)
s_barrier
ds_read_b64_tr_b16 v[208:209], v10 offset:32768
ds_read_b64_tr_b16 v[210:211], v10 offset:34816
ds_read_b64_tr_b16 v[212:213], v11 offset:32768
ds_read_b64_tr_b16 v[214:215], v11 offset:34816
ds_read_b64_tr_b16 v[216:217], v12 offset:32768
ds_read_b64_tr_b16 v[218:219], v12 offset:34816
v_mfma_f32_32x32x16_bf16 v[96:111], v[224:227], v[56:59], v[96:111]
ds_read_b64_tr_b16 v[220:221], v13 offset:32768
ds_read_b64_tr_b16 v[222:223], v13 offset:34816
v_exp_f32 v80, v80
v_exp_f32 v81, v81
v_mfma_f32_32x32x16_bf16 v[112:127], v[228:231], v[56:59], v[112:127]
ds_read_b64_tr_b16 v[224:225], v10 offset:36864
ds_read_b64_tr_b16 v[226:227], v10 offset:38912
v_exp_f32 v82, v82
v_add_f32 v14, v14, v80
v_exp_f32 v83, v83
v_mfma_f32_32x32x16_bf16 v[96:111], v[232:235], v[60:63], v[96:111]
ds_read_b64_tr_b16 v[228:229], v11 offset:36864
ds_read_b64_tr_b16 v[230:231], v11 offset:38912
v_add_f32 v14, v14, v81
v_cvt_pk_bf16_f32 v200, v80, v81
v_mfma_f32_32x32x16_bf16 v[112:127], v[236:239], v[60:63], v[112:127]
ds_read_b64_tr_b16 v[232:233], v12 offset:36864
ds_read_b64_tr_b16 v[234:235], v12 offset:38912
v_exp_f32 v84, v84
v_add_f32 v14, v14, v82
v_exp_f32 v85, v85
s_waitcnt lgkmcnt(10)
v_mfma_f32_32x32x16_bf16 v[128:143], v[208:211], v[192:195], v[128:143]
ds_read_b64_tr_b16 v[236:237], v13 offset:36864
ds_read_b64_tr_b16 v[238:239], v13 offset:38912
v_add_f32_e64 v14, v14, v83
v_cvt_pk_bf16_f32 v201, v82, v83
v_mfma_f32_32x32x16_bf16 v[144:159], v[212:215], v[192:195], v[144:159]
ds_read_b64_tr_b16 v[208:209], v10 offset:40960
ds_read_b64_tr_b16 v[210:211], v10 offset:43008
v_exp_f32 v86, v86
v_add_f32 v14, v14, v84
v_exp_f32 v87, v87
s_waitcnt lgkmcnt(10)
v_mfma_f32_32x32x16_bf16 v[160:175], v[216:219], v[192:195], v[160:175]
ds_read_b64_tr_b16 v[212:213], v11 offset:40960
ds_read_b64_tr_b16 v[214:215], v11 offset:43008
v_add_f32 v14, v14, v85
v_cvt_pk_bf16_f32 v202, v84, v85
v_mfma_f32_32x32x16_bf16 v[176:191], v[220:223], v[192:195], v[176:191]
ds_read_b64_tr_b16 v[216:217], v12 offset:40960
ds_read_b64_tr_b16 v[218:219], v12 offset:43008
v_exp_f32 v88, v88
v_add_f32 v14, v14, v86
v_exp_f32_e64 v89, v89
s_waitcnt lgkmcnt(10)
v_mfma_f32_32x32x16_bf16 v[128:143], v[224:227], v[196:199], v[128:143]
ds_read_b64_tr_b16 v[220:221], v13 offset:40960
ds_read_b64_tr_b16 v[222:223], v13 offset:43008
v_add_f32 v14, v14, v87
v_cvt_pk_bf16_f32 v203, v86, v87
v_mfma_f32_32x32x16_bf16 v[144:159], v[228:231], v[196:199], v[144:159]
ds_read_b64_tr_b16 v[224:225], v10 offset:45056
ds_read_b64_tr_b16 v[226:227], v10 offset:47104
v_exp_f32 v90, v90
v_add_f32 v14, v14, v88
v_exp_f32 v91, v91
s_waitcnt lgkmcnt(10)
v_mfma_f32_32x32x16_bf16 v[160:175], v[232:235], v[196:199], v[160:175]
ds_read_b64_tr_b16 v[228:229], v11 offset:45056
ds_read_b64_tr_b16 v[230:231], v11 offset:47104
v_add_f32 v14, v14, v89
v_cvt_pk_bf16_f32 v204, v88, v89
v_mfma_f32_32x32x16_bf16 v[176:191], v[236:239], v[196:199], v[176:191]
ds_read_b64_tr_b16 v[232:233], v12 offset:45056
ds_read_b64_tr_b16 v[234:235], v12 offset:47104
v_exp_f32 v92, v92
v_add_f32 v14, v14, v90
v_exp_f32 v93, v93
s_waitcnt lgkmcnt(10)
v_mfma_f32_32x32x16_bf16 v[128:143], v[208:211], v[200:203], v[128:143]
ds_read_b64_tr_b16 v[236:237], v13 offset:45056
ds_read_b64_tr_b16 v[238:239], v13 offset:47104
v_add_f32_e64 v14, v14, v91
v_cvt_pk_bf16_f32 v205, v90, v91
v_mfma_f32_32x32x16_bf16 v[144:159], v[212:215], v[200:203], v[144:159]
v_exp_f32 v94, v94
v_add_f32 v14, v14, v92
v_exp_f32 v95, v95
s_waitcnt lgkmcnt(8)
v_mfma_f32_32x32x16_bf16 v[160:175], v[216:219], v[200:203], v[160:175]
v_add_f32 v14, v14, v93
v_cvt_pk_bf16_f32 v206, v92, v93
v_mfma_f32_32x32x16_bf16 v[176:191], v[220:223], v[200:203], v[176:191]
v_add_f32 v14, v14, v94
v_add_f32_e64 v14, v14, v95
v_cvt_pk_bf16_f32 v207, v94, v95
s_waitcnt lgkmcnt(0)
s_barrier
ds_read_b128 v[208:211], v2 offset:16384
ds_read_b128 v[212:215], v2 offset:24576
ds_read_b128 v[216:219], v3 offset:16384
v_mfma_f32_32x32x16_bf16 v[128:143], v[224:227], v[204:207], v[128:143]
ds_read_b128 v[220:223], v3 offset:24576
v_max3_f32 v15, v96, v97, v98
v_max3_f32 v16, v111, v112, v113
v_max3_f32 v15, v15, v99, v100
v_max3_f32 v16, v16, v114, v115
v_mfma_f32_32x32x16_bf16 v[144:159], v[228:231], v[204:207], v[144:159]
ds_read_b128 v[224:227], v4 offset:16384
v_max3_f32 v15, v15, v101, v102
v_max3_f32 v16, v16, v116, v117
v_max3_f32 v15, v15, v103, v104
v_max3_f32 v16, v16, v118, v119
v_max3_f32 v15, v15, v105, v106
v_mfma_f32_32x32x16_bf16 v[160:175], v[232:235], v[204:207], v[160:175]
ds_read_b128 v[228:231], v4 offset:24576
v_max3_f32 v16, v16, v120, v121
v_max3_f32 v15, v15, v107, v108
v_max3_f32 v16, v16, v122, v123
v_max3_f32 v15, v15, v109, v110
v_max3_f32 v16, v16, v124, v125
v_mfma_f32_32x32x16_bf16 v[176:191], v[236:239], v[204:207], v[176:191]
ds_read_b128 v[232:235], v5 offset:16384
v_max3_f32 v15, v15, v126, v127
v_max_f32 v15, v15, v16
v_mov_b32 v16, v15
s_nop 1
v_permlane32_swap_b32 v15, v16
v_max_f32 v15, v15, v16
v_cmp_lt_f32 vcc, 0x41000000, v15
s_nop 4
s_cbranch_vccnz LX8
LB9:
s_waitcnt lgkmcnt(5)
v_mfma_f32_32x32x16_bf16 v[64:79], v[208:211], v[32:35], v[240:255]
ds_read_b128 v[236:239], v5 offset:24576
v_exp_f32 v96, v96
v_exp_f32 v97, v97
v_exp_f32 v98, v98
v_mfma_f32_32x32x16_bf16 v[80:95], v[212:215], v[32:35], v[240:255]
ds_read_b128 v[208:211], v6 offset:16384
v_add_f32 v14, v14, v96
v_exp_f32 v99, v99
v_add_f32 v14, v14, v97
s_waitcnt lgkmcnt(5)
v_mfma_f32_32x32x16_bf16 v[64:79], v[216:219], v[36:39], v[64:79]
ds_read_b128 v[212:215], v6 offset:24576
v_cvt_pk_bf16_f32 v192, v96, v97
v_exp_f32 v100, v100
v_add_f32 v14, v14, v98
v_exp_f32 v101, v101
v_mfma_f32_32x32x16_bf16 v[80:95], v[220:223], v[36:39], v[80:95]
ds_read_b128 v[216:219], v7 offset:16384
v_add_f32_e64 v14, v14, v99
v_cvt_pk_bf16_f32 v193, v98, v99
v_exp_f32 v102, v102
s_waitcnt lgkmcnt(5)
v_mfma_f32_32x32x16_bf16 v[64:79], v[224:227], v[40:43], v[64:79]
ds_read_b128 v[220:223], v7 offset:24576
v_add_f32 v14, v14, v100
v_exp_f32 v103, v103
v_add_f32_e64 v14, v14, v101
v_mfma_f32_32x32x16_bf16 v[80:95], v[228:231], v[40:43], v[80:95]
ds_read_b128 v[224:227], v8 offset:16384
v_cvt_pk_bf16_f32 v194, v100, v101
v_exp_f32 v104, v104
v_add_f32 v14, v14, v102
v_exp_f32 v105, v105
s_waitcnt lgkmcnt(5)
v_mfma_f32_32x32x16_bf16 v[64:79], v[232:235], v[44:47], v[64:79]
ds_read_b128 v[228:231], v8 offset:24576
v_add_f32 v14, v14, v103
v_cvt_pk_bf16_f32 v195, v102, v103
v_exp_f32 v106, v106
v_mfma_f32_32x32x16_bf16 v[80:95], v[236:239], v[44:47], v[80:95]
ds_read_b128 v[232:235], v9 offset:16384
v_add_f32 v14, v14, v104
v_exp_f32 v107, v107
v_add_f32 v14, v14, v105
s_waitcnt lgkmcnt(5)
v_mfma_f32_32x32x16_bf16 v[64:79], v[208:211], v[48:51], v[64:79]
ds_read_b128 v[236:239], v9 offset:24576
v_cvt_pk_bf16_f32 v196, v104, v105
v_exp_f32 v108, v108
v_add_f32 v14, v14, v106
v_exp_f32_e64 v109, v109
v_mfma_f32_32x32x16_bf16 v[80:95], v[212:215], v[48:51], v[80:95]
v_add_f32 v14, v14, v107
v_cvt_pk_bf16_f32 v197, v106, v107
v_exp_f32 v110, v110
s_waitcnt lgkmcnt(4)
v_mfma_f32_32x32x16_bf16 v[64:79], v[216:219], v[52:55], v[64:79]
v_add_f32 v14, v14, v108
v_exp_f32 v111, v111
v_add_f32 v14, v14, v109
v_mfma_f32_32x32x16_bf16 v[80:95], v[220:223], v[52:55], v[80:95]
v_cvt_pk_bf16_f32 v198, v108, v109
v_add_f32 v14, v14, v110
v_add_f32 v14, v14, v111
v_cvt_pk_bf16_f32 v199, v110, v111
s_waitcnt lgkmcnt(0)
s_barrier
ds_read_b64_tr_b16 v[208:209], v10 offset:0
ds_read_b64_tr_b16 v[210:211], v10 offset:2048
ds_read_b64_tr_b16 v[212:213], v11 offset:0
ds_read_b64_tr_b16 v[214:215], v11 offset:2048
ds_read_b64_tr_b16 v[216:217], v12 offset:0
ds_read_b64_tr_b16 v[218:219], v12 offset:2048
v_mfma_f32_32x32x16_bf16 v[64:79], v[224:227], v[56:59], v[64:79]
ds_read_b64_tr_b16 v[220:221], v13 offset:0
ds_read_b64_tr_b16 v[222:223], v13 offset:2048
v_exp_f32 v112, v112
v_exp_f32 v113, v113
v_mfma_f32_32x32x16_bf16 v[80:95], v[228:231], v[56:59], v[80:95]
ds_read_b64_tr_b16 v[224:225], v10 offset:4096
ds_read_b64_tr_b16 v[226:227], v10 offset:6144
v_exp_f32 v114, v114
v_add_f32 v14, v14, v112
v_exp_f32 v115, v115
v_mfma_f32_32x32x16_bf16 v[64:79], v[232:235], v[60:63], v[64:79]
ds_read_b64_tr_b16 v[228:229], v11 offset:4096
ds_read_b64_tr_b16 v[230:231], v11 offset:6144
v_add_f32 v14, v14, v113
v_cvt_pk_bf16_f32 v200, v112, v113
v_mfma_f32_32x32x16_bf16 v[80:95], v[236:239], v[60:63], v[80:95]
ds_read_b64_tr_b16 v[232:233], v12 offset:4096
ds_read_b64_tr_b16 v[234:235], v12 offset:6144
v_exp_f32 v116, v116
v_add_f32 v14, v14, v114
v_exp_f32 v117, v117
s_waitcnt lgkmcnt(10)
v_mfma_f32_32x32x16_bf16 v[128:143], v[208:211], v[192:195], v[128:143]
ds_read_b64_tr_b16 v[236:237], v13 offset:4096
ds_read_b64_tr_b16 v[238:239], v13 offset:6144
v_add_f32_e64 v14, v14, v115
v_cvt_pk_bf16_f32 v201, v114, v115
v_mfma_f32_32x32x16_bf16 v[144:159], v[212:215], v[192:195], v[144:159]
ds_read_b64_tr_b16 v[208:209], v10 offset:8192
ds_read_b64_tr_b16 v[210:211], v10 offset:10240
v_exp_f32 v118, v118
v_add_f32 v14, v14, v116
v_exp_f32 v119, v119
s_waitcnt lgkmcnt(10)
v_mfma_f32_32x32x16_bf16 v[160:175], v[216:219], v[192:195], v[160:175]
ds_read_b64_tr_b16 v[212:213], v11 offset:8192
ds_read_b64_tr_b16 v[214:215], v11 offset:10240
v_add_f32 v14, v14, v117
v_cvt_pk_bf16_f32 v202, v116, v117
v_mfma_f32_32x32x16_bf16 v[176:191], v[220:223], v[192:195], v[176:191]
ds_read_b64_tr_b16 v[216:217], v12 offset:8192
ds_read_b64_tr_b16 v[218:219], v12 offset:10240
v_exp_f32 v120, v120
v_add_f32 v14, v14, v118
v_exp_f32_e64 v121, v121
s_waitcnt lgkmcnt(10)
v_mfma_f32_32x32x16_bf16 v[128:143], v[224:227], v[196:199], v[128:143]
ds_read_b64_tr_b16 v[220:221], v13 offset:8192
ds_read_b64_tr_b16 v[222:223], v13 offset:10240
v_add_f32 v14, v14, v119
v_cvt_pk_bf16_f32 v203, v118, v119
v_mfma_f32_32x32x16_bf16 v[144:159], v[228:231], v[196:199], v[144:159]
ds_read_b64_tr_b16 v[224:225], v10 offset:12288
ds_read_b64_tr_b16 v[226:227], v10 offset:14336
v_exp_f32 v122, v122
v_add_f32 v14, v14, v120
v_exp_f32 v123, v123
s_waitcnt lgkmcnt(10)
v_mfma_f32_32x32x16_bf16 v[160:175], v[232:235], v[196:199], v[160:175]
ds_read_b64_tr_b16 v[228:229], v11 offset:12288
ds_read_b64_tr_b16 v[230:231], v11 offset:14336
v_add_f32 v14, v14, v121
v_cvt_pk_bf16_f32 v204, v120, v121
v_mfma_f32_32x32x16_bf16 v[176:191], v[236:239], v[196:199], v[176:191]
ds_read_b64_tr_b16 v[232:233], v12 offset:12288
ds_read_b64_tr_b16 v[234:235], v12 offset:14336
v_exp_f32 v124, v124
v_add_f32 v14, v14, v122
v_exp_f32 v125, v125
s_waitcnt lgkmcnt(10)
v_mfma_f32_32x32x16_bf16 v[128:143], v[208:211], v[200:203], v[128:143]
ds_read_b64_tr_b16 v[236:237], v13 offset:12288
ds_read_b64_tr_b16 v[238:239], v13 offset:14336
v_add_f32 v14, v14, v123
v_cvt_pk_bf16_f32 v205, v122, v123
v_mfma_f32_32x32x16_bf16 v[144:159], v[212:215], v[200:203], v[144:159]
v_exp_f32 v126, v126
v_add_f32 v14, v14, v124
v_exp_f32 v127, v127
s_waitcnt lgkmcnt(8)
v_mfma_f32_32x32x16_bf16 v[160:175], v[216:219], v[200:203], v[160:175]
v_add_f32 v14, v14, v125
v_cvt_pk_bf16_f32 v206, v124, v125
v_mfma_f32_32x32x16_bf16 v[176:191], v[220:223], v[200:203], v[176:191]
v_add_f32 v14, v14, v126
v_add_f32 v14, v14, v127
v_cvt_pk_bf16_f32 v207, v126, v127
s_waitcnt lgkmcnt(0)
s_barrier
ds_read_b128 v[208:211], v2 offset:32768
ds_read_b128 v[212:215], v2 offset:40960
ds_read_b128 v[216:219], v3 offset:32768
v_mfma_f32_32x32x16_bf16 v[128:143], v[224:227], v[204:207], v[128:143]
ds_read_b128 v[220:223], v3 offset:40960
v_max3_f32 v15, v64, v65, v66
v_max3_f32 v16, v79, v80, v81
v_max3_f32 v15, v15, v67, v68
v_max3_f32 v16, v16, v82, v83
v_mfma_f32_32x32x16_bf16 v[144:159], v[228:231], v[204:207], v[144:159]
ds_read_b128 v[224:227], v4 offset:32768
v_max3_f32 v15, v15, v69, v70
v_max3_f32 v16, v16, v84, v85
v_max3_f32 v15, v15, v71, v72
v_max3_f32 v16, v16, v86, v87
v_max3_f32 v15, v15, v73, v74
v_mfma_f32_32x32x16_bf16 v[160:175], v[232:235], v[204:207], v[160:175]
ds_read_b128 v[228:231], v4 offset:40960
v_max3_f32 v16, v16, v88, v89
v_max3_f32 v15, v15, v75, v76
v_max3_f32 v16, v16, v90, v91
v_max3_f32 v15, v15, v77, v78
v_max3_f32 v16, v16, v92, v93
v_mfma_f32_32x32x16_bf16 v[176:191], v[236:239], v[204:207], v[176:191]
ds_read_b128 v[232:235], v5 offset:32768
v_max3_f32 v15, v15, v94, v95
v_max_f32 v15, v15, v16
v_mov_b32 v16, v15
s_nop 1
v_permlane32_swap_b32 v15, v16
v_max_f32 v15, v15, v16
v_cmp_lt_f32 vcc, 0x41000000, v15
s_nop 4
s_cbranch_vccnz LX10
LB11:
s_waitcnt lgkmcnt(5)
v_mfma_f32_32x32x16_bf16 v[96:111], v[208:211], v[32:35], v[240:255]
ds_read_b128 v[236:239], v5 offset:40960
v_exp_f32 v64, v64
v_exp_f32 v65, v65
v_exp_f32 v66, v66
v_mfma_f32_32x32x16_bf16 v[112:127], v[212:215], v[32:35], v[240:255]
ds_read_b128 v[208:211], v6 offset:32768
v_add_f32 v14, v14, v64
v_exp_f32 v67, v67
v_add_f32_e64 v14, v14, v65
s_waitcnt lgkmcnt(5)
v_mfma_f32_32x32x16_bf16 v[96:111], v[216:219], v[36:39], v[96:111]
ds_read_b128 v[212:215], v6 offset:40960
v_cvt_pk_bf16_f32 v192, v64, v65
v_exp_f32 v68, v68
v_add_f32 v14, v14, v66
v_exp_f32 v69, v69
v_mfma_f32_32x32x16_bf16 v[112:127], v[220:223], v[36:39], v[112:127]
ds_read_b128 v[216:219], v7 offset:32768
v_add_f32 v14, v14, v67
v_cvt_pk_bf16_f32 v193, v66, v67
v_exp_f32 v70, v70
s_waitcnt lgkmcnt(5)
v_mfma_f32_32x32x16_bf16 v[96:111], v[224:227], v[40:43], v[96:111]
ds_read_b128 v[220:223], v7 offset:40960
v_add_f32 v14, v14, v68
v_exp_f32 v71, v71
v_add_f32 v14, v14, v69
v_mfma_f32_32x32x16_bf16 v[112:127], v[228:231], v[40:43], v[112:127]
ds_read_b128 v[224:227], v8 offset:32768
v_cvt_pk_bf16_f32 v194, v68, v69
v_exp_f32 v72, v72
v_add_f32 v14, v14, v70
v_exp_f32 v73, v73
s_waitcnt lgkmcnt(5)
v_mfma_f32_32x32x16_bf16 v[96:111], v[232:235], v[44:47], v[96:111]
ds_read_b128 v[228:231], v8 offset:40960
v_add_f32 v14, v14, v71
v_cvt_pk_bf16_f32 v195, v70, v71
v_exp_f32 v74, v74
v_mfma_f32_32x32x16_bf16 v[112:127], v[236:239], v[44:47], v[112:127]
ds_read_b128 v[232:235], v9 offset:32768
v_add_f32 v14, v14, v72
v_exp_f32 v75, v75
v_add_f32 v14, v14, v73
s_waitcnt lgkmcnt(5)
v_mfma_f32_32x32x16_bf16 v[96:111], v[208:211], v[48:51], v[96:111]
ds_read_b128 v[236:239], v9 offset:40960
v_cvt_pk_bf16_f32 v196, v72, v73
v_exp_f32 v76, v76
v_add_f32 v14, v14, v74
v_exp_f32 v77, v77
v_mfma_f32_32x32x16_bf16 v[112:127], v[212:215], v[48:51], v[112:127]
v_add_f32 v14, v14, v75
v_cvt_pk_bf16_f32 v197, v74, v75
v_exp_f32 v78, v78
s_waitcnt lgkmcnt(4)
v_mfma_f32_32x32x16_bf16 v[96:111], v[216:219], v[52:55], v[96:111]
v_add_f32 v14, v14, v76
v_exp_f32 v79, v79
v_add_f32 v14, v14, v77
v_mfma_f32_32x32x16_bf16 v[112:127], v[220:223], v[52:55], v[112:127]
v_cvt_pk_bf16_f32 v198, v76, v77
v_add_f32 v14, v14, v78
v_add_f32 v14, v14, v79
v_cvt_pk_bf16_f32 v199, v78, v79
s_waitcnt lgkmcnt(0)
s_barrier
ds_read_b64_tr_b16 v[208:209], v10 offset:16384
ds_read_b64_tr_b16 v[210:211], v10 offset:18432
ds_read_b64_tr_b16 v[212:213], v11 offset:16384
ds_read_b64_tr_b16 v[214:215], v11 offset:18432
ds_read_b64_tr_b16 v[216:217], v12 offset:16384
ds_read_b64_tr_b16 v[218:219], v12 offset:18432
v_mfma_f32_32x32x16_bf16 v[96:111], v[224:227], v[56:59], v[96:111]
ds_read_b64_tr_b16 v[220:221], v13 offset:16384
ds_read_b64_tr_b16 v[222:223], v13 offset:18432
v_exp_f32 v80, v80
v_exp_f32 v81, v81
v_mfma_f32_32x32x16_bf16 v[112:127], v[228:231], v[56:59], v[112:127]
ds_read_b64_tr_b16 v[224:225], v10 offset:20480
ds_read_b64_tr_b16 v[226:227], v10 offset:22528
v_exp_f32 v82, v82
v_add_f32 v14, v14, v80
v_exp_f32_e64 v83, v83
v_mfma_f32_32x32x16_bf16 v[96:111], v[232:235], v[60:63], v[96:111]
ds_read_b64_tr_b16 v[228:229], v11 offset:20480
ds_read_b64_tr_b16 v[230:231], v11 offset:22528
v_add_f32 v14, v14, v81
v_cvt_pk_bf16_f32 v200, v80, v81
v_mfma_f32_32x32x16_bf16 v[112:127], v[236:239], v[60:63], v[112:127]
ds_read_b64_tr_b16 v[232:233], v12 offset:20480
ds_read_b64_tr_b16 v[234:235], v12 offset:22528
v_exp_f32 v84, v84
v_add_f32 v14, v14, v82
v_exp_f32 v85, v85
s_waitcnt lgkmcnt(10)
v_mfma_f32_32x32x16_bf16 v[128:143], v[208:211], v[192:195], v[128:143]
ds_read_b64_tr_b16 v[236:237], v13 offset:20480
ds_read_b64_tr_b16 v[238:239], v13 offset:22528
v_add_f32 v14, v14, v83
v_cvt_pk_bf16_f32 v201, v82, v83
v_mfma_f32_32x32x16_bf16 v[144:159], v[212:215], v[192:195], v[144:159]
ds_read_b64_tr_b16 v[208:209], v10 offset:24576
ds_read_b64_tr_b16 v[210:211], v10 offset:26624
v_exp_f32 v86, v86
v_add_f32 v14, v14, v84
v_exp_f32 v87, v87
s_waitcnt lgkmcnt(10)
v_mfma_f32_32x32x16_bf16 v[160:175], v[216:219], v[192:195], v[160:175]
ds_read_b64_tr_b16 v[212:213], v11 offset:24576
ds_read_b64_tr_b16 v[214:215], v11 offset:26624
v_add_f32_e64 v14, v14, v85
v_cvt_pk_bf16_f32 v202, v84, v85
v_mfma_f32_32x32x16_bf16 v[176:191], v[220:223], v[192:195], v[176:191]
ds_read_b64_tr_b16 v[216:217], v12 offset:24576
ds_read_b64_tr_b16 v[218:219], v12 offset:26624
v_exp_f32 v88, v88
v_add_f32 v14, v14, v86
v_exp_f32 v89, v89
s_waitcnt lgkmcnt(10)
v_mfma_f32_32x32x16_bf16 v[128:143], v[224:227], v[196:199], v[128:143]
ds_read_b64_tr_b16 v[220:221], v13 offset:24576
ds_read_b64_tr_b16 v[222:223], v13 offset:26624
v_add_f32_e64 v14, v14, v87
v_cvt_pk_bf16_f32 v203, v86, v87
v_mfma_f32_32x32x16_bf16 v[144:159], v[228:231], v[196:199], v[144:159]
ds_read_b64_tr_b16 v[224:225], v10 offset:28672
ds_read_b64_tr_b16 v[226:227], v10 offset:30720
v_exp_f32 v90, v90
v_add_f32 v14, v14, v88
v_exp_f32 v91, v91
s_waitcnt lgkmcnt(10)
v_mfma_f32_32x32x16_bf16 v[160:175], v[232:235], v[196:199], v[160:175]
ds_read_b64_tr_b16 v[228:229], v11 offset:28672
ds_read_b64_tr_b16 v[230:231], v11 offset:30720
v_add_f32 v14, v14, v89
v_cvt_pk_bf16_f32 v204, v88, v89
v_mfma_f32_32x32x16_bf16 v[176:191], v[236:239], v[196:199], v[176:191]
ds_read_b64_tr_b16 v[232:233], v12 offset:28672
ds_read_b64_tr_b16 v[234:235], v12 offset:30720
v_exp_f32 v92, v92
v_add_f32 v14, v14, v90
v_exp_f32_e64 v93, v93
s_waitcnt lgkmcnt(10)
v_mfma_f32_32x32x16_bf16 v[128:143], v[208:211], v[200:203], v[128:143]
ds_read_b64_tr_b16 v[236:237], v13 offset:28672
ds_read_b64_tr_b16 v[238:239], v13 offset:30720
v_add_f32 v14, v14, v91
v_cvt_pk_bf16_f32 v205, v90, v91
v_mfma_f32_32x32x16_bf16 v[144:159], v[212:215], v[200:203], v[144:159]
v_exp_f32 v94, v94
v_add_f32 v14, v14, v92
v_exp_f32_e64 v95, v95
s_waitcnt lgkmcnt(8)
v_mfma_f32_32x32x16_bf16 v[160:175], v[216:219], v[200:203], v[160:175]
v_add_f32 v14, v14, v93
v_cvt_pk_bf16_f32 v206, v92, v93
v_mfma_f32_32x32x16_bf16 v[176:191], v[220:223], v[200:203], v[176:191]
v_add_f32 v14, v14, v94
v_add_f32_e64 v14, v14, v95
v_cvt_pk_bf16_f32 v207, v94, v95
s_waitcnt lgkmcnt(0)
s_barrier
ds_read_b128 v[208:211], v2 offset:0
ds_read_b128 v[212:215], v2 offset:8192
ds_read_b128 v[216:219], v3 offset:0
v_mfma_f32_32x32x16_bf16 v[128:143], v[224:227], v[204:207], v[128:143]
ds_read_b128 v[220:223], v3 offset:8192
v_max3_f32 v15, v96, v97, v98
v_max3_f32 v16, v111, v112, v113
v_max3_f32 v15, v15, v99, v100
v_max3_f32 v16, v16, v114, v115
v_mfma_f32_32x32x16_bf16 v[144:159], v[228:231], v[204:207], v[144:159]
ds_read_b128 v[224:227], v4 offset:0
v_max3_f32 v15, v15, v101, v102
v_max3_f32 v16, v16, v116, v117
v_max3_f32 v15, v15, v103, v104
v_max3_f32 v16, v16, v118, v119
v_max3_f32 v15, v15, v105, v106
v_mfma_f32_32x32x16_bf16 v[160:175], v[232:235], v[204:207], v[160:175]
ds_read_b128 v[228:231], v4 offset:8192
v_max3_f32 v16, v16, v120, v121
v_max3_f32 v15, v15, v107, v108
v_max3_f32 v16, v16, v122, v123
v_max3_f32 v15, v15, v109, v110
v_max3_f32 v16, v16, v124, v125
v_mfma_f32_32x32x16_bf16 v[176:191], v[236:239], v[204:207], v[176:191]
ds_read_b128 v[232:235], v5 offset:0
v_max3_f32 v15, v15, v126, v127
v_max_f32 v15, v15, v16
v_mov_b32 v16, v15
s_nop 1
v_permlane32_swap_b32 v15, v16
v_max_f32 v15, v15, v16
v_cmp_lt_f32 vcc, 0x41000000, v15
s_nop 4
s_cbranch_vccnz LX12
LB13:
s_waitcnt lgkmcnt(5)
v_mfma_f32_32x32x16_bf16 v[64:79], v[208:211], v[32:35], v[240:255]
ds_read_b128 v[236:239], v5 offset:8192
v_exp_f32 v96, v96
v_exp_f32 v97, v97
v_exp_f32 v98, v98
v_mfma_f32_32x32x16_bf16 v[80:95], v[212:215], v[32:35], v[240:255]
ds_read_b128 v[208:211], v6 offset:0
v_add_f32 v14, v14, v96
v_exp_f32 v99, v99
v_add_f32_e64 v14, v14, v97
s_waitcnt lgkmcnt(5)
v_mfma_f32_32x32x16_bf16 v[64:79], v[216:219], v[36:39], v[64:79]
ds_read_b128 v[212:215], v6 offset:8192
v_cvt_pk_bf16_f32 v192, v96, v97
v_exp_f32 v100, v100
v_add_f32 v14, v14, v98
v_exp_f32 v101, v101
v_mfma_f32_32x32x16_bf16 v[80:95], v[220:223], v[36:39], v[80:95]
ds_read_b128 v[216:219], v7 offset:0
v_add_f32 v14, v14, v99
v_cvt_pk_bf16_f32 v193, v98, v99
v_exp_f32 v102, v102
s_waitcnt lgkmcnt(5)
v_mfma_f32_32x32x16_bf16 v[64:79], v[224:227], v[40:43], v[64:79]
ds_read_b128 v[220:223], v7 offset:8192
v_add_f32 v14, v14, v100
v_exp_f32 v103, v103
v_add_f32 v14, v14, v101
v_mfma_f32_32x32x16_bf16 v[80:95], v[228:231], v[40:43], v[80:95]
ds_read_b128 v[224:227], v8 offset:0
v_cvt_pk_bf16_f32 v194, v100, v101
v_exp_f32 v104, v104
v_add_f32 v14, v14, v102
v_exp_f32_e64 v105, v105
s_waitcnt lgkmcnt(5)
v_mfma_f32_32x32x16_bf16 v[64:79], v[232:235], v[44:47], v[64:79]
ds_read_b128 v[228:231], v8 offset:8192
v_add_f32 v14, v14, v103
v_cvt_pk_bf16_f32 v195, v102, v103
v_exp_f32 v106, v106
v_mfma_f32_32x32x16_bf16 v[80:95], v[236:239], v[44:47], v[80:95]
ds_read_b128 v[232:235], v9 offset:0
v_add_f32 v14, v14, v104
v_exp_f32 v107, v107
v_add_f32 v14, v14, v105
s_waitcnt lgkmcnt(5)
v_mfma_f32_32x32x16_bf16 v[64:79], v[208:211], v[48:51], v[64:79]
ds_read_b128 v[236:239], v9 offset:8192
v_cvt_pk_bf16_f32 v196, v104, v105
v_exp_f32 v108, v108
v_add_f32 v14, v14, v106
v_exp_f32 v109, v109
v_mfma_f32_32x32x16_bf16 v[80:95], v[212:215], v[48:51], v[80:95]
v_add_f32 v14, v14, v107
v_cvt_pk_bf16_f32 v197, v106, v107
v_exp_f32 v110, v110
s_waitcnt lgkmcnt(4)
v_mfma_f32_32x32x16_bf16 v[64:79], v[216:219], v[52:55], v[64:79]
v_add_f32 v14, v14, v108
v_exp_f32 v111, v111
v_add_f32 v14, v14, v109
v_mfma_f32_32x32x16_bf16 v[80:95], v[220:223], v[52:55], v[80:95]
v_cvt_pk_bf16_f32 v198, v108, v109
v_add_f32 v14, v14, v110
v_add_f32_e64 v14, v14, v111
v_cvt_pk_bf16_f32 v199, v110, v111
s_waitcnt lgkmcnt(0)
s_barrier
ds_read_b64_tr_b16 v[208:209], v10 offset:32768
ds_read_b64_tr_b16 v[210:211], v10 offset:34816
ds_read_b64_tr_b16 v[212:213], v11 offset:32768
ds_read_b64_tr_b16 v[214:215], v11 offset:34816
ds_read_b64_tr_b16 v[216:217], v12 offset:32768
ds_read_b64_tr_b16 v[218:219], v12 offset:34816
v_mfma_f32_32x32x16_bf16 v[64:79], v[224:227], v[56:59], v[64:79]
ds_read_b64_tr_b16 v[220:221], v13 offset:32768
ds_read_b64_tr_b16 v[222:223], v13 offset:34816
v_exp_f32 v112, v112
v_exp_f32 v113, v113
v_mfma_f32_32x32x16_bf16 v[80:95], v[228:231], v[56:59], v[80:95]
ds_read_b64_tr_b16 v[224:225], v10 offset:36864
ds_read_b64_tr_b16 v[226:227], v10 offset:38912
v_exp_f32 v114, v114
v_add_f32 v14, v14, v112
v_exp_f32_e64 v115, v115
v_mfma_f32_32x32x16_bf16 v[64:79], v[232:235], v[60:63], v[64:79]
ds_read_b64_tr_b16 v[228:229], v11 offset:36864
ds_read_b64_tr_b16 v[230:231], v11 offset:38912
v_add_f32 v14, v14, v113
v_cvt_pk_bf16_f32 v200, v112, v113
v_mfma_f32_32x32x16_bf16 v[80:95], v[236:239], v[60:63], v[80:95]
ds_read_b64_tr_b16 v[232:233], v12 offset:36864
ds_read_b64_tr_b16 v[234:235], v12 offset:38912
v_exp_f32 v116, v116
v_add_f32 v14, v14, v114
v_exp_f32 v117, v117
s_waitcnt lgkmcnt(10)
v_mfma_f32_32x32x16_bf16 v[128:143], v[208:211], v[192:195], v[128:143]
ds_read_b64_tr_b16 v[236:237], v13 offset:36864
ds_read_b64_tr_b16 v[238:239], v13 offset:38912
v_add_f32 v14, v14, v115
v_cvt_pk_bf16_f32 v201, v114, v115
v_mfma_f32_32x32x16_bf16 v[144:159], v[212:215], v[192:195], v[144:159]
ds_read_b64_tr_b16 v[208:209], v10 offset:40960
ds_read_b64_tr_b16 v[210:211], v10 offset:43008
v_exp_f32 v118, v118
v_add_f32 v14, v14, v116
v_exp_f32 v119, v119
s_waitcnt lgkmcnt(10)
v_mfma_f32_32x32x16_bf16 v[160:175], v[216:219], v[192:195], v[160:175]
ds_read_b64_tr_b16 v[212:213], v11 offset:40960
ds_read_b64_tr_b16 v[214:215], v11 offset:43008
v_add_f32_e64 v14, v14, v117
v_cvt_pk_bf16_f32 v202, v116, v117
v_mfma_f32_32x32x16_bf16 v[176:191], v[220:223], v[192:195], v[176:191]
ds_read_b64_tr_b16 v[216:217], v12 offset:40960
ds_read_b64_tr_b16 v[218:219], v12 offset:43008
v_exp_f32 v120, v120
v_add_f32 v14, v14, v118
v_exp_f32 v121, v121
s_waitcnt lgkmcnt(10)
v_mfma_f32_32x32x16_bf16 v[128:143], v[224:227], v[196:199], v[128:143]
ds_read_b64_tr_b16 v[220:221], v13 offset:40960
ds_read_b64_tr_b16 v[222:223], v13 offset:43008
v_add_f32_e64 v14, v14, v119
v_cvt_pk_bf16_f32 v203, v118, v119
v_mfma_f32_32x32x16_bf16 v[144:159], v[228:231], v[196:199], v[144:159]
ds_read_b64_tr_b16 v[224:225], v10 offset:45056
ds_read_b64_tr_b16 v[226:227], v10 offset:47104
v_exp_f32 v122, v122
v_add_f32 v14, v14, v120
v_exp_f32 v123, v123
s_waitcnt lgkmcnt(10)
v_mfma_f32_32x32x16_bf16 v[160:175], v[232:235], v[196:199], v[160:175]
ds_read_b64_tr_b16 v[228:229], v11 offset:45056
ds_read_b64_tr_b16 v[230:231], v11 offset:47104
v_add_f32 v14, v14, v121
v_cvt_pk_bf16_f32 v204, v120, v121
v_mfma_f32_32x32x16_bf16 v[176:191], v[236:239], v[196:199], v[176:191]
ds_read_b64_tr_b16 v[232:233], v12 offset:45056
ds_read_b64_tr_b16 v[234:235], v12 offset:47104
v_exp_f32 v124, v124
v_add_f32 v14, v14, v122
v_exp_f32_e64 v125, v125
s_waitcnt lgkmcnt(10)
v_mfma_f32_32x32x16_bf16 v[128:143], v[208:211], v[200:203], v[128:143]
ds_read_b64_tr_b16 v[236:237], v13 offset:45056
ds_read_b64_tr_b16 v[238:239], v13 offset:47104
v_add_f32 v14, v14, v123
v_cvt_pk_bf16_f32 v205, v122, v123
v_mfma_f32_32x32x16_bf16 v[144:159], v[212:215], v[200:203], v[144:159]
v_exp_f32 v126, v126
v_add_f32 v14, v14, v124
v_exp_f32_e64 v127, v127
s_waitcnt lgkmcnt(8)
v_mfma_f32_32x32x16_bf16 v[160:175], v[216:219], v[200:203], v[160:175]
v_add_f32 v14, v14, v125
v_cvt_pk_bf16_f32 v206, v124, v125
v_mfma_f32_32x32x16_bf16 v[176:191], v[220:223], v[200:203], v[176:191]
v_add_f32 v14, v14, v126
v_add_f32_e64 v14, v14, v127
v_cvt_pk_bf16_f32 v207, v126, v127
s_waitcnt lgkmcnt(0)
s_barrier
ds_read_b128 v[208:211], v2 offset:16384
ds_read_b128 v[212:215], v2 offset:24576
ds_read_b128 v[216:219], v3 offset:16384
v_mfma_f32_32x32x16_bf16 v[128:143], v[224:227], v[204:207], v[128:143]
ds_read_b128 v[220:223], v3 offset:24576
v_max3_f32 v15, v64, v65, v66
v_max3_f32 v16, v79, v80, v81
v_max3_f32 v15, v15, v67, v68
v_max3_f32 v16, v16, v82, v83
v_mfma_f32_32x32x16_bf16 v[144:159], v[228:231], v[204:207], v[144:159]
ds_read_b128 v[224:227], v4 offset:16384
v_max3_f32 v15, v15, v69, v70
v_max3_f32 v16, v16, v84, v85
v_max3_f32 v15, v15, v71, v72
v_max3_f32 v16, v16, v86, v87
v_max3_f32 v15, v15, v73, v74
v_mfma_f32_32x32x16_bf16 v[160:175], v[232:235], v[204:207], v[160:175]
ds_read_b128 v[228:231], v4 offset:24576
v_max3_f32 v16, v16, v88, v89
v_max3_f32 v15, v15, v75, v76
v_max3_f32 v16, v16, v90, v91
v_max3_f32 v15, v15, v77, v78
v_max3_f32 v16, v16, v92, v93
v_mfma_f32_32x32x16_bf16 v[176:191], v[236:239], v[204:207], v[176:191]
ds_read_b128 v[232:235], v5 offset:16384
v_max3_f32 v15, v15, v94, v95
v_max_f32 v15, v15, v16
v_mov_b32 v16, v15
s_nop 1
v_permlane32_swap_b32 v15, v16
v_max_f32 v15, v15, v16
v_cmp_lt_f32 vcc, 0x41000000, v15
s_nop 4
s_cbranch_vccnz LX14
LB15:
s_waitcnt lgkmcnt(5)
v_mfma_f32_32x32x16_bf16 v[96:111], v[208:211], v[32:35], v[240:255]
ds_read_b128 v[236:239], v5 offset:24576
v_exp_f32 v64, v64
v_exp_f32 v65, v65
v_exp_f32 v66, v66
v_mfma_f32_32x32x16_bf16 v[112:127], v[212:215], v[32:35], v[240:255]
ds_read_b128 v[208:211], v6 offset:16384
v_add_f32 v14, v14, v64
v_exp_f32 v67, v67
v_add_f32_e64 v14, v14, v65
s_waitcnt lgkmcnt(5)
v_mfma_f32_32x32x16_bf16 v[96:111], v[216:219], v[36:39], v[96:111]
ds_read_b128 v[212:215], v6 offset:24576
v_cvt_pk_bf16_f32 v192, v64, v65
v_exp_f32 v68, v68
v_add_f32 v14, v14, v66
v_exp_f32 v69, v69
v_mfma_f32_32x32x16_bf16 v[112:127], v[220:223], v[36:39], v[112:127]
ds_read_b128 v[216:219], v7 offset:16384
v_add_f32 v14, v14, v67
v_cvt_pk_bf16_f32 v193, v66, v67
v_exp_f32 v70, v70
s_waitcnt lgkmcnt(5)
v_mfma_f32_32x32x16_bf16 v[96:111], v[224:227], v[40:43], v[96:111]
ds_read_b128 v[220:223], v7 offset:24576
v_add_f32 v14, v14, v68
v_exp_f32 v71, v71
v_add_f32 v14, v14, v69
v_mfma_f32_32x32x16_bf16 v[112:127], v[228:231], v[40:43], v[112:127]
ds_read_b128 v[224:227], v8 offset:16384
v_cvt_pk_bf16_f32 v194, v68, v69
v_exp_f32 v72, v72
v_add_f32 v14, v14, v70
v_exp_f32_e64 v73, v73
s_waitcnt lgkmcnt(5)
v_mfma_f32_32x32x16_bf16 v[96:111], v[232:235], v[44:47], v[96:111]
ds_read_b128 v[228:231], v8 offset:24576
v_add_f32 v14, v14, v71
v_cvt_pk_bf16_f32 v195, v70, v71
v_exp_f32 v74, v74
v_mfma_f32_32x32x16_bf16 v[112:127], v[236:239], v[44:47], v[112:127]
ds_read_b128 v[232:235], v9 offset:16384
v_add_f32 v14, v14, v72
v_exp_f32 v75, v75
v_add_f32 v14, v14, v73
s_waitcnt lgkmcnt(5)
v_mfma_f32_32x32x16_bf16 v[96:111], v[208:211], v[48:51], v[96:111]
ds_read_b128 v[236:239], v9 offset:24576
v_cvt_pk_bf16_f32 v196, v72, v73
v_exp_f32 v76, v76
v_add_f32 v14, v14, v74
v_exp_f32 v77, v77
v_mfma_f32_32x32x16_bf16 v[112:127], v[212:215], v[48:51], v[112:127]
v_add_f32 v14, v14, v75
v_cvt_pk_bf16_f32 v197, v74, v75
v_exp_f32 v78, v78
s_waitcnt lgkmcnt(4)
v_mfma_f32_32x32x16_bf16 v[96:111], v[216:219], v[52:55], v[96:111]
v_add_f32 v14, v14, v76
v_exp_f32 v79, v79
v_add_f32 v14, v14, v77
v_mfma_f32_32x32x16_bf16 v[112:127], v[220:223], v[52:55], v[112:127]
v_cvt_pk_bf16_f32 v198, v76, v77
v_add_f32 v14, v14, v78
v_add_f32_e64 v14, v14, v79
v_cvt_pk_bf16_f32 v199, v78, v79
s_waitcnt lgkmcnt(0)
s_barrier
ds_read_b64_tr_b16 v[208:209], v10 offset:0
ds_read_b64_tr_b16 v[210:211], v10 offset:2048
ds_read_b64_tr_b16 v[212:213], v11 offset:0
ds_read_b64_tr_b16 v[214:215], v11 offset:2048
ds_read_b64_tr_b16 v[216:217], v12 offset:0
ds_read_b64_tr_b16 v[218:219], v12 offset:2048
v_mfma_f32_32x32x16_bf16 v[96:111], v[224:227], v[56:59], v[96:111]
ds_read_b64_tr_b16 v[220:221], v13 offset:0
ds_read_b64_tr_b16 v[222:223], v13 offset:2048
v_exp_f32 v80, v80
v_exp_f32 v81, v81
v_mfma_f32_32x32x16_bf16 v[112:127], v[228:231], v[56:59], v[112:127]
ds_read_b64_tr_b16 v[224:225], v10 offset:4096
ds_read_b64_tr_b16 v[226:227], v10 offset:6144
v_exp_f32 v82, v82
v_add_f32 v14, v14, v80
v_exp_f32_e64 v83, v83
v_mfma_f32_32x32x16_bf16 v[96:111], v[232:235], v[60:63], v[96:111]
ds_read_b64_tr_b16 v[228:229], v11 offset:4096
ds_read_b64_tr_b16 v[230:231], v11 offset:6144
v_add_f32 v14, v14, v81
v_cvt_pk_bf16_f32 v200, v80, v81
v_mfma_f32_32x32x16_bf16 v[112:127], v[236:239], v[60:63], v[112:127]
ds_read_b64_tr_b16 v[232:233], v12 offset:4096
ds_read_b64_tr_b16 v[234:235], v12 offset:6144
v_exp_f32 v84, v84
v_add_f32 v14, v14, v82
v_exp_f32 v85, v85
ds_read_b128 v[32:35], v20 offset:32768
ds_read_b128 v[36:39], v20 offset:33792
ds_read_b128 v[40:43], v20 offset:34816
ds_read_b128 v[44:47], v20 offset:35840
ds_read_b128 v[48:51], v20 offset:36864
ds_read_b128 v[52:55], v20 offset:37888
ds_read_b128 v[56:59], v20 offset:38912
ds_read_b128 v[60:63], v20 offset:39936
s_waitcnt lgkmcnt(14)
v_mfma_f32_32x32x16_bf16 v[128:143], v[208:211], v[192:195], v[128:143]
ds_read_b64_tr_b16 v[236:237], v13 offset:4096
ds_read_b64_tr_b16 v[238:239], v13 offset:6144
v_add_f32 v14, v14, v83
v_cvt_pk_bf16_f32 v201, v82, v83
v_mfma_f32_32x32x16_bf16 v[144:159], v[212:215], v[192:195], v[144:159]
ds_read_b64_tr_b16 v[208:209], v10 offset:8192
ds_read_b64_tr_b16 v[210:211], v10 offset:10240
v_exp_f32 v86, v86
v_add_f32 v14, v14, v84
v_exp_f32 v87, v87
v_mfma_f32_32x32x16_bf16 v[160:175], v[216:219], v[192:195], v[160:175]
ds_read_b64_tr_b16 v[212:213], v11 offset:8192
ds_read_b64_tr_b16 v[214:215], v11 offset:10240
v_add_f32 v14, v14, v85
v_cvt_pk_bf16_f32 v202, v84, v85
v_mfma_f32_32x32x16_bf16 v[176:191], v[220:223], v[192:195], v[176:191]
ds_read_b64_tr_b16 v[216:217], v12 offset:8192
ds_read_b64_tr_b16 v[218:219], v12 offset:10240
v_exp_f32 v88, v88
v_add_f32 v14, v14, v86
v_exp_f32 v89, v89
s_waitcnt lgkmcnt(14)
v_mfma_f32_32x32x16_bf16 v[128:143], v[224:227], v[196:199], v[128:143]
ds_read_b64_tr_b16 v[220:221], v13 offset:8192
ds_read_b64_tr_b16 v[222:223], v13 offset:10240
v_add_f32_e64 v14, v14, v87
v_cvt_pk_bf16_f32 v203, v86, v87
v_mfma_f32_32x32x16_bf16 v[144:159], v[228:231], v[196:199], v[144:159]
ds_read_b64_tr_b16 v[224:225], v10 offset:12288
ds_read_b64_tr_b16 v[226:227], v10 offset:14336
v_exp_f32 v90, v90
v_add_f32 v14, v14, v88
v_exp_f32 v91, v91
v_mfma_f32_32x32x16_bf16 v[160:175], v[232:235], v[196:199], v[160:175]
ds_read_b64_tr_b16 v[228:229], v11 offset:12288
ds_read_b64_tr_b16 v[230:231], v11 offset:14336
v_add_f32 v14, v14, v89
v_cvt_pk_bf16_f32 v204, v88, v89
s_waitcnt lgkmcnt(10)
v_mfma_f32_32x32x16_bf16 v[176:191], v[236:239], v[196:199], v[176:191]
ds_read_b64_tr_b16 v[232:233], v12 offset:12288
ds_read_b64_tr_b16 v[234:235], v12 offset:14336
v_exp_f32 v92, v92
v_add_f32 v14, v14, v90
v_exp_f32 v93, v93
v_mfma_f32_32x32x16_bf16 v[128:143], v[208:211], v[200:203], v[128:143]
ds_read_b64_tr_b16 v[236:237], v13 offset:12288
ds_read_b64_tr_b16 v[238:239], v13 offset:14336
v_add_f32 v14, v14, v91
v_cvt_pk_bf16_f32 v205, v90, v91
s_waitcnt lgkmcnt(10)
v_mfma_f32_32x32x16_bf16 v[144:159], v[212:215], v[200:203], v[144:159]
v_exp_f32 v94, v94
v_add_f32 v14, v14, v92
v_exp_f32 v95, v95
v_mfma_f32_32x32x16_bf16 v[160:175], v[216:219], v[200:203], v[160:175]
v_add_f32 v14, v14, v93
v_cvt_pk_bf16_f32 v206, v92, v93
s_waitcnt lgkmcnt(6)
v_mfma_f32_32x32x16_bf16 v[176:191], v[220:223], v[200:203], v[176:191]
v_add_f32 v14, v14, v94
v_add_f32_e64 v14, v14, v95
v_cvt_pk_bf16_f32 v207, v94, v95
s_waitcnt lgkmcnt(0)
s_barrier
ds_read_b128 v[208:211], v2 offset:32768
ds_read_b128 v[212:215], v2 offset:40960
ds_read_b128 v[216:219], v3 offset:32768
v_mfma_f32_32x32x16_bf16 v[128:143], v[224:227], v[204:207], v[128:143]
ds_read_b128 v[220:223], v3 offset:40960
v_max3_f32 v15, v96, v97, v98
v_max3_f32 v16, v111, v112, v113
v_max3_f32 v15, v15, v99, v100
v_max3_f32 v16, v16, v114, v115
v_mfma_f32_32x32x16_bf16 v[144:159], v[228:231], v[204:207], v[144:159]
ds_read_b128 v[224:227], v4 offset:32768
v_max3_f32 v15, v15, v101, v102
v_max3_f32 v16, v16, v116, v117
v_max3_f32 v15, v15, v103, v104
v_max3_f32 v16, v16, v118, v119
v_max3_f32 v15, v15, v105, v106
v_mfma_f32_32x32x16_bf16 v[160:175], v[232:235], v[204:207], v[160:175]
ds_read_b128 v[228:231], v4 offset:40960
v_max3_f32 v16, v16, v120, v121
v_max3_f32 v15, v15, v107, v108
v_max3_f32 v16, v16, v122, v123
v_max3_f32 v15, v15, v109, v110
v_max3_f32 v16, v16, v124, v125
v_mfma_f32_32x32x16_bf16 v[176:191], v[236:239], v[204:207], v[176:191]
ds_read_b128 v[232:235], v5 offset:32768
v_max3_f32 v15, v15, v126, v127
v_max_f32 v15, v15, v16
v_mov_b32 v16, v15
s_nop 1
v_permlane32_swap_b32 v15, v16
v_max_f32 v15, v15, v16
v_cmp_lt_f32 vcc, 0x41000000, v15
s_nop 4
s_cbranch_vccnz LX18
LB19:
s_waitcnt lgkmcnt(5)
v_mfma_f32_32x32x16_bf16 v[64:79], v[208:211], v[32:35], 0
ds_read_b128 v[236:239], v5 offset:40960
v_exp_f32 v96, v96
v_exp_f32 v97, v97
v_exp_f32_e64 v98, v98
v_mfma_f32_32x32x16_bf16 v[80:95], v[212:215], v[32:35], 0
ds_read_b128 v[208:211], v6 offset:32768
v_add_f32 v14, v14, v96
v_exp_f32 v99, v99
v_add_f32 v14, v14, v97
s_waitcnt lgkmcnt(5)
v_mfma_f32_32x32x16_bf16 v[64:79], v[216:219], v[36:39], v[64:79]
ds_read_b128 v[212:215], v6 offset:40960
v_cvt_pk_bf16_f32 v192, v96, v97
v_exp_f32 v100, v100
v_add_f32 v14, v14, v98
v_exp_f32 v101, v101
v_mfma_f32_32x32x16_bf16 v[80:95], v[220:223], v[36:39], v[80:95]
ds_read_b128 v[216:219], v7 offset:32768
v_add_f32 v14, v14, v99
v_cvt_pk_bf16_f32 v193, v98, v99
v_exp_f32 v102, v102
s_waitcnt lgkmcnt(5)
v_mfma_f32_32x32x16_bf16 v[64:79], v[224:227], v[40:43], v[64:79]
ds_read_b128 v[220:223], v7 offset:40960
v_add_f32 v14, v14, v100
v_exp_f32 v103, v103
v_add_f32 v14, v14, v101
v_mfma_f32_32x32x16_bf16 v[80:95], v[228:231], v[40:43], v[80:95]
ds_read_b128 v[224:227], v8 offset:32768
v_cvt_pk_bf16_f32 v194, v100, v101
v_exp_f32 v104, v104
v_add_f32 v14, v14, v102
v_exp_f32 v105, v105
s_waitcnt lgkmcnt(5)
v_mfma_f32_32x32x16_bf16 v[64:79], v[232:235], v[44:47], v[64:79]
ds_read_b128 v[228:231], v8 offset:40960
v_add_f32 v14, v14, v103
v_cvt_pk_bf16_f32 v195, v102, v103
v_exp_f32 v106, v106
v_mfma_f32_32x32x16_bf16 v[80:95], v[236:239], v[44:47], v[80:95]
ds_read_b128 v[232:235], v9 offset:32768
v_add_f32 v14, v14, v104
v_exp_f32 v107, v107
v_add_f32_e64 v14, v14, v105
s_waitcnt lgkmcnt(5)
v_mfma_f32_32x32x16_bf16 v[64:79], v[208:211], v[48:51], v[64:79]
ds_read_b128 v[236:239], v9 offset:40960
v_cvt_pk_bf16_f32 v196, v104, v105
v_exp_f32 v108, v108
v_add_f32 v14, v14, v106
v_exp_f32 v109, v109
v_mfma_f32_32x32x16_bf16 v[80:95], v[212:215], v[48:51], v[80:95]
v_add_f32 v14, v14, v107
v_cvt_pk_bf16_f32 v197, v106, v107
v_exp_f32 v110, v110
s_waitcnt lgkmcnt(4)
v_mfma_f32_32x32x16_bf16 v[64:79], v[216:219], v[52:55], v[64:79]
v_add_f32 v14, v14, v108
v_exp_f32 v111, v111
v_add_f32 v14, v14, v109
v_mfma_f32_32x32x16_bf16 v[80:95], v[220:223], v[52:55], v[80:95]
v_cvt_pk_bf16_f32 v198, v108, v109
v_add_f32 v14, v14, v110
v_add_f32_e64 v14, v14, v111
v_cvt_pk_bf16_f32 v199, v110, v111
s_waitcnt lgkmcnt(0)
s_barrier
ds_read_b64_tr_b16 v[208:209], v10 offset:16384
ds_read_b64_tr_b16 v[210:211], v10 offset:18432
ds_read_b64_tr_b16 v[212:213], v11 offset:16384
ds_read_b64_tr_b16 v[214:215], v11 offset:18432
ds_read_b64_tr_b16 v[216:217], v12 offset:16384
ds_read_b64_tr_b16 v[218:219], v12 offset:18432
v_mfma_f32_32x32x16_bf16 v[64:79], v[224:227], v[56:59], v[64:79]
ds_read_b64_tr_b16 v[220:221], v13 offset:16384
ds_read_b64_tr_b16 v[222:223], v13 offset:18432
v_exp_f32 v112, v112
v_exp_f32 v113, v113
v_mfma_f32_32x32x16_bf16 v[80:95], v[228:231], v[56:59], v[80:95]
ds_read_b64_tr_b16 v[224:225], v10 offset:20480
ds_read_b64_tr_b16 v[226:227], v10 offset:22528
v_exp_f32 v114, v114
v_add_f32 v14, v14, v112
v_exp_f32 v115, v115
v_mfma_f32_32x32x16_bf16 v[64:79], v[232:235], v[60:63], v[64:79]
ds_read_b64_tr_b16 v[228:229], v11 offset:20480
ds_read_b64_tr_b16 v[230:231], v11 offset:22528
v_add_f32 v14, v14, v113
v_cvt_pk_bf16_f32 v200, v112, v113
v_mfma_f32_32x32x16_bf16 v[80:95], v[236:239], v[60:63], v[80:95]
ds_read_b64_tr_b16 v[232:233], v12 offset:20480
ds_read_b64_tr_b16 v[234:235], v12 offset:22528
v_exp_f32 v116, v116
v_add_f32 v14, v14, v114
v_exp_f32 v117, v117
s_waitcnt lgkmcnt(10)
v_mfma_f32_32x32x16_bf16 v[128:143], v[208:211], v[192:195], v[128:143]
ds_read_b64_tr_b16 v[236:237], v13 offset:20480
ds_read_b64_tr_b16 v[238:239], v13 offset:22528
v_add_f32 v14, v14, v115
v_cvt_pk_bf16_f32 v201, v114, v115
v_mfma_f32_32x32x16_bf16 v[144:159], v[212:215], v[192:195], v[144:159]
ds_read_b64_tr_b16 v[208:209], v10 offset:24576
ds_read_b64_tr_b16 v[210:211], v10 offset:26624
v_exp_f32 v118, v118
v_add_f32 v14, v14, v116
v_exp_f32_e64 v119, v119
s_waitcnt lgkmcnt(10)
v_mfma_f32_32x32x16_bf16 v[160:175], v[216:219], v[192:195], v[160:175]
ds_read_b64_tr_b16 v[212:213], v11 offset:24576
ds_read_b64_tr_b16 v[214:215], v11 offset:26624
v_add_f32 v14, v14, v117
v_cvt_pk_bf16_f32 v202, v116, v117
v_mfma_f32_32x32x16_bf16 v[176:191], v[220:223], v[192:195], v[176:191]
ds_read_b64_tr_b16 v[216:217], v12 offset:24576
ds_read_b64_tr_b16 v[218:219], v12 offset:26624
v_exp_f32 v120, v120
v_add_f32 v14, v14, v118
v_exp_f32 v121, v121
s_waitcnt lgkmcnt(10)
v_mfma_f32_32x32x16_bf16 v[128:143], v[224:227], v[196:199], v[128:143]
ds_read_b64_tr_b16 v[220:221], v13 offset:24576
ds_read_b64_tr_b16 v[222:223], v13 offset:26624
v_add_f32 v14, v14, v119
v_cvt_pk_bf16_f32 v203, v118, v119
v_mfma_f32_32x32x16_bf16 v[144:159], v[228:231], v[196:199], v[144:159]
ds_read_b64_tr_b16 v[224:225], v10 offset:28672
ds_read_b64_tr_b16 v[226:227], v10 offset:30720
v_exp_f32 v122, v122
v_add_f32 v14, v14, v120
v_exp_f32 v123, v123
s_waitcnt lgkmcnt(10)
v_mfma_f32_32x32x16_bf16 v[160:175], v[232:235], v[196:199], v[160:175]
ds_read_b64_tr_b16 v[228:229], v11 offset:28672
ds_read_b64_tr_b16 v[230:231], v11 offset:30720
v_add_f32_e64 v14, v14, v121
v_cvt_pk_bf16_f32 v204, v120, v121
v_mfma_f32_32x32x16_bf16 v[176:191], v[236:239], v[196:199], v[176:191]
ds_read_b64_tr_b16 v[232:233], v12 offset:28672
ds_read_b64_tr_b16 v[234:235], v12 offset:30720
v_exp_f32 v124, v124
v_add_f32 v14, v14, v122
v_exp_f32 v125, v125
s_waitcnt lgkmcnt(10)
v_mfma_f32_32x32x16_bf16 v[128:143], v[208:211], v[200:203], v[128:143]
ds_read_b64_tr_b16 v[236:237], v13 offset:28672
ds_read_b64_tr_b16 v[238:239], v13 offset:30720
v_add_f32 v14, v14, v123
v_cvt_pk_bf16_f32 v205, v122, v123
v_mfma_f32_32x32x16_bf16 v[144:159], v[212:215], v[200:203], v[144:159]
v_exp_f32 v126, v126
v_add_f32 v14, v14, v124
v_exp_f32 v127, v127
s_waitcnt lgkmcnt(8)
v_mfma_f32_32x32x16_bf16 v[160:175], v[216:219], v[200:203], v[160:175]
v_add_f32 v14, v14, v125
v_cvt_pk_bf16_f32 v206, v124, v125
v_mfma_f32_32x32x16_bf16 v[176:191], v[220:223], v[200:203], v[176:191]
v_add_f32 v14, v14, v126
v_add_f32 v14, v14, v127
v_cvt_pk_bf16_f32 v207, v126, v127
s_waitcnt lgkmcnt(0)
s_barrier
ds_read_b128 v[208:211], v2 offset:0
ds_read_b128 v[212:215], v2 offset:8192
ds_read_b128 v[216:219], v3 offset:0
v_mfma_f32_32x32x16_bf16 v[128:143], v[224:227], v[204:207], v[128:143]
ds_read_b128 v[220:223], v3 offset:8192
v_max3_f32 v15, v64, v65, v66
v_max3_f32 v16, v79, v80, v81
v_max3_f32 v15, v15, v67, v68
v_max3_f32 v16, v16, v82, v83
v_mfma_f32_32x32x16_bf16 v[144:159], v[228:231], v[204:207], v[144:159]
ds_read_b128 v[224:227], v4 offset:0
v_max3_f32 v15, v15, v69, v70
v_max3_f32 v16, v16, v84, v85
v_max3_f32 v15, v15, v71, v72
v_max3_f32 v16, v16, v86, v87
v_max3_f32 v15, v15, v73, v74
v_mfma_f32_32x32x16_bf16 v[160:175], v[232:235], v[204:207], v[160:175]
ds_read_b128 v[228:231], v4 offset:8192
v_max3_f32 v16, v16, v88, v89
v_max3_f32 v15, v15, v75, v76
v_max3_f32 v16, v16, v90, v91
v_max3_f32 v15, v15, v77, v78
v_max3_f32 v16, v16, v92, v93
v_mfma_f32_32x32x16_bf16 v[176:191], v[236:239], v[204:207], v[176:191]
ds_read_b128 v[232:235], v5 offset:0
v_max3_f32 v15, v15, v94, v95
v_max_f32 v15, v15, v16
v_mov_b32 v16, v15
s_nop 1
v_permlane32_swap_b32 v15, v16
v_max_f32 v15, v15, v16
s_cmp_eq_u32 s58, 3
s_cselect_b32 vcc_lo, 0xffff, -1
s_cselect_b32 vcc_hi, 0xffff, -1
v_mov_b32 v17, 0x7149f2ca
v_cndmask_b32 v15, v17, v15, vcc
v_mul_f32 v240, -1.0, v15
v_mul_f32 v241, -1.0, v15
v_mul_f32 v242, -1.0, v15
v_mul_f32 v243, -1.0, v15
v_mul_f32 v244, -1.0, v15
v_mul_f32 v245, -1.0, v15
v_mul_f32 v246, -1.0, v15
v_mul_f32 v247, -1.0, v15
v_mul_f32 v248, -1.0, v15
v_mul_f32 v249, -1.0, v15
v_mul_f32 v250, -1.0, v15
v_mul_f32 v251, -1.0, v15
v_mul_f32 v252, -1.0, v15
v_mul_f32 v253, -1.0, v15
v_mul_f32 v254, -1.0, v15
v_mul_f32 v255, -1.0, v15
s_waitcnt lgkmcnt(5)
s_nop 0
v_mfma_f32_32x32x16_bf16 v[96:111], v[208:211], v[32:35], v[240:255]
ds_read_b128 v[236:239], v5 offset:8192
v_mov_b32 v17, v14
v_mov_b32 v18, v14
s_nop 1
v_permlane32_swap_b32 v17, v18
v_add_f32 v17, v17, v18
v_max_f32 v17, 0x0da24260, v17
v_rcp_f32 v18, v17
s_nop 0
v_mul_f32 v128, v128, v18
v_mul_f32 v129, v129, v18
v_mul_f32 v130, v130, v18
v_mul_f32 v131, v131, v18
v_mul_f32 v132, v132, v18
v_mul_f32 v133, v133, v18
v_mul_f32_e64 v134, v134, v18
v_mfma_f32_32x32x16_bf16 v[112:127], v[212:215], v[32:35], v[240:255]
ds_read_b128 v[208:211], v6 offset:0
v_mul_f32 v135, v135, v18
v_cvt_pk_bf16_f32 v128, v128, v129
v_cvt_pk_bf16_f32 v129, v130, v131
v_cvt_pk_bf16_f32 v130, v132, v133
v_cvt_pk_bf16_f32 v131, v134, v135
ds_write_b128 v20, v[128:131] offset:32768
v_mul_f32 v136, v136, v18
v_mul_f32 v137, v137, v18
v_mul_f32 v138, v138, v18
v_mul_f32 v139, v139, v18
v_mul_f32 v140, v140, v18
v_mul_f32 v141, v141, v18
v_mul_f32 v142, v142, v18
v_mul_f32 v143, v143, v18
s_waitcnt lgkmcnt(6)
v_mfma_f32_32x32x16_bf16 v[96:111], v[216:219], v[36:39], v[96:111]
ds_read_b128 v[212:215], v6 offset:8192
v_cvt_pk_bf16_f32 v136, v136, v137
v_cvt_pk_bf16_f32 v137, v138, v139
v_cvt_pk_bf16_f32 v138, v140, v141
v_cvt_pk_bf16_f32 v139, v142, v143
ds_write_b128 v20, v[136:139] offset:33792
v_mul_f32 v144, v144, v18
v_mul_f32 v145, v145, v18
v_mul_f32 v146, v146, v18
v_mul_f32 v147, v147, v18
v_mul_f32 v148, v148, v18
v_mul_f32 v149, v149, v18
v_mul_f32 v150, v150, v18
v_mul_f32 v151, v151, v18
v_cvt_pk_bf16_f32 v144, v144, v145
v_mfma_f32_32x32x16_bf16 v[112:127], v[220:223], v[36:39], v[112:127]
ds_read_b128 v[216:219], v7 offset:0
v_cvt_pk_bf16_f32 v145, v146, v147
v_cvt_pk_bf16_f32 v146, v148, v149
v_cvt_pk_bf16_f32 v147, v150, v151
ds_write_b128 v20, v[144:147] offset:34816
v_mul_f32 v152, v152, v18
v_mul_f32 v153, v153, v18
v_mul_f32 v154, v154, v18
v_mul_f32 v155, v155, v18
v_mul_f32 v156, v156, v18
v_mul_f32 v157, v157, v18
v_mul_f32 v158, v158, v18
v_mul_f32_e64 v159, v159, v18
v_cvt_pk_bf16_f32 v152, v152, v153
v_cvt_pk_bf16_f32 v153, v154, v155
s_waitcnt lgkmcnt(8)
v_mfma_f32_32x32x16_bf16 v[96:111], v[224:227], v[40:43], v[96:111]
ds_read_b128 v[220:223], v7 offset:8192
v_cvt_pk_bf16_f32 v154, v156, v157
v_cvt_pk_bf16_f32 v155, v158, v159
ds_write_b128 v20, v[152:155] offset:35840
v_mul_f32 v160, v160, v18
v_mul_f32 v161, v161, v18
v_mul_f32 v162, v162, v18
v_mul_f32 v163, v163, v18
v_mul_f32 v164, v164, v18
v_mul_f32 v165, v165, v18
v_mul_f32 v166, v166, v18
v_mul_f32 v167, v167, v18
v_cvt_pk_bf16_f32 v160, v160, v161
v_cvt_pk_bf16_f32 v161, v162, v163
v_cvt_pk_bf16_f32 v162, v164, v165
v_mfma_f32_32x32x16_bf16 v[112:127], v[228:231], v[40:43], v[112:127]
ds_read_b128 v[224:227], v8 offset:0
v_cvt_pk_bf16_f32 v163, v166, v167
ds_write_b128 v20, v[160:163] offset:36864
v_mul_f32 v168, v168, v18
v_mul_f32 v169, v169, v18
v_mul_f32 v170, v170, v18
v_mul_f32 v171, v171, v18
v_mul_f32 v172, v172, v18
v_mul_f32 v173, v173, v18
v_mul_f32 v174, v174, v18
v_mul_f32 v175, v175, v18
v_cvt_pk_bf16_f32 v168, v168, v169
v_cvt_pk_bf16_f32 v169, v170, v171
v_cvt_pk_bf16_f32 v170, v172, v173
v_cvt_pk_bf16_f32 v171, v174, v175
s_waitcnt lgkmcnt(10)
v_mfma_f32_32x32x16_bf16 v[96:111], v[232:235], v[44:47], v[96:111]
ds_read_b128 v[228:231], v8 offset:8192
ds_write_b128 v20, v[168:171] offset:37888
v_mul_f32 v176, v176, v18
v_mul_f32 v177, v177, v18
v_mul_f32 v178, v178, v18
v_mul_f32 v179, v179, v18
v_mul_f32 v180, v180, v18
v_mul_f32 v181, v181, v18
v_mul_f32 v182, v182, v18
v_mul_f32_e64 v183, v183, v18
v_cvt_pk_bf16_f32 v176, v176, v177
v_cvt_pk_bf16_f32 v177, v178, v179
v_cvt_pk_bf16_f32 v178, v180, v181
v_cvt_pk_bf16_f32 v179, v182, v183
v_mfma_f32_32x32x16_bf16 v[112:127], v[236:239], v[44:47], v[112:127]
ds_read_b128 v[232:235], v9 offset:0
ds_write_b128 v20, v[176:179] offset:38912
v_mul_f32 v184, v184, v18
v_mul_f32 v185, v185, v18
v_mul_f32 v186, v186, v18
v_mul_f32 v187, v187, v18
v_mul_f32 v188, v188, v18
v_mul_f32 v189, v189, v18
v_mul_f32 v190, v190, v18
v_mul_f32 v191, v191, v18
v_cvt_pk_bf16_f32 v184, v184, v185
v_cvt_pk_bf16_f32 v185, v186, v187
v_cvt_pk_bf16_f32 v186, v188, v189
v_cvt_pk_bf16_f32 v187, v190, v191
ds_write_b128 v20, v[184:187] offset:39936
s_waitcnt lgkmcnt(13)
v_mfma_f32_32x32x16_bf16 v[96:111], v[208:211], v[48:51], v[96:111]
ds_read_b128 v[236:239], v9 offset:8192
v_add_f32 v64, v64, v240
v_add_f32 v65, v65, v240
v_exp_f32 v64, v64
v_add_f32 v66, v66, v240
v_exp_f32 v65, v65
v_mov_b32 v14, v64
v_add_f32 v67, v67, v240
v_exp_f32 v66, v66
v_add_f32 v14, v14, v65
v_cvt_pk_bf16_f32 v192, v64, v65
v_add_f32 v68, v68, v240
v_exp_f32 v67, v67
v_add_f32 v14, v14, v66
v_add_f32 v69, v69, v240
s_waitcnt lgkmcnt(12)
v_mfma_f32_32x32x16_bf16 v[112:127], v[212:215], v[48:51], v[112:127]
v_exp_f32 v68, v68
v_add_f32 v14, v14, v67
v_cvt_pk_bf16_f32 v193, v66, v67
v_add_f32 v70, v70, v240
v_exp_f32 v69, v69
v_add_f32 v14, v14, v68
v_add_f32 v71, v71, v240
v_exp_f32 v70, v70
v_add_f32 v14, v14, v69
v_cvt_pk_bf16_f32 v194, v68, v69
v_add_f32 v72, v72, v240
v_exp_f32 v71, v71
v_add_f32 v14, v14, v70
v_add_f32 v73, v73, v240
s_waitcnt lgkmcnt(10)
v_mfma_f32_32x32x16_bf16 v[96:111], v[216:219], v[52:55], v[96:111]
v_exp_f32 v72, v72
v_add_f32 v14, v14, v71
v_cvt_pk_bf16_f32 v195, v70, v71
v_add_f32 v74, v74, v240
v_exp_f32 v73, v73
v_add_f32 v14, v14, v72
v_add_f32 v75, v75, v240
v_exp_f32 v74, v74
v_add_f32 v14, v14, v73
v_cvt_pk_bf16_f32 v196, v72, v73
v_add_f32 v76, v76, v240
v_exp_f32 v75, v75
v_add_f32 v14, v14, v74
v_add_f32 v77, v77, v240
s_waitcnt lgkmcnt(8)
v_mfma_f32_32x32x16_bf16 v[112:127], v[220:223], v[52:55], v[112:127]
v_exp_f32 v76, v76
v_add_f32 v14, v14, v75
v_cvt_pk_bf16_f32 v197, v74, v75
v_add_f32 v78, v78, v240
v_exp_f32 v77, v77
v_add_f32 v14, v14, v76
v_add_f32 v79, v79, v240
v_exp_f32 v78, v78
v_add_f32_e64 v14, v14, v77
v_cvt_pk_bf16_f32 v198, v76, v77
v_exp_f32 v79, v79
v_add_f32 v14, v14, v78
v_add_f32_e64 v14, v14, v79
v_cvt_pk_bf16_f32 v199, v78, v79
s_waitcnt lgkmcnt(0)
s_barrier
ds_read_b64_tr_b16 v[208:209], v10 offset:32768
ds_read_b64_tr_b16 v[210:211], v10 offset:34816
ds_read_b64_tr_b16 v[212:213], v11 offset:32768
ds_read_b64_tr_b16 v[214:215], v11 offset:34816
ds_read_b64_tr_b16 v[216:217], v12 offset:32768
ds_read_b64_tr_b16 v[218:219], v12 offset:34816
v_mfma_f32_32x32x16_bf16 v[96:111], v[224:227], v[56:59], v[96:111]
ds_read_b64_tr_b16 v[220:221], v13 offset:32768
ds_read_b64_tr_b16 v[222:223], v13 offset:34816
v_add_f32 v80, v80, v240
v_add_f32 v81, v81, v240
v_exp_f32_e64 v80, v80
v_mfma_f32_32x32x16_bf16 v[112:127], v[228:231], v[56:59], v[112:127]
ds_read_b64_tr_b16 v[224:225], v10 offset:36864
ds_read_b64_tr_b16 v[226:227], v10 offset:38912
v_add_f32 v82, v82, v240
v_exp_f32 v81, v81
v_add_f32 v14, v14, v80
v_add_f32 v83, v83, v240
v_mfma_f32_32x32x16_bf16 v[96:111], v[232:235], v[60:63], v[96:111]
ds_read_b64_tr_b16 v[228:229], v11 offset:36864
ds_read_b64_tr_b16 v[230:231], v11 offset:38912
v_exp_f32 v82, v82
v_add_f32 v14, v14, v81
v_cvt_pk_bf16_f32 v200, v80, v81
v_mfma_f32_32x32x16_bf16 v[112:127], v[236:239], v[60:63], v[112:127]
ds_read_b64_tr_b16 v[232:233], v12 offset:36864
ds_read_b64_tr_b16 v[234:235], v12 offset:38912
v_add_f32 v84, v84, v240
v_exp_f32 v83, v83
v_add_f32 v14, v14, v82
v_add_f32_e64 v85, v85, v240
s_waitcnt lgkmcnt(10)
v_mfma_f32_32x32x16_bf16 v[128:143], v[208:211], v[192:195], 0
ds_read_b64_tr_b16 v[236:237], v13 offset:36864
ds_read_b64_tr_b16 v[238:239], v13 offset:38912
v_exp_f32 v84, v84
v_add_f32 v14, v14, v83
v_cvt_pk_bf16_f32 v201, v82, v83
v_mfma_f32_32x32x16_bf16 v[144:159], v[212:215], v[192:195], 0
ds_read_b64_tr_b16 v[208:209], v10 offset:40960
ds_read_b64_tr_b16 v[210:211], v10 offset:43008
v_add_f32 v86, v86, v240
v_exp_f32 v85, v85
v_add_f32 v14, v14, v84
v_add_f32 v87, v87, v240
s_waitcnt lgkmcnt(10)
v_mfma_f32_32x32x16_bf16 v[160:175], v[216:219], v[192:195], 0
ds_read_b64_tr_b16 v[212:213], v11 offset:40960
ds_read_b64_tr_b16 v[214:215], v11 offset:43008
v_exp_f32 v86, v86
v_add_f32_e64 v14, v14, v85
v_cvt_pk_bf16_f32 v202, v84, v85
v_mfma_f32_32x32x16_bf16 v[176:191], v[220:223], v[192:195], 0
ds_read_b64_tr_b16 v[216:217], v12 offset:40960
ds_read_b64_tr_b16 v[218:219], v12 offset:43008
v_add_f32 v88, v88, v240
v_exp_f32 v87, v87
v_add_f32 v14, v14, v86
v_add_f32_e64 v89, v89, v240
s_waitcnt lgkmcnt(10)
v_mfma_f32_32x32x16_bf16 v[128:143], v[224:227], v[196:199], v[128:143]
ds_read_b64_tr_b16 v[220:221], v13 offset:40960
ds_read_b64_tr_b16 v[222:223], v13 offset:43008
v_exp_f32 v88, v88
v_add_f32 v14, v14, v87
v_cvt_pk_bf16_f32 v203, v86, v87
v_mfma_f32_32x32x16_bf16 v[144:159], v[228:231], v[196:199], v[144:159]
ds_read_b64_tr_b16 v[224:225], v10 offset:45056
ds_read_b64_tr_b16 v[226:227], v10 offset:47104
v_add_f32 v90, v90, v240
v_exp_f32 v89, v89
v_add_f32 v14, v14, v88
v_add_f32 v91, v91, v240
s_waitcnt lgkmcnt(10)
v_mfma_f32_32x32x16_bf16 v[160:175], v[232:235], v[196:199], v[160:175]
ds_read_b64_tr_b16 v[228:229], v11 offset:45056
ds_read_b64_tr_b16 v[230:231], v11 offset:47104
v_exp_f32 v90, v90
v_add_f32_e64 v14, v14, v89
v_cvt_pk_bf16_f32 v204, v88, v89
v_mfma_f32_32x32x16_bf16 v[176:191], v[236:239], v[196:199], v[176:191]
ds_read_b64_tr_b16 v[232:233], v12 offset:45056
ds_read_b64_tr_b16 v[234:235], v12 offset:47104
v_add_f32 v92, v92, v240
v_exp_f32 v91, v91
v_add_f32 v14, v14, v90
v_add_f32 v93, v93, v240
s_waitcnt lgkmcnt(10)
v_mfma_f32_32x32x16_bf16 v[128:143], v[208:211], v[200:203], v[128:143]
ds_read_b64_tr_b16 v[236:237], v13 offset:45056
ds_read_b64_tr_b16 v[238:239], v13 offset:47104
v_exp_f32 v92, v92
v_add_f32_e64 v14, v14, v91
v_cvt_pk_bf16_f32 v205, v90, v91
v_mfma_f32_32x32x16_bf16 v[144:159], v[212:215], v[200:203], v[144:159]
v_add_f32 v94, v94, v240
v_exp_f32 v93, v93
v_add_f32 v14, v14, v92
v_add_f32 v95, v95, v240
s_waitcnt lgkmcnt(8)
v_mfma_f32_32x32x16_bf16 v[160:175], v[216:219], v[200:203], v[160:175]
v_exp_f32 v94, v94
v_add_f32_e64 v14, v14, v93
v_cvt_pk_bf16_f32 v206, v92, v93
v_mfma_f32_32x32x16_bf16 v[176:191], v[220:223], v[200:203], v[176:191]
v_exp_f32 v95, v95
v_add_f32 v14, v14, v94
v_add_f32 v14, v14, v95
v_cvt_pk_bf16_f32 v207, v94, v95
s_waitcnt lgkmcnt(0)
s_barrier
v_lshlrev_b32 v17, 4, v1
s_and_b32 s52, s58, 1
s_lshl_b32 s52, s52, 13
s_lshr_b32 s53, s58, 1
s_mul_i32 s53, s53, 98304
s_add_u32 s52, s52, s53
s_add_u32 s52, s52, 49152
v_add_u32_e64 v20, s52, v17
ds_read_b128 v[208:211], v2 offset:16384
ds_read_b128 v[212:215], v2 offset:24576
ds_read_b128 v[216:219], v3 offset:16384
v_mfma_f32_32x32x16_bf16 v[128:143], v[224:227], v[204:207], v[128:143]
ds_read_b128 v[220:223], v3 offset:24576
v_max3_f32 v15, v96, v97, v98
v_max3_f32 v16, v111, v112, v113
v_max3_f32 v15, v15, v99, v100
v_max3_f32 v16, v16, v114, v115
v_mfma_f32_32x32x16_bf16 v[144:159], v[228:231], v[204:207], v[144:159]
ds_read_b128 v[224:227], v4 offset:16384
v_max3_f32 v15, v15, v101, v102
v_max3_f32 v16, v16, v116, v117
v_max3_f32 v15, v15, v103, v104
v_max3_f32 v16, v16, v118, v119
v_max3_f32 v15, v15, v105, v106
v_mfma_f32_32x32x16_bf16 v[160:175], v[232:235], v[204:207], v[160:175]
ds_read_b128 v[228:231], v4 offset:24576
v_max3_f32 v16, v16, v120, v121
v_max3_f32 v15, v15, v107, v108
v_max3_f32 v16, v16, v122, v123
v_max3_f32 v15, v15, v109, v110
v_max3_f32 v16, v16, v124, v125
v_mfma_f32_32x32x16_bf16 v[176:191], v[236:239], v[204:207], v[176:191]
ds_read_b128 v[232:235], v5 offset:16384
v_max3_f32 v15, v15, v126, v127
v_max_f32 v15, v15, v16
v_mov_b32 v16, v15
s_nop 1
v_permlane32_swap_b32 v15, v16
v_max_f32 v15, v15, v16
v_cmp_lt_f32 vcc, 0x41000000, v15
s_nop 4
s_cbranch_vccnz LX20
LB21:
s_waitcnt lgkmcnt(5)
v_mfma_f32_32x32x16_bf16 v[64:79], v[208:211], v[32:35], v[240:255]
ds_read_b128 v[236:239], v5 offset:24576
v_exp_f32 v96, v96
v_exp_f32 v97, v97
v_exp_f32 v98, v98
v_mfma_f32_32x32x16_bf16 v[80:95], v[212:215], v[32:35], v[240:255]
ds_read_b128 v[208:211], v6 offset:16384
v_add_f32 v14, v14, v96
v_exp_f32 v99, v99
v_add_f32 v14, v14, v97
s_waitcnt lgkmcnt(5)
v_mfma_f32_32x32x16_bf16 v[64:79], v[216:219], v[36:39], v[64:79]
ds_read_b128 v[212:215], v6 offset:24576
v_cvt_pk_bf16_f32 v192, v96, v97
v_exp_f32 v100, v100
v_add_f32 v14, v14, v98
v_exp_f32 v101, v101
v_mfma_f32_32x32x16_bf16 v[80:95], v[220:223], v[36:39], v[80:95]
ds_read_b128 v[216:219], v7 offset:16384
v_add_f32_e64 v14, v14, v99
v_cvt_pk_bf16_f32 v193, v98, v99
v_exp_f32 v102, v102
s_waitcnt lgkmcnt(5)
v_mfma_f32_32x32x16_bf16 v[64:79], v[224:227], v[40:43], v[64:79]
ds_read_b128 v[220:223], v7 offset:24576
v_add_f32 v14, v14, v100
v_exp_f32 v103, v103
v_add_f32_e64 v14, v14, v101
v_mfma_f32_32x32x16_bf16 v[80:95], v[228:231], v[40:43], v[80:95]
ds_read_b128 v[224:227], v8 offset:16384
v_cvt_pk_bf16_f32 v194, v100, v101
v_exp_f32 v104, v104
v_add_f32 v14, v14, v102
v_exp_f32 v105, v105
s_waitcnt lgkmcnt(5)
v_mfma_f32_32x32x16_bf16 v[64:79], v[232:235], v[44:47], v[64:79]
ds_read_b128 v[228:231], v8 offset:24576
v_add_f32 v14, v14, v103
v_cvt_pk_bf16_f32 v195, v102, v103
v_exp_f32 v106, v106
v_mfma_f32_32x32x16_bf16 v[80:95], v[236:239], v[44:47], v[80:95]
ds_read_b128 v[232:235], v9 offset:16384
v_add_f32 v14, v14, v104
v_exp_f32 v107, v107
v_add_f32 v14, v14, v105
s_waitcnt lgkmcnt(5)
v_mfma_f32_32x32x16_bf16 v[64:79], v[208:211], v[48:51], v[64:79]
ds_read_b128 v[236:239], v9 offset:24576
v_cvt_pk_bf16_f32 v196, v104, v105
v_exp_f32 v108, v108
v_add_f32 v14, v14, v106
v_exp_f32_e64 v109, v109
v_mfma_f32_32x32x16_bf16 v[80:95], v[212:215], v[48:51], v[80:95]
v_add_f32 v14, v14, v107
v_cvt_pk_bf16_f32 v197, v106, v107
v_exp_f32 v110, v110
s_waitcnt lgkmcnt(4)
v_mfma_f32_32x32x16_bf16 v[64:79], v[216:219], v[52:55], v[64:79]
v_add_f32 v14, v14, v108
v_exp_f32 v111, v111
v_add_f32 v14, v14, v109
v_mfma_f32_32x32x16_bf16 v[80:95], v[220:223], v[52:55], v[80:95]
v_cvt_pk_bf16_f32 v198, v108, v109
v_add_f32 v14, v14, v110
v_add_f32 v14, v14, v111
v_cvt_pk_bf16_f32 v199, v110, v111
s_waitcnt lgkmcnt(0)
s_barrier
v_and_b32 v26, 3, v1
v_lshlrev_b32_e64 v26, 16, v26
s_sub_u32 s53, s59, 16777216
s_lshr_b32 s53, s53, 2
s_andn2_b32 s53, s53, 0x30000
s_lshl_b32 s50, s54, 14
s_add_u32 s53, s53, s50
s_add_u32 s53, s53, 37750784
buffer_load_dword v24, v26, s[28:31], s53 offen sc1
ds_read_b64_tr_b16 v[208:209], v10 offset:0
ds_read_b64_tr_b16 v[210:211], v10 offset:2048
ds_read_b64_tr_b16 v[212:213], v11 offset:0
ds_read_b64_tr_b16 v[214:215], v11 offset:2048
ds_read_b64_tr_b16 v[216:217], v12 offset:0
ds_read_b64_tr_b16 v[218:219], v12 offset:2048
v_mfma_f32_32x32x16_bf16 v[64:79], v[224:227], v[56:59], v[64:79]
ds_read_b64_tr_b16 v[220:221], v13 offset:0
ds_read_b64_tr_b16 v[222:223], v13 offset:2048
v_exp_f32 v112, v112
v_exp_f32 v113, v113
v_mfma_f32_32x32x16_bf16 v[80:95], v[228:231], v[56:59], v[80:95]
ds_read_b64_tr_b16 v[224:225], v10 offset:4096
ds_read_b64_tr_b16 v[226:227], v10 offset:6144
v_exp_f32 v114, v114
v_add_f32 v14, v14, v112
v_exp_f32 v115, v115
v_mfma_f32_32x32x16_bf16 v[64:79], v[232:235], v[60:63], v[64:79]
ds_read_b64_tr_b16 v[228:229], v11 offset:4096
ds_read_b64_tr_b16 v[230:231], v11 offset:6144
v_add_f32 v14, v14, v113
v_cvt_pk_bf16_f32 v200, v112, v113
v_mfma_f32_32x32x16_bf16 v[80:95], v[236:239], v[60:63], v[80:95]
ds_read_b64_tr_b16 v[232:233], v12 offset:4096
ds_read_b64_tr_b16 v[234:235], v12 offset:6144
v_exp_f32 v116, v116
v_add_f32 v14, v14, v114
v_exp_f32 v117, v117
s_waitcnt lgkmcnt(10)
v_mfma_f32_32x32x16_bf16 v[128:143], v[208:211], v[192:195], v[128:143]
ds_read_b64_tr_b16 v[236:237], v13 offset:4096
ds_read_b64_tr_b16 v[238:239], v13 offset:6144
v_add_f32_e64 v14, v14, v115
v_cvt_pk_bf16_f32 v201, v114, v115
v_mfma_f32_32x32x16_bf16 v[144:159], v[212:215], v[192:195], v[144:159]
ds_read_b64_tr_b16 v[208:209], v10 offset:8192
ds_read_b64_tr_b16 v[210:211], v10 offset:10240
v_exp_f32 v118, v118
v_add_f32 v14, v14, v116
v_exp_f32 v119, v119
s_waitcnt lgkmcnt(10)
v_mfma_f32_32x32x16_bf16 v[160:175], v[216:219], v[192:195], v[160:175]
ds_read_b64_tr_b16 v[212:213], v11 offset:8192
ds_read_b64_tr_b16 v[214:215], v11 offset:10240
v_add_f32_e64 v14, v14, v117
v_cvt_pk_bf16_f32 v202, v116, v117
v_mfma_f32_32x32x16_bf16 v[176:191], v[220:223], v[192:195], v[176:191]
ds_read_b64_tr_b16 v[216:217], v12 offset:8192
ds_read_b64_tr_b16 v[218:219], v12 offset:10240
v_exp_f32 v120, v120
v_add_f32 v14, v14, v118
v_exp_f32 v121, v121
s_waitcnt lgkmcnt(10)
v_mfma_f32_32x32x16_bf16 v[128:143], v[224:227], v[196:199], v[128:143]
ds_read_b64_tr_b16 v[220:221], v13 offset:8192
ds_read_b64_tr_b16 v[222:223], v13 offset:10240
v_add_f32 v14, v14, v119
v_cvt_pk_bf16_f32 v203, v118, v119
v_mfma_f32_32x32x16_bf16 v[144:159], v[228:231], v[196:199], v[144:159]
ds_read_b64_tr_b16 v[224:225], v10 offset:12288
ds_read_b64_tr_b16 v[226:227], v10 offset:14336
v_exp_f32 v122, v122
v_add_f32 v14, v14, v120
v_exp_f32_e64 v123, v123
s_waitcnt lgkmcnt(10)
v_mfma_f32_32x32x16_bf16 v[160:175], v[232:235], v[196:199], v[160:175]
ds_read_b64_tr_b16 v[228:229], v11 offset:12288
ds_read_b64_tr_b16 v[230:231], v11 offset:14336
v_add_f32 v14, v14, v121
v_cvt_pk_bf16_f32 v204, v120, v121
v_mfma_f32_32x32x16_bf16 v[176:191], v[236:239], v[196:199], v[176:191]
ds_read_b64_tr_b16 v[232:233], v12 offset:12288
ds_read_b64_tr_b16 v[234:235], v12 offset:14336
v_exp_f32 v124, v124
v_add_f32 v14, v14, v122
v_exp_f32 v125, v125
s_waitcnt lgkmcnt(10)
v_mfma_f32_32x32x16_bf16 v[128:143], v[208:211], v[200:203], v[128:143]
ds_read_b64_tr_b16 v[236:237], v13 offset:12288
ds_read_b64_tr_b16 v[238:239], v13 offset:14336
v_add_f32 v14, v14, v123
v_cvt_pk_bf16_f32 v205, v122, v123
v_mfma_f32_32x32x16_bf16 v[144:159], v[212:215], v[200:203], v[144:159]
v_exp_f32 v126, v126
v_add_f32 v14, v14, v124
v_exp_f32 v127, v127
s_waitcnt lgkmcnt(8)
v_mfma_f32_32x32x16_bf16 v[160:175], v[216:219], v[200:203], v[160:175]
v_add_f32 v14, v14, v125
v_cvt_pk_bf16_f32 v206, v124, v125
v_mfma_f32_32x32x16_bf16 v[176:191], v[220:223], v[200:203], v[176:191]
v_add_f32 v14, v14, v126
v_add_f32_e64 v14, v14, v127
v_cvt_pk_bf16_f32 v207, v126, v127
s_waitcnt lgkmcnt(0)
s_barrier
ds_read_b128 v[208:211], v2 offset:32768
ds_read_b128 v[212:215], v2 offset:40960
ds_read_b128 v[216:219], v3 offset:32768
v_mfma_f32_32x32x16_bf16 v[128:143], v[224:227], v[204:207], v[128:143]
ds_read_b128 v[220:223], v3 offset:40960
v_max3_f32 v15, v64, v65, v66
v_max3_f32 v16, v79, v80, v81
v_max3_f32 v15, v15, v67, v68
v_max3_f32 v16, v16, v82, v83
v_mfma_f32_32x32x16_bf16 v[144:159], v[228:231], v[204:207], v[144:159]
ds_read_b128 v[224:227], v4 offset:32768
v_max3_f32 v15, v15, v69, v70
v_max3_f32 v16, v16, v84, v85
v_max3_f32 v15, v15, v71, v72
v_max3_f32 v16, v16, v86, v87
v_max3_f32 v15, v15, v73, v74
v_mfma_f32_32x32x16_bf16 v[160:175], v[232:235], v[204:207], v[160:175]
ds_read_b128 v[228:231], v4 offset:40960
v_max3_f32 v16, v16, v88, v89
v_max3_f32 v15, v15, v75, v76
v_max3_f32 v16, v16, v90, v91
v_max3_f32 v15, v15, v77, v78
v_max3_f32 v16, v16, v92, v93
v_mfma_f32_32x32x16_bf16 v[176:191], v[236:239], v[204:207], v[176:191]
ds_read_b128 v[232:235], v5 offset:32768
v_max3_f32 v15, v15, v94, v95
v_max_f32 v15, v15, v16
v_mov_b32 v16, v15
s_nop 1
v_permlane32_swap_b32 v15, v16
v_max_f32 v15, v15, v16
v_cmp_lt_f32 vcc, 0x41000000, v15
s_nop 4
s_cbranch_vccnz LX22
LB23:
s_waitcnt lgkmcnt(5)
v_mfma_f32_32x32x16_bf16 v[96:111], v[208:211], v[32:35], v[240:255]
ds_read_b128 v[236:239], v5 offset:40960
v_exp_f32 v64, v64
v_exp_f32 v65, v65
v_exp_f32 v66, v66
v_mfma_f32_32x32x16_bf16 v[112:127], v[212:215], v[32:35], v[240:255]
ds_read_b128 v[208:211], v6 offset:32768
v_add_f32 v14, v14, v64
v_exp_f32 v67, v67
v_add_f32_e64 v14, v14, v65
s_waitcnt lgkmcnt(5)
v_mfma_f32_32x32x16_bf16 v[96:111], v[216:219], v[36:39], v[96:111]
ds_read_b128 v[212:215], v6 offset:40960
v_cvt_pk_bf16_f32 v192, v64, v65
v_exp_f32 v68, v68
v_add_f32 v14, v14, v66
v_exp_f32 v69, v69
v_mfma_f32_32x32x16_bf16 v[112:127], v[220:223], v[36:39], v[112:127]
ds_read_b128 v[216:219], v7 offset:32768
v_add_f32 v14, v14, v67
v_cvt_pk_bf16_f32 v193, v66, v67
v_exp_f32 v70, v70
s_waitcnt lgkmcnt(5)
v_mfma_f32_32x32x16_bf16 v[96:111], v[224:227], v[40:43], v[96:111]
ds_read_b128 v[220:223], v7 offset:40960
v_add_f32 v14, v14, v68
v_exp_f32 v71, v71
v_add_f32 v14, v14, v69
v_mfma_f32_32x32x16_bf16 v[112:127], v[228:231], v[40:43], v[112:127]
ds_read_b128 v[224:227], v8 offset:32768
v_cvt_pk_bf16_f32 v194, v68, v69
v_exp_f32 v72, v72
v_add_f32 v14, v14, v70
v_exp_f32 v73, v73
s_waitcnt lgkmcnt(5)
v_mfma_f32_32x32x16_bf16 v[96:111], v[232:235], v[44:47], v[96:111]
ds_read_b128 v[228:231], v8 offset:40960
v_add_f32 v14, v14, v71
v_cvt_pk_bf16_f32 v195, v70, v71
v_exp_f32 v74, v74
v_mfma_f32_32x32x16_bf16 v[112:127], v[236:239], v[44:47], v[112:127]
ds_read_b128 v[232:235], v9 offset:32768
v_add_f32 v14, v14, v72
v_exp_f32 v75, v75
v_add_f32 v14, v14, v73
s_waitcnt lgkmcnt(5)
v_mfma_f32_32x32x16_bf16 v[96:111], v[208:211], v[48:51], v[96:111]
ds_read_b128 v[236:239], v9 offset:40960
v_cvt_pk_bf16_f32 v196, v72, v73
v_exp_f32 v76, v76
v_add_f32 v14, v14, v74
v_exp_f32 v77, v77
v_mfma_f32_32x32x16_bf16 v[112:127], v[212:215], v[48:51], v[112:127]
v_add_f32 v14, v14, v75
v_cvt_pk_bf16_f32 v197, v74, v75
v_exp_f32 v78, v78
s_waitcnt lgkmcnt(4)
v_mfma_f32_32x32x16_bf16 v[96:111], v[216:219], v[52:55], v[96:111]
v_add_f32 v14, v14, v76
v_exp_f32 v79, v79
v_add_f32 v14, v14, v77
v_mfma_f32_32x32x16_bf16 v[112:127], v[220:223], v[52:55], v[112:127]
v_cvt_pk_bf16_f32 v198, v76, v77
v_add_f32 v14, v14, v78
v_add_f32 v14, v14, v79
v_cvt_pk_bf16_f32 v199, v78, v79
s_waitcnt lgkmcnt(0)
s_barrier
ds_read_b64_tr_b16 v[208:209], v10 offset:16384
ds_read_b64_tr_b16 v[210:211], v10 offset:18432
ds_read_b64_tr_b16 v[212:213], v11 offset:16384
ds_read_b64_tr_b16 v[214:215], v11 offset:18432
ds_read_b64_tr_b16 v[216:217], v12 offset:16384
ds_read_b64_tr_b16 v[218:219], v12 offset:18432
v_mfma_f32_32x32x16_bf16 v[96:111], v[224:227], v[56:59], v[96:111]
ds_read_b64_tr_b16 v[220:221], v13 offset:16384
ds_read_b64_tr_b16 v[222:223], v13 offset:18432
v_exp_f32 v80, v80
v_exp_f32 v81, v81
v_mfma_f32_32x32x16_bf16 v[112:127], v[228:231], v[56:59], v[112:127]
ds_read_b64_tr_b16 v[224:225], v10 offset:20480
ds_read_b64_tr_b16 v[226:227], v10 offset:22528
v_exp_f32 v82, v82
v_add_f32 v14, v14, v80
v_exp_f32_e64 v83, v83
v_mfma_f32_32x32x16_bf16 v[96:111], v[232:235], v[60:63], v[96:111]
ds_read_b64_tr_b16 v[228:229], v11 offset:20480
ds_read_b64_tr_b16 v[230:231], v11 offset:22528
v_add_f32 v14, v14, v81
v_cvt_pk_bf16_f32 v200, v80, v81
v_mfma_f32_32x32x16_bf16 v[112:127], v[236:239], v[60:63], v[112:127]
ds_read_b64_tr_b16 v[232:233], v12 offset:20480
ds_read_b64_tr_b16 v[234:235], v12 offset:22528
v_exp_f32 v84, v84
v_add_f32 v14, v14, v82
v_exp_f32 v85, v85
s_waitcnt lgkmcnt(10)
v_mfma_f32_32x32x16_bf16 v[128:143], v[208:211], v[192:195], v[128:143]
ds_read_b64_tr_b16 v[236:237], v13 offset:20480
ds_read_b64_tr_b16 v[238:239], v13 offset:22528
v_add_f32 v14, v14, v83
v_cvt_pk_bf16_f32 v201, v82, v83
v_mfma_f32_32x32x16_bf16 v[144:159], v[212:215], v[192:195], v[144:159]
ds_read_b64_tr_b16 v[208:209], v10 offset:24576
ds_read_b64_tr_b16 v[210:211], v10 offset:26624
v_exp_f32 v86, v86
v_add_f32 v14, v14, v84
v_exp_f32 v87, v87
s_waitcnt lgkmcnt(10)
v_mfma_f32_32x32x16_bf16 v[160:175], v[216:219], v[192:195], v[160:175]
ds_read_b64_tr_b16 v[212:213], v11 offset:24576
ds_read_b64_tr_b16 v[214:215], v11 offset:26624
v_add_f32_e64 v14, v14, v85
v_cvt_pk_bf16_f32 v202, v84, v85
v_mfma_f32_32x32x16_bf16 v[176:191], v[220:223], v[192:195], v[176:191]
ds_read_b64_tr_b16 v[216:217], v12 offset:24576
ds_read_b64_tr_b16 v[218:219], v12 offset:26624
v_exp_f32 v88, v88
v_add_f32 v14, v14, v86
v_exp_f32 v89, v89
s_waitcnt lgkmcnt(10)
v_mfma_f32_32x32x16_bf16 v[128:143], v[224:227], v[196:199], v[128:143]
ds_read_b64_tr_b16 v[220:221], v13 offset:24576
ds_read_b64_tr_b16 v[222:223], v13 offset:26624
v_add_f32_e64 v14, v14, v87
v_cvt_pk_bf16_f32 v203, v86, v87
v_mfma_f32_32x32x16_bf16 v[144:159], v[228:231], v[196:199], v[144:159]
ds_read_b64_tr_b16 v[224:225], v10 offset:28672
ds_read_b64_tr_b16 v[226:227], v10 offset:30720
v_exp_f32 v90, v90
v_add_f32 v14, v14, v88
v_exp_f32 v91, v91
s_waitcnt lgkmcnt(10)
v_mfma_f32_32x32x16_bf16 v[160:175], v[232:235], v[196:199], v[160:175]
ds_read_b64_tr_b16 v[228:229], v11 offset:28672
ds_read_b64_tr_b16 v[230:231], v11 offset:30720
v_add_f32 v14, v14, v89
v_cvt_pk_bf16_f32 v204, v88, v89
v_mfma_f32_32x32x16_bf16 v[176:191], v[236:239], v[196:199], v[176:191]
ds_read_b64_tr_b16 v[232:233], v12 offset:28672
ds_read_b64_tr_b16 v[234:235], v12 offset:30720
v_exp_f32 v92, v92
v_add_f32 v14, v14, v90
v_exp_f32_e64 v93, v93
s_waitcnt lgkmcnt(10)
v_mfma_f32_32x32x16_bf16 v[128:143], v[208:211], v[200:203], v[128:143]
ds_read_b64_tr_b16 v[236:237], v13 offset:28672
ds_read_b64_tr_b16 v[238:239], v13 offset:30720
v_add_f32 v14, v14, v91
v_cvt_pk_bf16_f32 v205, v90, v91
v_mfma_f32_32x32x16_bf16 v[144:159], v[212:215], v[200:203], v[144:159]
v_exp_f32 v94, v94
v_add_f32 v14, v14, v92
v_exp_f32_e64 v95, v95
s_waitcnt lgkmcnt(8)
v_mfma_f32_32x32x16_bf16 v[160:175], v[216:219], v[200:203], v[160:175]
v_add_f32 v14, v14, v93
v_cvt_pk_bf16_f32 v206, v92, v93
v_mfma_f32_32x32x16_bf16 v[176:191], v[220:223], v[200:203], v[176:191]
v_add_f32 v14, v14, v94
v_add_f32 v14, v14, v95
v_cvt_pk_bf16_f32 v207, v94, v95
s_waitcnt lgkmcnt(0)
s_barrier
s_waitcnt vmcnt(0)
v_cmp_eq_u32 vcc, s5, v24
s_nop 3
s_cmp_eq_u64 vcc, -1
s_cselect_b64 s[6:7], -1, 0
ds_read_b128 v[208:211], v2 offset:0
ds_read_b128 v[212:215], v2 offset:8192
ds_read_b128 v[216:219], v3 offset:0
v_mfma_f32_32x32x16_bf16 v[128:143], v[224:227], v[204:207], v[128:143]
ds_read_b128 v[220:223], v3 offset:8192
v_max3_f32 v15, v96, v97, v98
v_max3_f32 v16, v111, v112, v113
v_max3_f32 v15, v15, v99, v100
v_max3_f32 v16, v16, v114, v115
v_mfma_f32_32x32x16_bf16 v[144:159], v[228:231], v[204:207], v[144:159]
ds_read_b128 v[224:227], v4 offset:0
v_max3_f32 v15, v15, v101, v102
v_max3_f32 v16, v16, v116, v117
v_max3_f32 v15, v15, v103, v104
v_max3_f32 v16, v16, v118, v119
v_max3_f32 v15, v15, v105, v106
v_mfma_f32_32x32x16_bf16 v[160:175], v[232:235], v[204:207], v[160:175]
ds_read_b128 v[228:231], v4 offset:8192
v_max3_f32 v16, v16, v120, v121
v_max3_f32 v15, v15, v107, v108
v_max3_f32 v16, v16, v122, v123
v_max3_f32 v15, v15, v109, v110
v_max3_f32 v16, v16, v124, v125
v_mfma_f32_32x32x16_bf16 v[176:191], v[236:239], v[204:207], v[176:191]
ds_read_b128 v[232:235], v5 offset:0
v_max3_f32 v15, v15, v126, v127
v_max_f32 v15, v15, v16
v_mov_b32 v16, v15
s_nop 1
v_permlane32_swap_b32 v15, v16
v_max_f32 v15, v15, v16
v_cmp_lt_f32 vcc, 0x41000000, v15
s_nop 4
s_cbranch_vccnz LX26
LB27:
s_waitcnt lgkmcnt(5)
v_mfma_f32_32x32x16_bf16 v[64:79], v[208:211], v[32:35], v[240:255]
ds_read_b128 v[236:239], v5 offset:8192
v_exp_f32 v96, v96
v_exp_f32 v97, v97
v_exp_f32 v98, v98
v_mfma_f32_32x32x16_bf16 v[80:95], v[212:215], v[32:35], v[240:255]
ds_read_b128 v[208:211], v6 offset:0
v_add_f32 v14, v14, v96
v_exp_f32 v99, v99
v_add_f32_e64 v14, v14, v97
s_waitcnt lgkmcnt(5)
v_mfma_f32_32x32x16_bf16 v[64:79], v[216:219], v[36:39], v[64:79]
ds_read_b128 v[212:215], v6 offset:8192
v_cvt_pk_bf16_f32 v192, v96, v97
v_exp_f32 v100, v100
v_add_f32 v14, v14, v98
v_exp_f32 v101, v101
v_mfma_f32_32x32x16_bf16 v[80:95], v[220:223], v[36:39], v[80:95]
ds_read_b128 v[216:219], v7 offset:0
v_add_f32 v14, v14, v99
v_cvt_pk_bf16_f32 v193, v98, v99
v_exp_f32 v102, v102
s_waitcnt lgkmcnt(5)
v_mfma_f32_32x32x16_bf16 v[64:79], v[224:227], v[40:43], v[64:79]
ds_read_b128 v[220:223], v7 offset:8192
v_add_f32 v14, v14, v100
v_exp_f32 v103, v103
v_add_f32 v14, v14, v101
v_mfma_f32_32x32x16_bf16 v[80:95], v[228:231], v[40:43], v[80:95]
ds_read_b128 v[224:227], v8 offset:0
v_cvt_pk_bf16_f32 v194, v100, v101
v_exp_f32 v104, v104
v_add_f32 v14, v14, v102
v_exp_f32 v105, v105
s_waitcnt lgkmcnt(5)
v_mfma_f32_32x32x16_bf16 v[64:79], v[232:235], v[44:47], v[64:79]
ds_read_b128 v[228:231], v8 offset:8192
v_add_f32 v14, v14, v103
v_cvt_pk_bf16_f32 v195, v102, v103
v_exp_f32 v106, v106
v_mfma_f32_32x32x16_bf16 v[80:95], v[236:239], v[44:47], v[80:95]
ds_read_b128 v[232:235], v9 offset:0
v_add_f32 v14, v14, v104
v_exp_f32 v107, v107
v_add_f32 v14, v14, v105
s_waitcnt lgkmcnt(5)
v_mfma_f32_32x32x16_bf16 v[64:79], v[208:211], v[48:51], v[64:79]
ds_read_b128 v[236:239], v9 offset:8192
v_cvt_pk_bf16_f32 v196, v104, v105
v_exp_f32 v108, v108
v_add_f32 v14, v14, v106
v_exp_f32 v109, v109
v_mfma_f32_32x32x16_bf16 v[80:95], v[212:215], v[48:51], v[80:95]
v_add_f32_e64 v14, v14, v107
v_cvt_pk_bf16_f32 v197, v106, v107
v_exp_f32 v110, v110
s_waitcnt lgkmcnt(4)
v_mfma_f32_32x32x16_bf16 v[64:79], v[216:219], v[52:55], v[64:79]
v_add_f32 v14, v14, v108
v_exp_f32 v111, v111
v_add_f32 v14, v14, v109
v_mfma_f32_32x32x16_bf16 v[80:95], v[220:223], v[52:55], v[80:95]
v_cvt_pk_bf16_f32 v198, v108, v109
v_add_f32 v14, v14, v110
v_add_f32_e64 v14, v14, v111
v_cvt_pk_bf16_f32 v199, v110, v111
s_waitcnt lgkmcnt(0)
s_barrier
ds_read_b64_tr_b16 v[208:209], v10 offset:32768
ds_read_b64_tr_b16 v[210:211], v10 offset:34816
ds_read_b64_tr_b16 v[212:213], v11 offset:32768
ds_read_b64_tr_b16 v[214:215], v11 offset:34816
ds_read_b64_tr_b16 v[216:217], v12 offset:32768
ds_read_b64_tr_b16 v[218:219], v12 offset:34816
v_mfma_f32_32x32x16_bf16 v[64:79], v[224:227], v[56:59], v[64:79]
ds_read_b64_tr_b16 v[220:221], v13 offset:32768
ds_read_b64_tr_b16 v[222:223], v13 offset:34816
v_exp_f32 v112, v112
v_exp_f32 v113, v113
v_mfma_f32_32x32x16_bf16 v[80:95], v[228:231], v[56:59], v[80:95]
ds_read_b64_tr_b16 v[224:225], v10 offset:36864
ds_read_b64_tr_b16 v[226:227], v10 offset:38912
v_exp_f32 v114, v114
v_add_f32 v14, v14, v112
v_exp_f32 v115, v115
v_mfma_f32_32x32x16_bf16 v[64:79], v[232:235], v[60:63], v[64:79]
ds_read_b64_tr_b16 v[228:229], v11 offset:36864
ds_read_b64_tr_b16 v[230:231], v11 offset:38912
v_add_f32 v14, v14, v113
v_cvt_pk_bf16_f32 v200, v112, v113
v_mfma_f32_32x32x16_bf16 v[80:95], v[236:239], v[60:63], v[80:95]
ds_read_b64_tr_b16 v[232:233], v12 offset:36864
ds_read_b64_tr_b16 v[234:235], v12 offset:38912
v_exp_f32 v116, v116
v_add_f32 v14, v14, v114
v_exp_f32 v117, v117
s_waitcnt lgkmcnt(10)
v_mfma_f32_32x32x16_bf16 v[128:143], v[208:211], v[192:195], v[128:143]
ds_read_b64_tr_b16 v[236:237], v13 offset:36864
ds_read_b64_tr_b16 v[238:239], v13 offset:38912
v_add_f32_e64 v14, v14, v115
v_cvt_pk_bf16_f32 v201, v114, v115
v_mfma_f32_32x32x16_bf16 v[144:159], v[212:215], v[192:195], v[144:159]
ds_read_b64_tr_b16 v[208:209], v10 offset:40960
ds_read_b64_tr_b16 v[210:211], v10 offset:43008
v_exp_f32 v118, v118
v_add_f32 v14, v14, v116
v_exp_f32 v119, v119
s_waitcnt lgkmcnt(10)
v_mfma_f32_32x32x16_bf16 v[160:175], v[216:219], v[192:195], v[160:175]
ds_read_b64_tr_b16 v[212:213], v11 offset:40960
ds_read_b64_tr_b16 v[214:215], v11 offset:43008
v_add_f32_e64 v14, v14, v117
v_cvt_pk_bf16_f32 v202, v116, v117
v_mfma_f32_32x32x16_bf16 v[176:191], v[220:223], v[192:195], v[176:191]
ds_read_b64_tr_b16 v[216:217], v12 offset:40960
ds_read_b64_tr_b16 v[218:219], v12 offset:43008
v_exp_f32 v120, v120
v_add_f32 v14, v14, v118
v_exp_f32 v121, v121
s_waitcnt lgkmcnt(10)
v_mfma_f32_32x32x16_bf16 v[128:143], v[224:227], v[196:199], v[128:143]
ds_read_b64_tr_b16 v[220:221], v13 offset:40960
ds_read_b64_tr_b16 v[222:223], v13 offset:43008
v_add_f32 v14, v14, v119
v_cvt_pk_bf16_f32 v203, v118, v119
v_mfma_f32_32x32x16_bf16 v[144:159], v[228:231], v[196:199], v[144:159]
ds_read_b64_tr_b16 v[224:225], v10 offset:45056
ds_read_b64_tr_b16 v[226:227], v10 offset:47104
v_exp_f32 v122, v122
v_add_f32 v14, v14, v120
v_exp_f32_e64 v123, v123
s_waitcnt lgkmcnt(10)
v_mfma_f32_32x32x16_bf16 v[160:175], v[232:235], v[196:199], v[160:175]
ds_read_b64_tr_b16 v[228:229], v11 offset:45056
ds_read_b64_tr_b16 v[230:231], v11 offset:47104
v_add_f32 v14, v14, v121
v_cvt_pk_bf16_f32 v204, v120, v121
v_mfma_f32_32x32x16_bf16 v[176:191], v[236:239], v[196:199], v[176:191]
ds_read_b64_tr_b16 v[232:233], v12 offset:45056
ds_read_b64_tr_b16 v[234:235], v12 offset:47104
v_exp_f32 v124, v124
v_add_f32 v14, v14, v122
v_exp_f32 v125, v125
s_waitcnt lgkmcnt(10)
v_mfma_f32_32x32x16_bf16 v[128:143], v[208:211], v[200:203], v[128:143]
ds_read_b64_tr_b16 v[236:237], v13 offset:45056
ds_read_b64_tr_b16 v[238:239], v13 offset:47104
v_add_f32 v14, v14, v123
v_cvt_pk_bf16_f32 v205, v122, v123
v_mfma_f32_32x32x16_bf16 v[144:159], v[212:215], v[200:203], v[144:159]
v_exp_f32 v126, v126
v_add_f32 v14, v14, v124
v_exp_f32 v127, v127
s_waitcnt lgkmcnt(8)
v_mfma_f32_32x32x16_bf16 v[160:175], v[216:219], v[200:203], v[160:175]
v_add_f32 v14, v14, v125
v_cvt_pk_bf16_f32 v206, v124, v125
v_mfma_f32_32x32x16_bf16 v[176:191], v[220:223], v[200:203], v[176:191]
v_add_f32 v14, v14, v126
v_add_f32_e64 v14, v14, v127
v_cvt_pk_bf16_f32 v207, v126, v127
s_waitcnt lgkmcnt(0)
s_barrier
ds_read_b128 v[208:211], v2 offset:16384
ds_read_b128 v[212:215], v2 offset:24576
ds_read_b128 v[216:219], v3 offset:16384
v_mfma_f32_32x32x16_bf16 v[128:143], v[224:227], v[204:207], v[128:143]
ds_read_b128 v[220:223], v3 offset:24576
v_max3_f32 v15, v64, v65, v66
v_max3_f32 v16, v79, v80, v81
v_max3_f32 v15, v15, v67, v68
v_max3_f32 v16, v16, v82, v83
v_mfma_f32_32x32x16_bf16 v[144:159], v[228:231], v[204:207], v[144:159]
ds_read_b128 v[224:227], v4 offset:16384
v_max3_f32 v15, v15, v69, v70
v_max3_f32 v16, v16, v84, v85
v_max3_f32 v15, v15, v71, v72
v_max3_f32 v16, v16, v86, v87
v_max3_f32 v15, v15, v73, v74
v_mfma_f32_32x32x16_bf16 v[160:175], v[232:235], v[204:207], v[160:175]
ds_read_b128 v[228:231], v4 offset:24576
v_max3_f32 v16, v16, v88, v89
v_max3_f32 v15, v15, v75, v76
v_max3_f32 v16, v16, v90, v91
v_max3_f32 v15, v15, v77, v78
v_max3_f32 v16, v16, v92, v93
v_mfma_f32_32x32x16_bf16 v[176:191], v[236:239], v[204:207], v[176:191]
ds_read_b128 v[232:235], v5 offset:16384
v_max3_f32 v15, v15, v94, v95
v_max_f32 v15, v15, v16
v_mov_b32 v16, v15
s_nop 1
v_permlane32_swap_b32 v15, v16
v_max_f32 v15, v15, v16
v_cmp_lt_f32 vcc, 0x41000000, v15
s_nop 4
s_cbranch_vccnz LX32
LB33:
s_waitcnt lgkmcnt(5)
v_mfma_f32_32x32x16_bf16 v[96:111], v[208:211], v[32:35], v[240:255]
ds_read_b128 v[236:239], v5 offset:24576
v_exp_f32 v64, v64
v_exp_f32 v65, v65
v_exp_f32 v66, v66
v_mfma_f32_32x32x16_bf16 v[112:127], v[212:215], v[32:35], v[240:255]
ds_read_b128 v[208:211], v6 offset:16384
v_add_f32 v14, v14, v64
v_exp_f32 v67, v67
v_add_f32_e64 v14, v14, v65
s_waitcnt lgkmcnt(5)
v_mfma_f32_32x32x16_bf16 v[96:111], v[216:219], v[36:39], v[96:111]
ds_read_b128 v[212:215], v6 offset:24576
v_cvt_pk_bf16_f32 v192, v64, v65
v_exp_f32 v68, v68
v_add_f32 v14, v14, v66
v_exp_f32 v69, v69
v_mfma_f32_32x32x16_bf16 v[112:127], v[220:223], v[36:39], v[112:127]
ds_read_b128 v[216:219], v7 offset:16384
v_add_f32 v14, v14, v67
v_cvt_pk_bf16_f32 v193, v66, v67
v_exp_f32 v70, v70
s_waitcnt lgkmcnt(5)
v_mfma_f32_32x32x16_bf16 v[96:111], v[224:227], v[40:43], v[96:111]
ds_read_b128 v[220:223], v7 offset:24576
v_add_f32 v14, v14, v68
v_exp_f32 v71, v71
v_add_f32 v14, v14, v69
v_mfma_f32_32x32x16_bf16 v[112:127], v[228:231], v[40:43], v[112:127]
ds_read_b128 v[224:227], v8 offset:16384
v_cvt_pk_bf16_f32 v194, v68, v69
v_exp_f32 v72, v72
v_add_f32 v14, v14, v70
v_exp_f32 v73, v73
s_waitcnt lgkmcnt(5)
v_mfma_f32_32x32x16_bf16 v[96:111], v[232:235], v[44:47], v[96:111]
ds_read_b128 v[228:231], v8 offset:24576
v_add_f32 v14, v14, v71
v_cvt_pk_bf16_f32 v195, v70, v71
v_exp_f32 v74, v74
v_mfma_f32_32x32x16_bf16 v[112:127], v[236:239], v[44:47], v[112:127]
ds_read_b128 v[232:235], v9 offset:16384
v_add_f32 v14, v14, v72
v_exp_f32 v75, v75
v_add_f32 v14, v14, v73
s_waitcnt lgkmcnt(5)
v_mfma_f32_32x32x16_bf16 v[96:111], v[208:211], v[48:51], v[96:111]
ds_read_b128 v[236:239], v9 offset:24576
v_cvt_pk_bf16_f32 v196, v72, v73
v_exp_f32 v76, v76
v_add_f32 v14, v14, v74
v_exp_f32 v77, v77
v_mfma_f32_32x32x16_bf16 v[112:127], v[212:215], v[48:51], v[112:127]
v_add_f32 v14, v14, v75
v_cvt_pk_bf16_f32 v197, v74, v75
v_exp_f32 v78, v78
s_waitcnt lgkmcnt(4)
v_mfma_f32_32x32x16_bf16 v[96:111], v[216:219], v[52:55], v[96:111]
v_add_f32 v14, v14, v76
v_exp_f32 v79, v79
v_add_f32 v14, v14, v77
v_mfma_f32_32x32x16_bf16 v[112:127], v[220:223], v[52:55], v[112:127]
v_cvt_pk_bf16_f32 v198, v76, v77
v_add_f32 v14, v14, v78
v_add_f32 v14, v14, v79
v_cvt_pk_bf16_f32 v199, v78, v79
s_waitcnt lgkmcnt(0)
s_barrier
ds_read_b64_tr_b16 v[208:209], v10 offset:0
ds_read_b64_tr_b16 v[210:211], v10 offset:2048
ds_read_b64_tr_b16 v[212:213], v11 offset:0
ds_read_b64_tr_b16 v[214:215], v11 offset:2048
ds_read_b64_tr_b16 v[216:217], v12 offset:0
ds_read_b64_tr_b16 v[218:219], v12 offset:2048
v_mfma_f32_32x32x16_bf16 v[96:111], v[224:227], v[56:59], v[96:111]
ds_read_b64_tr_b16 v[220:221], v13 offset:0
ds_read_b64_tr_b16 v[222:223], v13 offset:2048
v_exp_f32 v80, v80
v_exp_f32 v81, v81
v_mfma_f32_32x32x16_bf16 v[112:127], v[228:231], v[56:59], v[112:127]
ds_read_b64_tr_b16 v[224:225], v10 offset:4096
ds_read_b64_tr_b16 v[226:227], v10 offset:6144
v_exp_f32 v82, v82
v_add_f32 v14, v14, v80
v_exp_f32_e64 v83, v83
v_mfma_f32_32x32x16_bf16 v[96:111], v[232:235], v[60:63], v[96:111]
ds_read_b64_tr_b16 v[228:229], v11 offset:4096
ds_read_b64_tr_b16 v[230:231], v11 offset:6144
v_add_f32 v14, v14, v81
v_cvt_pk_bf16_f32 v200, v80, v81
v_mfma_f32_32x32x16_bf16 v[112:127], v[236:239], v[60:63], v[112:127]
ds_read_b64_tr_b16 v[232:233], v12 offset:4096
ds_read_b64_tr_b16 v[234:235], v12 offset:6144
v_exp_f32 v84, v84
v_add_f32 v14, v14, v82
v_exp_f32 v85, v85
s_waitcnt lgkmcnt(10)
v_mfma_f32_32x32x16_bf16 v[128:143], v[208:211], v[192:195], v[128:143]
ds_read_b64_tr_b16 v[236:237], v13 offset:4096
ds_read_b64_tr_b16 v[238:239], v13 offset:6144
v_add_f32 v14, v14, v83
v_cvt_pk_bf16_f32 v201, v82, v83
v_mfma_f32_32x32x16_bf16 v[144:159], v[212:215], v[192:195], v[144:159]
ds_read_b64_tr_b16 v[208:209], v10 offset:8192
ds_read_b64_tr_b16 v[210:211], v10 offset:10240
v_exp_f32 v86, v86
v_add_f32 v14, v14, v84
v_exp_f32 v87, v87
s_waitcnt lgkmcnt(10)
v_mfma_f32_32x32x16_bf16 v[160:175], v[216:219], v[192:195], v[160:175]
ds_read_b64_tr_b16 v[212:213], v11 offset:8192
ds_read_b64_tr_b16 v[214:215], v11 offset:10240
v_add_f32_e64 v14, v14, v85
v_cvt_pk_bf16_f32 v202, v84, v85
v_mfma_f32_32x32x16_bf16 v[176:191], v[220:223], v[192:195], v[176:191]
ds_read_b64_tr_b16 v[216:217], v12 offset:8192
ds_read_b64_tr_b16 v[218:219], v12 offset:10240
v_exp_f32 v88, v88
v_add_f32 v14, v14, v86
v_exp_f32 v89, v89
s_waitcnt lgkmcnt(10)
v_mfma_f32_32x32x16_bf16 v[128:143], v[224:227], v[196:199], v[128:143]
ds_read_b64_tr_b16 v[220:221], v13 offset:8192
ds_read_b64_tr_b16 v[222:223], v13 offset:10240
v_add_f32_e64 v14, v14, v87
v_cvt_pk_bf16_f32 v203, v86, v87
v_mfma_f32_32x32x16_bf16 v[144:159], v[228:231], v[196:199], v[144:159]
ds_read_b64_tr_b16 v[224:225], v10 offset:12288
ds_read_b64_tr_b16 v[226:227], v10 offset:14336
v_exp_f32 v90, v90
v_add_f32 v14, v14, v88
v_exp_f32 v91, v91
s_waitcnt lgkmcnt(10)
v_mfma_f32_32x32x16_bf16 v[160:175], v[232:235], v[196:199], v[160:175]
ds_read_b64_tr_b16 v[228:229], v11 offset:12288
ds_read_b64_tr_b16 v[230:231], v11 offset:14336
v_add_f32 v14, v14, v89
v_cvt_pk_bf16_f32 v204, v88, v89
v_mfma_f32_32x32x16_bf16 v[176:191], v[236:239], v[196:199], v[176:191]
ds_read_b64_tr_b16 v[232:233], v12 offset:12288
ds_read_b64_tr_b16 v[234:235], v12 offset:14336
v_exp_f32 v92, v92
v_add_f32 v14, v14, v90
v_exp_f32_e64 v93, v93
s_waitcnt lgkmcnt(10)
v_mfma_f32_32x32x16_bf16 v[128:143], v[208:211], v[200:203], v[128:143]
ds_read_b64_tr_b16 v[236:237], v13 offset:12288
ds_read_b64_tr_b16 v[238:239], v13 offset:14336
v_add_f32 v14, v14, v91
v_cvt_pk_bf16_f32 v205, v90, v91
v_mfma_f32_32x32x16_bf16 v[144:159], v[212:215], v[200:203], v[144:159]
v_exp_f32 v94, v94
v_add_f32 v14, v14, v92
v_exp_f32_e64 v95, v95
s_waitcnt lgkmcnt(8)
v_mfma_f32_32x32x16_bf16 v[160:175], v[216:219], v[200:203], v[160:175]
v_add_f32 v14, v14, v93
v_cvt_pk_bf16_f32 v206, v92, v93
v_mfma_f32_32x32x16_bf16 v[176:191], v[220:223], v[200:203], v[176:191]
v_add_f32 v14, v14, v94
v_add_f32_e64 v14, v14, v95
v_cvt_pk_bf16_f32 v207, v94, v95
s_waitcnt lgkmcnt(0)
s_barrier
ds_read_b128 v[208:211], v2 offset:32768
ds_read_b128 v[212:215], v2 offset:40960
ds_read_b128 v[216:219], v3 offset:32768
v_mfma_f32_32x32x16_bf16 v[128:143], v[224:227], v[204:207], v[128:143]
ds_read_b128 v[220:223], v3 offset:40960
v_max3_f32 v15, v96, v97, v98
v_max3_f32 v16, v111, v112, v113
v_max3_f32 v15, v15, v99, v100
v_max3_f32 v16, v16, v114, v115
v_mfma_f32_32x32x16_bf16 v[144:159], v[228:231], v[204:207], v[144:159]
ds_read_b128 v[224:227], v4 offset:32768
v_max3_f32 v15, v15, v101, v102
v_max3_f32 v16, v16, v116, v117
v_max3_f32 v15, v15, v103, v104
v_max3_f32 v16, v16, v118, v119
v_max3_f32 v15, v15, v105, v106
v_mfma_f32_32x32x16_bf16 v[160:175], v[232:235], v[204:207], v[160:175]
ds_read_b128 v[228:231], v4 offset:40960
v_max3_f32 v16, v16, v120, v121
v_max3_f32 v15, v15, v107, v108
v_max3_f32 v16, v16, v122, v123
v_max3_f32 v15, v15, v109, v110
v_max3_f32 v16, v16, v124, v125
v_mfma_f32_32x32x16_bf16 v[176:191], v[236:239], v[204:207], v[176:191]
ds_read_b128 v[232:235], v5 offset:32768
v_max3_f32 v15, v15, v126, v127
v_max_f32 v15, v15, v16
v_mov_b32 v16, v15
s_nop 1
v_permlane32_swap_b32 v15, v16
v_max_f32 v15, v15, v16
v_cmp_lt_f32 vcc, 0x41000000, v15
s_nop 4
s_cbranch_vccnz LX38
LB39:
s_waitcnt lgkmcnt(5)
v_mfma_f32_32x32x16_bf16 v[64:79], v[208:211], v[32:35], v[240:255]
ds_read_b128 v[236:239], v5 offset:40960
v_exp_f32 v96, v96
v_exp_f32 v97, v97
v_exp_f32 v98, v98
v_mfma_f32_32x32x16_bf16 v[80:95], v[212:215], v[32:35], v[240:255]
ds_read_b128 v[208:211], v6 offset:32768
v_add_f32 v14, v14, v96
v_exp_f32 v99, v99
v_add_f32_e64 v14, v14, v97
s_waitcnt lgkmcnt(5)
v_mfma_f32_32x32x16_bf16 v[64:79], v[216:219], v[36:39], v[64:79]
ds_read_b128 v[212:215], v6 offset:40960
v_cvt_pk_bf16_f32 v192, v96, v97
v_exp_f32 v100, v100
v_add_f32 v14, v14, v98
v_exp_f32 v101, v101
v_mfma_f32_32x32x16_bf16 v[80:95], v[220:223], v[36:39], v[80:95]
ds_read_b128 v[216:219], v7 offset:32768
v_add_f32 v14, v14, v99
v_cvt_pk_bf16_f32 v193, v98, v99
v_exp_f32 v102, v102
s_waitcnt lgkmcnt(5)
v_mfma_f32_32x32x16_bf16 v[64:79], v[224:227], v[40:43], v[64:79]
ds_read_b128 v[220:223], v7 offset:40960
v_add_f32 v14, v14, v100
v_exp_f32 v103, v103
v_add_f32 v14, v14, v101
v_mfma_f32_32x32x16_bf16 v[80:95], v[228:231], v[40:43], v[80:95]
ds_read_b128 v[224:227], v8 offset:32768
v_cvt_pk_bf16_f32 v194, v100, v101
v_exp_f32 v104, v104
v_add_f32 v14, v14, v102
v_exp_f32_e64 v105, v105
s_waitcnt lgkmcnt(5)
v_mfma_f32_32x32x16_bf16 v[64:79], v[232:235], v[44:47], v[64:79]
ds_read_b128 v[228:231], v8 offset:40960
v_add_f32 v14, v14, v103
v_cvt_pk_bf16_f32 v195, v102, v103
v_exp_f32 v106, v106
v_mfma_f32_32x32x16_bf16 v[80:95], v[236:239], v[44:47], v[80:95]
ds_read_b128 v[232:235], v9 offset:32768
v_add_f32 v14, v14, v104
v_exp_f32 v107, v107
v_add_f32 v14, v14, v105
s_waitcnt lgkmcnt(5)
v_mfma_f32_32x32x16_bf16 v[64:79], v[208:211], v[48:51], v[64:79]
ds_read_b128 v[236:239], v9 offset:40960
v_cvt_pk_bf16_f32 v196, v104, v105
v_exp_f32 v108, v108
v_add_f32 v14, v14, v106
v_exp_f32 v109, v109
v_mfma_f32_32x32x16_bf16 v[80:95], v[212:215], v[48:51], v[80:95]
v_add_f32 v14, v14, v107
v_cvt_pk_bf16_f32 v197, v106, v107
v_exp_f32 v110, v110
s_waitcnt lgkmcnt(4)
v_mfma_f32_32x32x16_bf16 v[64:79], v[216:219], v[52:55], v[64:79]
v_add_f32 v14, v14, v108
v_exp_f32 v111, v111
v_add_f32 v14, v14, v109
v_mfma_f32_32x32x16_bf16 v[80:95], v[220:223], v[52:55], v[80:95]
v_cvt_pk_bf16_f32 v198, v108, v109
v_add_f32 v14, v14, v110
v_add_f32_e64 v14, v14, v111
v_cvt_pk_bf16_f32 v199, v110, v111
s_waitcnt lgkmcnt(0)
s_barrier
ds_read_b64_tr_b16 v[208:209], v10 offset:16384
ds_read_b64_tr_b16 v[210:211], v10 offset:18432
ds_read_b64_tr_b16 v[212:213], v11 offset:16384
ds_read_b64_tr_b16 v[214:215], v11 offset:18432
ds_read_b64_tr_b16 v[216:217], v12 offset:16384
ds_read_b64_tr_b16 v[218:219], v12 offset:18432
v_mfma_f32_32x32x16_bf16 v[64:79], v[224:227], v[56:59], v[64:79]
ds_read_b64_tr_b16 v[220:221], v13 offset:16384
ds_read_b64_tr_b16 v[222:223], v13 offset:18432
v_exp_f32 v112, v112
v_exp_f32 v113, v113
v_mfma_f32_32x32x16_bf16 v[80:95], v[228:231], v[56:59], v[80:95]
ds_read_b64_tr_b16 v[224:225], v10 offset:20480
ds_read_b64_tr_b16 v[226:227], v10 offset:22528
v_exp_f32 v114, v114
v_add_f32 v14, v14, v112
v_exp_f32_e64 v115, v115
v_mfma_f32_32x32x16_bf16 v[64:79], v[232:235], v[60:63], v[64:79]
ds_read_b64_tr_b16 v[228:229], v11 offset:20480
ds_read_b64_tr_b16 v[230:231], v11 offset:22528
v_add_f32 v14, v14, v113
v_cvt_pk_bf16_f32 v200, v112, v113
v_mfma_f32_32x32x16_bf16 v[80:95], v[236:239], v[60:63], v[80:95]
ds_read_b64_tr_b16 v[232:233], v12 offset:20480
ds_read_b64_tr_b16 v[234:235], v12 offset:22528
v_exp_f32 v116, v116
v_add_f32 v14, v14, v114
v_exp_f32 v117, v117
s_waitcnt lgkmcnt(10)
v_mfma_f32_32x32x16_bf16 v[128:143], v[208:211], v[192:195], v[128:143]
ds_read_b64_tr_b16 v[236:237], v13 offset:20480
ds_read_b64_tr_b16 v[238:239], v13 offset:22528
v_add_f32 v14, v14, v115
v_cvt_pk_bf16_f32 v201, v114, v115
v_mfma_f32_32x32x16_bf16 v[144:159], v[212:215], v[192:195], v[144:159]
ds_read_b64_tr_b16 v[208:209], v10 offset:24576
ds_read_b64_tr_b16 v[210:211], v10 offset:26624
v_exp_f32 v118, v118
v_add_f32 v14, v14, v116
v_exp_f32 v119, v119
s_waitcnt lgkmcnt(10)
v_mfma_f32_32x32x16_bf16 v[160:175], v[216:219], v[192:195], v[160:175]
ds_read_b64_tr_b16 v[212:213], v11 offset:24576
ds_read_b64_tr_b16 v[214:215], v11 offset:26624
v_add_f32_e64 v14, v14, v117
v_cvt_pk_bf16_f32 v202, v116, v117
v_mfma_f32_32x32x16_bf16 v[176:191], v[220:223], v[192:195], v[176:191]
ds_read_b64_tr_b16 v[216:217], v12 offset:24576
ds_read_b64_tr_b16 v[218:219], v12 offset:26624
v_exp_f32 v120, v120
v_add_f32 v14, v14, v118
v_exp_f32 v121, v121
s_waitcnt lgkmcnt(10)
v_mfma_f32_32x32x16_bf16 v[128:143], v[224:227], v[196:199], v[128:143]
ds_read_b64_tr_b16 v[220:221], v13 offset:24576
ds_read_b64_tr_b16 v[222:223], v13 offset:26624
v_add_f32_e64 v14, v14, v119
v_cvt_pk_bf16_f32 v203, v118, v119
v_mfma_f32_32x32x16_bf16 v[144:159], v[228:231], v[196:199], v[144:159]
ds_read_b64_tr_b16 v[224:225], v10 offset:28672
ds_read_b64_tr_b16 v[226:227], v10 offset:30720
v_exp_f32 v122, v122
v_add_f32 v14, v14, v120
v_exp_f32 v123, v123
s_waitcnt lgkmcnt(10)
v_mfma_f32_32x32x16_bf16 v[160:175], v[232:235], v[196:199], v[160:175]
ds_read_b64_tr_b16 v[228:229], v11 offset:28672
ds_read_b64_tr_b16 v[230:231], v11 offset:30720
v_add_f32 v14, v14, v121
v_cvt_pk_bf16_f32 v204, v120, v121
v_mfma_f32_32x32x16_bf16 v[176:191], v[236:239], v[196:199], v[176:191]
ds_read_b64_tr_b16 v[232:233], v12 offset:28672
ds_read_b64_tr_b16 v[234:235], v12 offset:30720
v_exp_f32 v124, v124
v_add_f32 v14, v14, v122
v_exp_f32_e64 v125, v125
s_waitcnt lgkmcnt(10)
v_mfma_f32_32x32x16_bf16 v[128:143], v[208:211], v[200:203], v[128:143]
ds_read_b64_tr_b16 v[236:237], v13 offset:28672
ds_read_b64_tr_b16 v[238:239], v13 offset:30720
v_add_f32 v14, v14, v123
v_cvt_pk_bf16_f32 v205, v122, v123
v_mfma_f32_32x32x16_bf16 v[144:159], v[212:215], v[200:203], v[144:159]
v_exp_f32 v126, v126
v_add_f32 v14, v14, v124
v_exp_f32_e64 v127, v127
s_waitcnt lgkmcnt(8)
v_mfma_f32_32x32x16_bf16 v[160:175], v[216:219], v[200:203], v[160:175]
v_add_f32 v14, v14, v125
v_cvt_pk_bf16_f32 v206, v124, v125
v_mfma_f32_32x32x16_bf16 v[176:191], v[220:223], v[200:203], v[176:191]
v_add_f32 v14, v14, v126
v_add_f32_e64 v14, v14, v127
v_cvt_pk_bf16_f32 v207, v126, v127
s_waitcnt lgkmcnt(0)
s_barrier
ds_read_b128 v[208:211], v2 offset:0
ds_read_b128 v[212:215], v2 offset:8192
ds_read_b128 v[216:219], v3 offset:0
v_mfma_f32_32x32x16_bf16 v[128:143], v[224:227], v[204:207], v[128:143]
ds_read_b128 v[220:223], v3 offset:8192
v_max3_f32 v15, v64, v65, v66
v_max3_f32 v16, v79, v80, v81
v_max3_f32 v15, v15, v67, v68
v_max3_f32 v16, v16, v82, v83
v_mfma_f32_32x32x16_bf16 v[144:159], v[228:231], v[204:207], v[144:159]
ds_read_b128 v[224:227], v4 offset:0
v_max3_f32 v15, v15, v69, v70
v_max3_f32 v16, v16, v84, v85
v_max3_f32 v15, v15, v71, v72
v_max3_f32 v16, v16, v86, v87
v_max3_f32 v15, v15, v73, v74
v_mfma_f32_32x32x16_bf16 v[160:175], v[232:235], v[204:207], v[160:175]
ds_read_b128 v[228:231], v4 offset:8192
v_max3_f32 v16, v16, v88, v89
v_max3_f32 v15, v15, v75, v76
v_max3_f32 v16, v16, v90, v91
v_max3_f32 v15, v15, v77, v78
v_max3_f32 v16, v16, v92, v93
v_mfma_f32_32x32x16_bf16 v[176:191], v[236:239], v[204:207], v[176:191]
ds_read_b128 v[232:235], v5 offset:0
v_max3_f32 v15, v15, v94, v95
v_max_f32 v15, v15, v16
v_mov_b32 v16, v15
s_nop 1
v_permlane32_swap_b32 v15, v16
v_max_f32 v15, v15, v16
v_cmp_lt_f32 vcc, 0x41000000, v15
s_nop 4
s_cbranch_vccnz LX44
LB45:
s_waitcnt lgkmcnt(5)
v_mfma_f32_32x32x16_bf16 v[96:111], v[208:211], v[32:35], v[240:255]
ds_read_b128 v[236:239], v5 offset:8192
v_exp_f32 v64, v64
v_exp_f32 v65, v65
v_exp_f32 v66, v66
v_mfma_f32_32x32x16_bf16 v[112:127], v[212:215], v[32:35], v[240:255]
ds_read_b128 v[208:211], v6 offset:0
v_add_f32 v14, v14, v64
v_exp_f32 v67, v67
v_add_f32_e64 v14, v14, v65
s_waitcnt lgkmcnt(5)
v_mfma_f32_32x32x16_bf16 v[96:111], v[216:219], v[36:39], v[96:111]
ds_read_b128 v[212:215], v6 offset:8192
v_cvt_pk_bf16_f32 v192, v64, v65
v_exp_f32 v68, v68
v_add_f32 v14, v14, v66
v_exp_f32 v69, v69
v_mfma_f32_32x32x16_bf16 v[112:127], v[220:223], v[36:39], v[112:127]
ds_read_b128 v[216:219], v7 offset:0
v_add_f32 v14, v14, v67
v_cvt_pk_bf16_f32 v193, v66, v67
v_exp_f32 v70, v70
s_waitcnt lgkmcnt(5)
v_mfma_f32_32x32x16_bf16 v[96:111], v[224:227], v[40:43], v[96:111]
ds_read_b128 v[220:223], v7 offset:8192
v_add_f32 v14, v14, v68
v_exp_f32 v71, v71
v_add_f32 v14, v14, v69
v_mfma_f32_32x32x16_bf16 v[112:127], v[228:231], v[40:43], v[112:127]
ds_read_b128 v[224:227], v8 offset:0
v_cvt_pk_bf16_f32 v194, v68, v69
v_exp_f32 v72, v72
v_add_f32 v14, v14, v70
v_exp_f32_e64 v73, v73
s_waitcnt lgkmcnt(5)
v_mfma_f32_32x32x16_bf16 v[96:111], v[232:235], v[44:47], v[96:111]
ds_read_b128 v[228:231], v8 offset:8192
v_add_f32 v14, v14, v71
v_cvt_pk_bf16_f32 v195, v70, v71
v_exp_f32 v74, v74
v_mfma_f32_32x32x16_bf16 v[112:127], v[236:239], v[44:47], v[112:127]
ds_read_b128 v[232:235], v9 offset:0
v_add_f32 v14, v14, v72
v_exp_f32 v75, v75
v_add_f32 v14, v14, v73
s_waitcnt lgkmcnt(5)
v_mfma_f32_32x32x16_bf16 v[96:111], v[208:211], v[48:51], v[96:111]
ds_read_b128 v[236:239], v9 offset:8192
v_cvt_pk_bf16_f32 v196, v72, v73
v_exp_f32 v76, v76
v_add_f32 v14, v14, v74
v_exp_f32 v77, v77
v_mfma_f32_32x32x16_bf16 v[112:127], v[212:215], v[48:51], v[112:127]
v_add_f32 v14, v14, v75
v_cvt_pk_bf16_f32 v197, v74, v75
v_exp_f32 v78, v78
s_waitcnt lgkmcnt(4)
v_mfma_f32_32x32x16_bf16 v[96:111], v[216:219], v[52:55], v[96:111]
v_add_f32 v14, v14, v76
v_exp_f32 v79, v79
v_add_f32 v14, v14, v77
v_mfma_f32_32x32x16_bf16 v[112:127], v[220:223], v[52:55], v[112:127]
v_cvt_pk_bf16_f32 v198, v76, v77
v_add_f32 v14, v14, v78
v_add_f32_e64 v14, v14, v79
v_cvt_pk_bf16_f32 v199, v78, v79
s_waitcnt lgkmcnt(0)
s_barrier
ds_read_b64_tr_b16 v[208:209], v10 offset:32768
ds_read_b64_tr_b16 v[210:211], v10 offset:34816
ds_read_b64_tr_b16 v[212:213], v11 offset:32768
ds_read_b64_tr_b16 v[214:215], v11 offset:34816
ds_read_b64_tr_b16 v[216:217], v12 offset:32768
ds_read_b64_tr_b16 v[218:219], v12 offset:34816
v_mfma_f32_32x32x16_bf16 v[96:111], v[224:227], v[56:59], v[96:111]
ds_read_b64_tr_b16 v[220:221], v13 offset:32768
ds_read_b64_tr_b16 v[222:223], v13 offset:34816
v_exp_f32 v80, v80
v_exp_f32 v81, v81
v_mfma_f32_32x32x16_bf16 v[112:127], v[228:231], v[56:59], v[112:127]
ds_read_b64_tr_b16 v[224:225], v10 offset:36864
ds_read_b64_tr_b16 v[226:227], v10 offset:38912
v_exp_f32 v82, v82
v_add_f32 v14, v14, v80
v_exp_f32_e64 v83, v83
v_mfma_f32_32x32x16_bf16 v[96:111], v[232:235], v[60:63], v[96:111]
ds_read_b64_tr_b16 v[228:229], v11 offset:36864
ds_read_b64_tr_b16 v[230:231], v11 offset:38912
v_add_f32 v14, v14, v81
v_cvt_pk_bf16_f32 v200, v80, v81
v_mfma_f32_32x32x16_bf16 v[112:127], v[236:239], v[60:63], v[112:127]
ds_read_b64_tr_b16 v[232:233], v12 offset:36864
ds_read_b64_tr_b16 v[234:235], v12 offset:38912
v_exp_f32 v84, v84
v_add_f32 v14, v14, v82
v_exp_f32 v85, v85
s_waitcnt lgkmcnt(10)
v_mfma_f32_32x32x16_bf16 v[128:143], v[208:211], v[192:195], v[128:143]
ds_read_b64_tr_b16 v[236:237], v13 offset:36864
ds_read_b64_tr_b16 v[238:239], v13 offset:38912
v_add_f32 v14, v14, v83
v_cvt_pk_bf16_f32 v201, v82, v83
v_mfma_f32_32x32x16_bf16 v[144:159], v[212:215], v[192:195], v[144:159]
ds_read_b64_tr_b16 v[208:209], v10 offset:40960
ds_read_b64_tr_b16 v[210:211], v10 offset:43008
v_exp_f32 v86, v86
v_add_f32 v14, v14, v84
v_exp_f32 v87, v87
s_waitcnt lgkmcnt(10)
v_mfma_f32_32x32x16_bf16 v[160:175], v[216:219], v[192:195], v[160:175]
ds_read_b64_tr_b16 v[212:213], v11 offset:40960
ds_read_b64_tr_b16 v[214:215], v11 offset:43008
v_add_f32_e64 v14, v14, v85
v_cvt_pk_bf16_f32 v202, v84, v85
v_mfma_f32_32x32x16_bf16 v[176:191], v[220:223], v[192:195], v[176:191]
ds_read_b64_tr_b16 v[216:217], v12 offset:40960
ds_read_b64_tr_b16 v[218:219], v12 offset:43008
v_exp_f32 v88, v88
v_add_f32 v14, v14, v86
v_exp_f32 v89, v89
s_waitcnt lgkmcnt(10)
v_mfma_f32_32x32x16_bf16 v[128:143], v[224:227], v[196:199], v[128:143]
ds_read_b64_tr_b16 v[220:221], v13 offset:40960
ds_read_b64_tr_b16 v[222:223], v13 offset:43008
v_add_f32_e64 v14, v14, v87
v_cvt_pk_bf16_f32 v203, v86, v87
v_mfma_f32_32x32x16_bf16 v[144:159], v[228:231], v[196:199], v[144:159]
ds_read_b64_tr_b16 v[224:225], v10 offset:45056
ds_read_b64_tr_b16 v[226:227], v10 offset:47104
v_exp_f32 v90, v90
v_add_f32 v14, v14, v88
v_exp_f32 v91, v91
s_waitcnt lgkmcnt(10)
v_mfma_f32_32x32x16_bf16 v[160:175], v[232:235], v[196:199], v[160:175]
ds_read_b64_tr_b16 v[228:229], v11 offset:45056
ds_read_b64_tr_b16 v[230:231], v11 offset:47104
v_add_f32 v14, v14, v89
v_cvt_pk_bf16_f32 v204, v88, v89
v_mfma_f32_32x32x16_bf16 v[176:191], v[236:239], v[196:199], v[176:191]
ds_read_b64_tr_b16 v[232:233], v12 offset:45056
ds_read_b64_tr_b16 v[234:235], v12 offset:47104
v_exp_f32 v92, v92
v_add_f32 v14, v14, v90
v_exp_f32_e64 v93, v93
s_waitcnt lgkmcnt(10)
v_mfma_f32_32x32x16_bf16 v[128:143], v[208:211], v[200:203], v[128:143]
ds_read_b64_tr_b16 v[236:237], v13 offset:45056
ds_read_b64_tr_b16 v[238:239], v13 offset:47104
v_add_f32 v14, v14, v91
v_cvt_pk_bf16_f32 v205, v90, v91
v_mfma_f32_32x32x16_bf16 v[144:159], v[212:215], v[200:203], v[144:159]
v_exp_f32 v94, v94
v_add_f32 v14, v14, v92
v_exp_f32_e64 v95, v95
s_waitcnt lgkmcnt(8)
v_mfma_f32_32x32x16_bf16 v[160:175], v[216:219], v[200:203], v[160:175]
v_add_f32 v14, v14, v93
v_cvt_pk_bf16_f32 v206, v92, v93
v_mfma_f32_32x32x16_bf16 v[176:191], v[220:223], v[200:203], v[176:191]
v_add_f32 v14, v14, v94
v_add_f32_e64 v14, v14, v95
v_cvt_pk_bf16_f32 v207, v94, v95
s_waitcnt lgkmcnt(0)
s_barrier
ds_read_b64_tr_b16 v[208:209], v10 offset:0
ds_read_b64_tr_b16 v[210:211], v10 offset:2048
ds_read_b64_tr_b16 v[212:213], v11 offset:0
ds_read_b64_tr_b16 v[214:215], v11 offset:2048
ds_read_b64_tr_b16 v[216:217], v12 offset:0
ds_read_b64_tr_b16 v[218:219], v12 offset:2048
v_mfma_f32_32x32x16_bf16 v[128:143], v[224:227], v[204:207], v[128:143]
ds_read_b64_tr_b16 v[220:221], v13 offset:0
ds_read_b64_tr_b16 v[222:223], v13 offset:2048
v_max3_f32 v15, v96, v97, v98
v_max3_f32 v16, v111, v112, v113
v_max3_f32 v15, v15, v99, v100
v_max3_f32 v16, v16, v114, v115
v_mfma_f32_32x32x16_bf16 v[144:159], v[228:231], v[204:207], v[144:159]
ds_read_b64_tr_b16 v[224:225], v10 offset:4096
ds_read_b64_tr_b16 v[226:227], v10 offset:6144
v_max3_f32 v15, v15, v101, v102
v_max3_f32 v16, v16, v116, v117
v_max3_f32 v15, v15, v103, v104
v_max3_f32 v16, v16, v118, v119
v_max3_f32 v15, v15, v105, v106
v_mfma_f32_32x32x16_bf16 v[160:175], v[232:235], v[204:207], v[160:175]
ds_read_b64_tr_b16 v[228:229], v11 offset:4096
ds_read_b64_tr_b16 v[230:231], v11 offset:6144
v_max3_f32 v16, v16, v120, v121
v_max3_f32 v15, v15, v107, v108
v_max3_f32 v16, v16, v122, v123
v_max3_f32 v15, v15, v109, v110
v_max3_f32 v16, v16, v124, v125
v_mfma_f32_32x32x16_bf16 v[176:191], v[236:239], v[204:207], v[176:191]
ds_read_b64_tr_b16 v[232:233], v12 offset:4096
ds_read_b64_tr_b16 v[234:235], v12 offset:6144
v_max3_f32 v15, v15, v126, v127
v_max_f32 v15, v15, v16
v_mov_b32 v16, v15
s_nop 1
v_permlane32_swap_b32 v15, v16
v_max_f32 v15, v15, v16
v_cmp_lt_f32 vcc, 0x41000000, v15
s_nop 4
s_cbranch_vccnz LX46
LB47:
v_exp_f32 v96, v96
v_exp_f32 v97, v97
v_exp_f32 v98, v98
v_add_f32 v14, v14, v96
v_exp_f32 v99, v99
v_add_f32_e64 v14, v14, v97
v_cvt_pk_bf16_f32 v192, v96, v97
v_exp_f32 v100, v100
v_add_f32 v14, v14, v98
v_exp_f32 v101, v101
v_add_f32 v14, v14, v99
v_cvt_pk_bf16_f32 v193, v98, v99
v_exp_f32 v102, v102
v_add_f32 v14, v14, v100
v_exp_f32 v103, v103
v_add_f32 v14, v14, v101
v_cvt_pk_bf16_f32 v194, v100, v101
v_exp_f32 v104, v104
v_add_f32 v14, v14, v102
v_exp_f32 v105, v105
v_add_f32 v14, v14, v103
v_cvt_pk_bf16_f32 v195, v102, v103
s_waitcnt lgkmcnt(10)
s_nop 0
v_mfma_f32_32x32x16_bf16 v[128:143], v[208:211], v[192:195], v[128:143]
ds_read_b64_tr_b16 v[236:237], v13 offset:4096
ds_read_b64_tr_b16 v[238:239], v13 offset:6144
v_exp_f32 v106, v106
v_add_f32 v14, v14, v104
v_exp_f32 v107, v107
v_add_f32 v14, v14, v105
v_mfma_f32_32x32x16_bf16 v[144:159], v[212:215], v[192:195], v[144:159]
ds_read_b64_tr_b16 v[208:209], v10 offset:8192
ds_read_b64_tr_b16 v[210:211], v10 offset:10240
v_cvt_pk_bf16_f32 v196, v104, v105
v_exp_f32 v108, v108
v_add_f32 v14, v14, v106
v_exp_f32 v109, v109
v_add_f32_e64 v14, v14, v107
s_waitcnt lgkmcnt(10)
v_mfma_f32_32x32x16_bf16 v[160:175], v[216:219], v[192:195], v[160:175]
ds_read_b64_tr_b16 v[212:213], v11 offset:8192
ds_read_b64_tr_b16 v[214:215], v11 offset:10240
v_cvt_pk_bf16_f32 v197, v106, v107
v_exp_f32 v110, v110
v_add_f32 v14, v14, v108
v_exp_f32 v111, v111
v_mfma_f32_32x32x16_bf16 v[176:191], v[220:223], v[192:195], v[176:191]
ds_read_b64_tr_b16 v[216:217], v12 offset:8192
ds_read_b64_tr_b16 v[218:219], v12 offset:10240
v_add_f32 v14, v14, v109
v_cvt_pk_bf16_f32 v198, v108, v109
v_add_f32 v14, v14, v110
v_add_f32 v14, v14, v111
v_cvt_pk_bf16_f32 v199, v110, v111
s_waitcnt lgkmcnt(10)
s_nop 0
v_mfma_f32_32x32x16_bf16 v[128:143], v[224:227], v[196:199], v[128:143]
ds_read_b64_tr_b16 v[220:221], v13 offset:8192
ds_read_b64_tr_b16 v[222:223], v13 offset:10240
v_exp_f32 v112, v112
v_exp_f32 v113, v113
v_exp_f32 v114, v114
v_add_f32 v14, v14, v112
v_exp_f32 v115, v115
v_mfma_f32_32x32x16_bf16 v[144:159], v[228:231], v[196:199], v[144:159]
ds_read_b64_tr_b16 v[224:225], v10 offset:12288
ds_read_b64_tr_b16 v[226:227], v10 offset:14336
v_add_f32 v14, v14, v113
v_cvt_pk_bf16_f32 v200, v112, v113
v_exp_f32 v116, v116
v_add_f32 v14, v14, v114
v_exp_f32 v117, v117
v_add_f32 v14, v14, v115
s_waitcnt lgkmcnt(10)
v_mfma_f32_32x32x16_bf16 v[160:175], v[232:235], v[196:199], v[160:175]
ds_read_b64_tr_b16 v[228:229], v11 offset:12288
ds_read_b64_tr_b16 v[230:231], v11 offset:14336
v_cvt_pk_bf16_f32 v201, v114, v115
v_exp_f32 v118, v118
v_add_f32 v14, v14, v116
v_exp_f32 v119, v119
v_add_f32_e64 v14, v14, v117
v_mfma_f32_32x32x16_bf16 v[176:191], v[236:239], v[196:199], v[176:191]
ds_read_b64_tr_b16 v[232:233], v12 offset:12288
ds_read_b64_tr_b16 v[234:235], v12 offset:14336
v_cvt_pk_bf16_f32 v202, v116, v117
v_exp_f32 v120, v120
v_add_f32 v14, v14, v118
v_exp_f32 v121, v121
v_add_f32 v14, v14, v119
v_cvt_pk_bf16_f32 v203, v118, v119
s_waitcnt lgkmcnt(10)
s_nop 0
v_mfma_f32_32x32x16_bf16 v[128:143], v[208:211], v[200:203], v[128:143]
ds_read_b64_tr_b16 v[236:237], v13 offset:12288
ds_read_b64_tr_b16 v[238:239], v13 offset:14336
v_exp_f32 v122, v122
v_add_f32 v14, v14, v120
v_exp_f32 v123, v123
v_add_f32 v14, v14, v121
v_mfma_f32_32x32x16_bf16 v[144:159], v[212:215], v[200:203], v[144:159]
v_cvt_pk_bf16_f32 v204, v120, v121
v_exp_f32 v124, v124
v_add_f32 v14, v14, v122
v_exp_f32 v125, v125
v_add_f32 v14, v14, v123
s_waitcnt lgkmcnt(8)
v_mfma_f32_32x32x16_bf16 v[160:175], v[216:219], v[200:203], v[160:175]
v_cvt_pk_bf16_f32 v205, v122, v123
v_exp_f32 v126, v126
v_add_f32 v14, v14, v124
v_exp_f32 v127, v127
v_mfma_f32_32x32x16_bf16 v[176:191], v[220:223], v[200:203], v[176:191]
v_add_f32 v14, v14, v125
v_cvt_pk_bf16_f32 v206, v124, v125
v_add_f32 v14, v14, v126
v_add_f32_e64 v14, v14, v127
v_cvt_pk_bf16_f32 v207, v126, v127
s_waitcnt lgkmcnt(6)
s_nop 0
v_mfma_f32_32x32x16_bf16 v[128:143], v[224:227], v[204:207], v[128:143]
v_mov_b32 v17, v14
v_mov_b32 v18, v14
s_add_u32 s51, s44, 131072
s_waitcnt lgkmcnt(4)
v_mfma_f32_32x32x16_bf16 v[144:159], v[228:231], v[204:207], v[144:159]
s_add_u32 s52, s44, 135168
v_permlane32_swap_b32 v17, v18
s_lshr_b32 s53, s51, 3
s_waitcnt lgkmcnt(2)
v_mfma_f32_32x32x16_bf16 v[160:175], v[232:235], v[204:207], v[160:175]
s_add_u32 s53, s53, 33554432
v_add_f32 v17, v17, v18
v_max_f32 v17, 0x0da24260, v17
s_waitcnt lgkmcnt(0)
v_mfma_f32_32x32x16_bf16 v[176:191], v[236:239], v[204:207], v[176:191]
v_mov_b32 v30, s62
v_rcp_f32 v24, v17
v_mov_b32 v31, s62
v_mov_b32 v25, v24
s_barrier
s_cmp_eq_u64 s[6:7], 0
s_cbranch_scc1 LF48
v_pk_mul_f32 v[128:129], v[128:129], v[24:25]
v_pk_mul_f32 v[130:131], v[130:131], v[24:25]
v_pk_mul_f32 v[132:133], v[132:133], v[24:25]
v_pk_mul_f32 v[134:135], v[134:135], v[24:25]
v_cvt_pk_bf16_f32 v128, v128, v129
v_cvt_pk_bf16_f32 v129, v130, v131
s_nop 0
v_cvt_pk_bf16_f32 v130, v132, v133
v_cvt_pk_bf16_f32 v131, v134, v135
buffer_store_dwordx4 v[128:131], v19, s[28:31], s51 offen offset:0 nt
v_add3_u32 v28, v128, v129, s62
v_add3_u32 v28, v28, v130, v131
ds_write_b128 v20, v[128:131] offset:0
v_pk_mul_f32 v[136:137], v[136:137], v[24:25]
v_pk_mul_f32 v[138:139], v[138:139], v[24:25]
v_pk_mul_f32 v[140:141], v[140:141], v[24:25]
v_pk_mul_f32 v[142:143], v[142:143], v[24:25]
v_cvt_pk_bf16_f32 v136, v136, v137
v_cvt_pk_bf16_f32 v137, v138, v139
v_cvt_pk_bf16_f32 v138, v140, v141
v_cvt_pk_bf16_f32 v139, v142, v143
buffer_store_dwordx4 v[136:139], v19, s[28:31], s51 offen offset:1024 nt
v_add3_u32 v28, v28, v136, v137
v_add3_u32 v28, v28, v138, v139
ds_write_b128 v20, v[136:139] offset:1024
v_pk_mul_f32 v[144:145], v[144:145], v[24:25]
v_pk_mul_f32 v[146:147], v[146:147], v[24:25]
v_pk_mul_f32 v[148:149], v[148:149], v[24:25]
v_pk_mul_f32 v[150:151], v[150:151], v[24:25]
v_cvt_pk_bf16_f32 v144, v144, v145
v_cvt_pk_bf16_f32 v145, v146, v147
v_cvt_pk_bf16_f32 v146, v148, v149
v_cvt_pk_bf16_f32 v147, v150, v151
buffer_store_dwordx4 v[144:147], v19, s[28:31], s51 offen offset:2048 nt
v_add3_u32 v28, v28, v144, v145
v_add3_u32 v28, v28, v146, v147
ds_write_b128 v20, v[144:147] offset:2048
v_pk_mul_f32 v[152:153], v[152:153], v[24:25]
v_pk_mul_f32 v[154:155], v[154:155], v[24:25]
v_pk_mul_f32 v[156:157], v[156:157], v[24:25]
v_pk_mul_f32 v[158:159], v[158:159], v[24:25]
v_cvt_pk_bf16_f32 v152, v152, v153
v_cvt_pk_bf16_f32 v153, v154, v155
v_cvt_pk_bf16_f32 v154, v156, v157
v_cvt_pk_bf16_f32 v155, v158, v159
buffer_store_dwordx4 v[152:155], v19, s[28:31], s51 offen offset:3072 nt
v_add3_u32 v28, v28, v152, v153
v_add3_u32 v28, v28, v154, v155
ds_write_b128 v20, v[152:155] offset:3072
v_pk_mul_f32 v[160:161], v[160:161], v[24:25]
v_pk_mul_f32 v[162:163], v[162:163], v[24:25]
v_pk_mul_f32 v[164:165], v[164:165], v[24:25]
v_pk_mul_f32 v[166:167], v[166:167], v[24:25]
v_cvt_pk_bf16_f32 v160, v160, v161
v_cvt_pk_bf16_f32 v161, v162, v163
v_cvt_pk_bf16_f32 v162, v164, v165
v_cvt_pk_bf16_f32 v163, v166, v167
buffer_store_dwordx4 v[160:163], v19, s[28:31], s52 offen offset:0 nt
v_add3_u32 v29, v160, v161, s62
v_add3_u32 v29, v29, v162, v163
ds_write_b128 v20, v[160:163] offset:4096
v_pk_mul_f32 v[168:169], v[168:169], v[24:25]
v_pk_mul_f32 v[170:171], v[170:171], v[24:25]
v_pk_mul_f32 v[172:173], v[172:173], v[24:25]
v_pk_mul_f32 v[174:175], v[174:175], v[24:25]
v_cvt_pk_bf16_f32 v168, v168, v169
v_cvt_pk_bf16_f32 v169, v170, v171
v_cvt_pk_bf16_f32 v170, v172, v173
v_cvt_pk_bf16_f32 v171, v174, v175
buffer_store_dwordx4 v[168:171], v19, s[28:31], s52 offen offset:1024 nt
v_add3_u32 v29, v29, v168, v169
v_add3_u32 v29, v29, v170, v171
ds_write_b128 v20, v[168:171] offset:5120
v_pk_mul_f32 v[176:177], v[176:177], v[24:25]
v_pk_mul_f32 v[178:179], v[178:179], v[24:25]
v_pk_mul_f32 v[180:181], v[180:181], v[24:25]
v_pk_mul_f32 v[182:183], v[182:183], v[24:25]
v_cvt_pk_bf16_f32 v176, v176, v177
v_cvt_pk_bf16_f32 v177, v178, v179
v_cvt_pk_bf16_f32 v178, v180, v181
v_cvt_pk_bf16_f32 v179, v182, v183
buffer_store_dwordx4 v[176:179], v19, s[28:31], s52 offen offset:2048 nt
v_add3_u32 v29, v29, v176, v177
v_add3_u32 v29, v29, v178, v179
ds_write_b128 v20, v[176:179] offset:6144
v_pk_mul_f32 v[184:185], v[184:185], v[24:25]
v_pk_mul_f32 v[186:187], v[186:187], v[24:25]
v_pk_mul_f32 v[188:189], v[188:189], v[24:25]
v_pk_mul_f32 v[190:191], v[190:191], v[24:25]
v_cvt_pk_bf16_f32 v184, v184, v185
v_cvt_pk_bf16_f32 v185, v186, v187
v_cvt_pk_bf16_f32 v186, v188, v189
v_cvt_pk_bf16_f32 v187, v190, v191
buffer_store_dwordx4 v[184:187], v19, s[28:31], s52 offen offset:3072 nt
v_add3_u32 v29, v29, v184, v185
v_add3_u32 v29, v29, v186, v187
buffer_store_dwordx4 v[28:31], v19, s[28:31], s53 offen nt
LJ49:
ds_write_b128 v20, v[184:187] offset:7168
s_waitcnt lgkmcnt(0)
s_waitcnt lgkmcnt(0)
s_barrier
s_endpgm
L_pj:
v_lshrrev_b32 v23, 4, v1
v_and_b32 v24, 7, v1
v_xor_b32 v24, v23, v24
v_lshlrev_b32 v24, 4, v24
v_lshrrev_b32 v23, 3, v1
v_lshlrev_b32 v32, 10, v23
v_add_u32 v32, v32, v24
v_xor_b32 v33, 64, v32
v_lshrrev_b32 v23, 4, v1
v_lshlrev_b32 v25, 2, v23
v_and_b32 v24, 15, v1
v_xor_b32 v24, v25, v24
v_lshlrev_b32 v24, 4, v24
v_lshlrev_b32 v16, 13, v23
v_add_u32_e64 v16, v16, v24
s_barrier
s_add_u32 m0, s36, 32768
s_add_u32 s50, s39, 0
buffer_load_dwordx4 v32, s[20:23], s50 offen offset:0 lds
s_add_u32 s51, s39, 7168
buffer_load_dwordx4 v33, s[20:23], s51 offen offset:1024 lds
s_add_u32 s50, s39, 14336
buffer_load_dwordx4 v32, s[20:23], s50 offen offset:2048 lds
s_add_u32 s51, s39, 21504
buffer_load_dwordx4 v33, s[20:23], s51 offen offset:3072 lds
s_add_u32 m0, s36, 49152
s_add_u32 s50, s38, 0
s_nop 0
buffer_load_dwordx4 v16, s[16:19], s50 offen offset:0 lds
s_add_u32 s51, s38, 31744
buffer_load_dwordx4 v16, s[16:19], s51 offen offset:1024 lds
s_add_u32 s50, s38, 63488
buffer_load_dwordx4 v16, s[16:19], s50 offen offset:2048 lds
s_add_u32 s51, s38, 95232
buffer_load_dwordx4 v16, s[16:19], s51 offen offset:3072 lds
v_lshrrev_b32 v23, 4, v1
v_and_b32 v24, 15, v1
v_xor_b32 v24, v23, v24
v_lshlrev_b32 v24, 4, v24
v_lshlrev_b32 v11, 8, v23
v_add_u32 v11, v11, v24
v_xor_b32 v12, 64, v11
v_xor_b32 v13, 128, v11
v_xor_b32 v14, 192, v11
v_lshrrev_b32 v23, 4, v1
v_lshlrev_b32 v25, 2, v23
v_and_b32 v24, 15, v1
v_xor_b32 v24, v25, v24
v_lshlrev_b32 v24, 4, v24
v_lshlrev_b32 v15, 8, v23
v_add_u32 v15, v15, v24
v_lshrrev_b32 v23, 5, v1
v_lshlrev_b32 v2, 11, v23
v_bfe_u32 v23, v1, 2, 2
v_lshlrev_b32 v24, 8, v23
v_add_u32 v2, v2, v24
v_lshlrev_b32 v24, 6, v23
v_add_u32 v2, v2, v24
v_bfe_u32 v23, v1, 4, 1
v_lshlrev_b32 v24, 5, v23
v_add_u32 v2, v2, v24
v_and_b32 v23, 1, v1
v_lshlrev_b32 v24, 4, v23
v_add_u32_e64 v2, v2, v24
v_bfe_u32 v23, v1, 1, 1
v_lshlrev_b32 v24, 3, v23
v_add_u32 v2, v2, v24
v_xor_b32 v3, 64, v2
v_xor_b32 v4, 128, v2
v_xor_b32 v5, 192, v2
v_lshrrev_b32 v23, 5, v1
v_lshlrev_b32 v6, 10, v23
v_bfe_u32 v23, v1, 2, 2
v_lshlrev_b32 v24, 8, v23
v_add_u32 v6, v6, v24
v_lshlrev_b32 v24, 6, v23
v_add_u32 v6, v6, v24
v_bfe_u32 v23, v1, 4, 1
v_lshlrev_b32 v24, 5, v23
v_add_u32 v6, v6, v24
v_bfe_u32 v23, v1, 1, 1
v_lshlrev_b32 v24, 4, v23
v_add_u32 v6, v6, v24
v_and_b32 v23, 1, v1
v_lshlrev_b32 v24, 3, v23
v_add_u32 v6, v6, v24
v_xor_b32_e64 v7, 64, v6
v_xor_b32 v8, 128, v6
v_xor_b32 v9, 192, v6
v_and_b32 v23, 31, v1
v_lshlrev_b32 v10, 7, v23
v_bfe_u32 v24, v1, 1, 3
v_lshrrev_b32 v23, 5, v1
v_xor_b32 v23, v23, v24
v_lshlrev_b32 v23, 4, v23
v_add_u32 v10, v10, v23
v_add_u32 v10, s36, v10
v_lshrrev_b32 v23, 4, v1
v_lshlrev_b32 v25, 2, v23
v_and_b32 v24, 15, v1
v_xor_b32 v24, v25, v24
v_lshlrev_b32 v24, 4, v24
v_lshlrev_b32 v17, 10, v23
v_add_u32 v17, v17, v24
s_add_u32 m0, s36, 65536
s_add_u32 s50, s39, 128
buffer_load_dwordx4 v32, s[20:23], s50 offen offset:0 lds
s_add_u32 s51, s39, 7296
buffer_load_dwordx4 v33, s[20:23], s51 offen offset:1024 lds
s_add_u32 s50, s39, 14464
buffer_load_dwordx4 v32, s[20:23], s50 offen offset:2048 lds
s_add_u32 s51, s39, 21632
buffer_load_dwordx4 v33, s[20:23], s51 offen offset:3072 lds
s_add_u32 m0, s36, 81920
s_add_u32 s50, s38, 524288
buffer_load_dwordx4 v16, s[16:19], s50 offen offset:0 lds
s_add_u32 s51, s38, 556032
buffer_load_dwordx4 v16, s[16:19], s51 offen offset:1024 lds
s_add_u32 s50, s38, 587776
buffer_load_dwordx4 v16, s[16:19], s50 offen offset:2048 lds
s_add_u32 s51, s38, 619520
buffer_load_dwordx4 v16, s[16:19], s51 offen offset:3072 lds
v_lshlrev_b32 v18, 4, v1
s_lshl_b32 s52, s58, 13
s_add_u32 s52, s52, 98304
v_add_u32 v19, s52, v18
s_cmp_eq_u32 s58, 3
s_cselect_b32 s53, 0x40000000, 0
v_lshlrev_b32 v23, 26, v1
v_and_b32 v23, s53, v23
v_or_b32 v18, v18, v23
v_add_u32 v6, 0x18000, v6
v_add_u32 v7, 0x18000, v7
v_add_u32 v8, 0x18000, v8
v_add_u32 v9, 0x18000, v9
s_waitcnt vmcnt(12)
s_waitcnt vmcnt(8)
s_barrier
v_xor_b32 v25, 32, v10
v_xor_b32_e64 v26, 64, v10
v_xor_b32 v27, 96, v10
ds_read_b128 v[96:99], v10 offset:32768
ds_read_b128 v[100:103], v25 offset:32768
ds_read_b128 v[104:107], v26 offset:32768
ds_read_b128 v[108:111], v27 offset:32768
ds_read_b64_tr_b16 v[224:225], v2 offset:49152
ds_read_b64_tr_b16 v[226:227], v2 offset:50176
ds_read_b64_tr_b16 v[228:229], v3 offset:49152
ds_read_b64_tr_b16 v[230:231], v3 offset:50176
ds_read_b64_tr_b16 v[232:233], v4 offset:49152
ds_read_b64_tr_b16 v[234:235], v4 offset:50176
ds_read_b64_tr_b16 v[236:237], v5 offset:49152
ds_read_b64_tr_b16 v[238:239], v5 offset:50176
ds_read_b64_tr_b16 v[240:241], v2 offset:53248
ds_read_b64_tr_b16 v[242:243], v2 offset:54272
ds_read_b64_tr_b16 v[244:245], v3 offset:53248
ds_read_b64_tr_b16 v[246:247], v3 offset:54272
ds_read_b64_tr_b16 v[248:249], v4 offset:53248
ds_read_b64_tr_b16 v[250:251], v4 offset:54272
s_waitcnt lgkmcnt(10)
v_mfma_f32_32x32x16_bf16 v[32:47], v[224:227], v[96:99], 0
ds_read_b64_tr_b16 v[252:253], v5 offset:53248
ds_read_b64_tr_b16 v[254:255], v5 offset:54272
v_mfma_f32_32x32x16_bf16 v[48:63], v[228:231], v[96:99], 0
ds_read_b64_tr_b16 v[224:225], v2 offset:57344
s_nop 0
ds_read_b64_tr_b16 v[226:227], v2 offset:58368
s_waitcnt lgkmcnt(10)
v_mfma_f32_32x32x16_bf16 v[64:79], v[232:235], v[96:99], 0
ds_read_b64_tr_b16 v[228:229], v3 offset:57344
ds_read_b64_tr_b16 v[230:231], v3 offset:58368
v_mfma_f32_32x32x16_bf16 v[80:95], v[236:239], v[96:99], 0
ds_read_b64_tr_b16 v[232:233], v4 offset:57344
ds_read_b64_tr_b16 v[234:235], v4 offset:58368
s_waitcnt lgkmcnt(10)
v_mfma_f32_32x32x16_bf16 v[32:47], v[240:243], v[100:103], v[32:47]
ds_read_b64_tr_b16 v[236:237], v5 offset:57344
ds_read_b64_tr_b16 v[238:239], v5 offset:58368
v_mfma_f32_32x32x16_bf16 v[48:63], v[244:247], v[100:103], v[48:63]
ds_read_b64_tr_b16 v[240:241], v2 offset:61440
ds_read_b64_tr_b16 v[242:243], v2 offset:62464
s_waitcnt lgkmcnt(10)
v_mfma_f32_32x32x16_bf16 v[64:79], v[248:251], v[100:103], v[64:79]
s_nop 0
ds_read_b64_tr_b16 v[244:245], v3 offset:61440
ds_read_b64_tr_b16 v[246:247], v3 offset:62464
v_mfma_f32_32x32x16_bf16 v[80:95], v[252:255], v[100:103], v[80:95]
ds_read_b64_tr_b16 v[248:249], v4 offset:61440
ds_read_b64_tr_b16 v[250:251], v4 offset:62464
s_waitcnt lgkmcnt(10)
v_mfma_f32_32x32x16_bf16 v[32:47], v[224:227], v[104:107], v[32:47]
ds_read_b64_tr_b16 v[252:253], v5 offset:61440
s_nop 0
ds_read_b64_tr_b16 v[254:255], v5 offset:62464
v_mfma_f32_32x32x16_bf16 v[48:63], v[228:231], v[104:107], v[48:63]
s_waitcnt lgkmcnt(8)
v_mfma_f32_32x32x16_bf16 v[64:79], v[232:235], v[104:107], v[64:79]
v_mfma_f32_32x32x16_bf16 v[80:95], v[236:239], v[104:107], v[80:95]
s_waitcnt vmcnt(4)
s_waitcnt vmcnt(0)
s_waitcnt lgkmcnt(0)
s_barrier
v_add_u32 v10, 0x10000, v10
v_xor_b32 v25, 32, v10
v_xor_b32_e64 v26, 64, v10
v_xor_b32 v27, 96, v10
ds_read_b128 v[112:115], v10 offset:0
ds_read_b128 v[116:119], v25 offset:0
ds_read_b128 v[120:123], v26 offset:0
ds_read_b128 v[124:127], v27 offset:0
v_add_u32 v2, 0x10000, v2
v_add_u32 v3, 0x10000, v3
v_add_u32 v4, 0x10000, v4
v_add_u32 v5, 0x10000, v5
ds_read_b64_tr_b16 v[224:225], v2 offset:16384
ds_read_b64_tr_b16 v[226:227], v2 offset:17408
ds_read_b64_tr_b16 v[228:229], v3 offset:16384
ds_read_b64_tr_b16 v[230:231], v3 offset:17408
ds_read_b64_tr_b16 v[232:233], v4 offset:16384
ds_read_b64_tr_b16 v[234:235], v4 offset:17408
v_mfma_f32_32x32x16_bf16 v[32:47], v[240:243], v[108:111], v[32:47]
ds_read_b64_tr_b16 v[236:237], v5 offset:16384
ds_read_b64_tr_b16 v[238:239], v5 offset:17408
v_mfma_f32_32x32x16_bf16 v[48:63], v[244:247], v[108:111], v[48:63]
ds_read_b64_tr_b16 v[240:241], v2 offset:20480
ds_read_b64_tr_b16 v[242:243], v2 offset:21504
v_mfma_f32_32x32x16_bf16 v[64:79], v[248:251], v[108:111], v[64:79]
ds_read_b64_tr_b16 v[244:245], v3 offset:20480
ds_read_b64_tr_b16 v[246:247], v3 offset:21504
v_mfma_f32_32x32x16_bf16 v[80:95], v[252:255], v[108:111], v[80:95]
ds_read_b64_tr_b16 v[248:249], v4 offset:20480
ds_read_b64_tr_b16 v[250:251], v4 offset:21504
s_waitcnt lgkmcnt(10)
v_mfma_f32_32x32x16_bf16 v[32:47], v[224:227], v[112:115], v[32:47]
ds_read_b64_tr_b16 v[252:253], v5 offset:20480
ds_read_b64_tr_b16 v[254:255], v5 offset:21504
s_nop 0
v_mfma_f32_32x32x16_bf16 v[48:63], v[228:231], v[112:115], v[48:63]
ds_read_b64_tr_b16 v[224:225], v2 offset:24576
ds_read_b64_tr_b16 v[226:227], v2 offset:25600
s_waitcnt lgkmcnt(10)
v_mfma_f32_32x32x16_bf16 v[64:79], v[232:235], v[112:115], v[64:79]
ds_read_b64_tr_b16 v[228:229], v3 offset:24576
ds_read_b64_tr_b16 v[230:231], v3 offset:25600
v_mfma_f32_32x32x16_bf16 v[80:95], v[236:239], v[112:115], v[80:95]
s_nop 0
ds_read_b64_tr_b16 v[232:233], v4 offset:24576
ds_read_b64_tr_b16 v[234:235], v4 offset:25600
s_waitcnt lgkmcnt(10)
v_mfma_f32_32x32x16_bf16 v[32:47], v[240:243], v[116:119], v[32:47]
ds_read_b64_tr_b16 v[236:237], v5 offset:24576
ds_read_b64_tr_b16 v[238:239], v5 offset:25600
v_mfma_f32_32x32x16_bf16 v[48:63], v[244:247], v[116:119], v[48:63]
ds_read_b64_tr_b16 v[240:241], v2 offset:28672
s_nop 0
ds_read_b64_tr_b16 v[242:243], v2 offset:29696
s_waitcnt lgkmcnt(10)
v_mfma_f32_32x32x16_bf16 v[64:79], v[248:251], v[116:119], v[64:79]
ds_read_b64_tr_b16 v[244:245], v3 offset:28672
ds_read_b64_tr_b16 v[246:247], v3 offset:29696
v_mfma_f32_32x32x16_bf16 v[80:95], v[252:255], v[116:119], v[80:95]
ds_read_b64_tr_b16 v[248:249], v4 offset:28672
ds_read_b64_tr_b16 v[250:251], v4 offset:29696
s_waitcnt lgkmcnt(10)
v_mfma_f32_32x32x16_bf16 v[32:47], v[224:227], v[120:123], v[32:47]
ds_read_b64_tr_b16 v[252:253], v5 offset:28672
ds_read_b64_tr_b16 v[254:255], v5 offset:29696
v_mfma_f32_32x32x16_bf16 v[48:63], v[228:231], v[120:123], v[48:63]
s_waitcnt lgkmcnt(8)
v_mfma_f32_32x32x16_bf16 v[64:79], v[232:235], v[120:123], v[64:79]
v_mfma_f32_32x32x16_bf16 v[80:95], v[236:239], v[120:123], v[80:95]
s_waitcnt lgkmcnt(0)
s_barrier
v_xor_b32 v25, 32, v10
v_xor_b32_e64 v26, 64, v10
v_xor_b32 v27, 96, v10
ds_read_b128 v[128:131], v10 offset:32768
ds_read_b128 v[132:135], v25 offset:32768
ds_read_b128 v[136:139], v26 offset:32768
ds_read_b128 v[140:143], v27 offset:32768
ds_read_b64_tr_b16 v[224:225], v2 offset:49152
ds_read_b64_tr_b16 v[226:227], v2 offset:50176
ds_read_b64_tr_b16 v[228:229], v3 offset:49152
ds_read_b64_tr_b16 v[230:231], v3 offset:50176
ds_read_b64_tr_b16 v[232:233], v4 offset:49152
ds_read_b64_tr_b16 v[234:235], v4 offset:50176
v_mfma_f32_32x32x16_bf16 v[32:47], v[240:243], v[124:127], v[32:47]
ds_read_b64_tr_b16 v[236:237], v5 offset:49152
ds_read_b64_tr_b16 v[238:239], v5 offset:50176
v_mfma_f32_32x32x16_bf16 v[48:63], v[244:247], v[124:127], v[48:63]
ds_read_b64_tr_b16 v[240:241], v2 offset:53248
ds_read_b64_tr_b16 v[242:243], v2 offset:54272
v_mfma_f32_32x32x16_bf16 v[64:79], v[248:251], v[124:127], v[64:79]
ds_read_b64_tr_b16 v[244:245], v3 offset:53248
ds_read_b64_tr_b16 v[246:247], v3 offset:54272
v_mfma_f32_32x32x16_bf16 v[80:95], v[252:255], v[124:127], v[80:95]
ds_read_b64_tr_b16 v[248:249], v4 offset:53248
ds_read_b64_tr_b16 v[250:251], v4 offset:54272
s_waitcnt lgkmcnt(10)
v_mfma_f32_32x32x16_bf16 v[32:47], v[224:227], v[128:131], v[32:47]
ds_read_b64_tr_b16 v[252:253], v5 offset:53248
ds_read_b64_tr_b16 v[254:255], v5 offset:54272
v_mfma_f32_32x32x16_bf16 v[48:63], v[228:231], v[128:131], v[48:63]
ds_read_b64_tr_b16 v[224:225], v2 offset:57344
ds_read_b64_tr_b16 v[226:227], v2 offset:58368
s_waitcnt lgkmcnt(10)
v_mfma_f32_32x32x16_bf16 v[64:79], v[232:235], v[128:131], v[64:79]
ds_read_b64_tr_b16 v[228:229], v3 offset:57344
ds_read_b64_tr_b16 v[230:231], v3 offset:58368
v_mfma_f32_32x32x16_bf16 v[80:95], v[236:239], v[128:131], v[80:95]
ds_read_b64_tr_b16 v[232:233], v4 offset:57344
ds_read_b64_tr_b16 v[234:235], v4 offset:58368
s_waitcnt lgkmcnt(10)
v_mfma_f32_32x32x16_bf16 v[32:47], v[240:243], v[132:135], v[32:47]
ds_read_b64_tr_b16 v[236:237], v5 offset:57344
s_nop 0
ds_read_b64_tr_b16 v[238:239], v5 offset:58368
v_mfma_f32_32x32x16_bf16 v[48:63], v[244:247], v[132:135], v[48:63]
ds_read_b64_tr_b16 v[240:241], v2 offset:61440
ds_read_b64_tr_b16 v[242:243], v2 offset:62464
s_waitcnt lgkmcnt(10)
v_mfma_f32_32x32x16_bf16 v[64:79], v[248:251], v[132:135], v[64:79]
ds_read_b64_tr_b16 v[244:245], v3 offset:61440
ds_read_b64_tr_b16 v[246:247], v3 offset:62464
s_nop 0
v_mfma_f32_32x32x16_bf16 v[80:95], v[252:255], v[132:135], v[80:95]
ds_read_b64_tr_b16 v[248:249], v4 offset:61440
ds_read_b64_tr_b16 v[250:251], v4 offset:62464
s_waitcnt lgkmcnt(10)
v_mfma_f32_32x32x16_bf16 v[32:47], v[224:227], v[136:139], v[32:47]
ds_read_b64_tr_b16 v[252:253], v5 offset:61440
ds_read_b64_tr_b16 v[254:255], v5 offset:62464
v_mfma_f32_32x32x16_bf16 v[48:63], v[228:231], v[136:139], v[48:63]
s_waitcnt lgkmcnt(8)
v_mfma_f32_32x32x16_bf16 v[64:79], v[232:235], v[136:139], v[64:79]
v_mfma_f32_32x32x16_bf16 v[80:95], v[236:239], v[136:139], v[80:95]
s_waitcnt lgkmcnt(0)
s_barrier
v_add_u32 v10, 0x10000, v10
v_xor_b32 v25, 32, v10
v_xor_b32 v26, 64, v10
v_xor_b32 v27, 96, v10
ds_read_b128 v[144:147], v10 offset:0
ds_read_b128 v[148:151], v25 offset:0
ds_read_b128 v[152:155], v26 offset:0
ds_read_b128 v[156:159], v27 offset:0
v_add_u32 v2, 0x8000, v2
v_add_u32 v3, 0x8000, v3
v_add_u32 v4, 0x8000, v4
v_add_u32 v5, 0x8000, v5
ds_read_b64_tr_b16 v[224:225], v2 offset:49152
ds_read_b64_tr_b16 v[226:227], v2 offset:50176
ds_read_b64_tr_b16 v[228:229], v3 offset:49152
ds_read_b64_tr_b16 v[230:231], v3 offset:50176
ds_read_b64_tr_b16 v[232:233], v4 offset:49152
ds_read_b64_tr_b16 v[234:235], v4 offset:50176
v_mfma_f32_32x32x16_bf16 v[32:47], v[240:243], v[140:143], v[32:47]
ds_read_b64_tr_b16 v[236:237], v5 offset:49152
ds_read_b64_tr_b16 v[238:239], v5 offset:50176
v_mfma_f32_32x32x16_bf16 v[48:63], v[244:247], v[140:143], v[48:63]
ds_read_b64_tr_b16 v[240:241], v2 offset:53248
ds_read_b64_tr_b16 v[242:243], v2 offset:54272
v_mfma_f32_32x32x16_bf16 v[64:79], v[248:251], v[140:143], v[64:79]
ds_read_b64_tr_b16 v[244:245], v3 offset:53248
ds_read_b64_tr_b16 v[246:247], v3 offset:54272
v_mfma_f32_32x32x16_bf16 v[80:95], v[252:255], v[140:143], v[80:95]
ds_read_b64_tr_b16 v[248:249], v4 offset:53248
ds_read_b64_tr_b16 v[250:251], v4 offset:54272
s_waitcnt lgkmcnt(10)
v_mfma_f32_32x32x16_bf16 v[32:47], v[224:227], v[144:147], v[32:47]
ds_read_b64_tr_b16 v[252:253], v5 offset:53248
ds_read_b64_tr_b16 v[254:255], v5 offset:54272
v_mfma_f32_32x32x16_bf16 v[48:63], v[228:231], v[144:147], v[48:63]
ds_read_b64_tr_b16 v[224:225], v2 offset:57344
ds_read_b64_tr_b16 v[226:227], v2 offset:58368
s_waitcnt lgkmcnt(10)
v_mfma_f32_32x32x16_bf16 v[64:79], v[232:235], v[144:147], v[64:79]
ds_read_b64_tr_b16 v[228:229], v3 offset:57344
ds_read_b64_tr_b16 v[230:231], v3 offset:58368
v_mfma_f32_32x32x16_bf16 v[80:95], v[236:239], v[144:147], v[80:95]
ds_read_b64_tr_b16 v[232:233], v4 offset:57344
ds_read_b64_tr_b16 v[234:235], v4 offset:58368
s_waitcnt lgkmcnt(10)
v_mfma_f32_32x32x16_bf16 v[32:47], v[240:243], v[148:151], v[32:47]
ds_read_b64_tr_b16 v[236:237], v5 offset:57344
s_nop 0
ds_read_b64_tr_b16 v[238:239], v5 offset:58368
v_mfma_f32_32x32x16_bf16 v[48:63], v[244:247], v[148:151], v[48:63]
ds_read_b64_tr_b16 v[240:241], v2 offset:61440
ds_read_b64_tr_b16 v[242:243], v2 offset:62464
s_waitcnt lgkmcnt(10)
v_mfma_f32_32x32x16_bf16 v[64:79], v[248:251], v[148:151], v[64:79]
ds_read_b64_tr_b16 v[244:245], v3 offset:61440
ds_read_b64_tr_b16 v[246:247], v3 offset:62464
s_nop 0
v_mfma_f32_32x32x16_bf16 v[80:95], v[252:255], v[148:151], v[80:95]
ds_read_b64_tr_b16 v[248:249], v4 offset:61440
ds_read_b64_tr_b16 v[250:251], v4 offset:62464
s_waitcnt lgkmcnt(10)
v_mfma_f32_32x32x16_bf16 v[32:47], v[224:227], v[152:155], v[32:47]
ds_read_b64_tr_b16 v[252:253], v5 offset:61440
ds_read_b64_tr_b16 v[254:255], v5 offset:62464
v_mfma_f32_32x32x16_bf16 v[48:63], v[228:231], v[152:155], v[48:63]
s_waitcnt lgkmcnt(8)
v_mfma_f32_32x32x16_bf16 v[64:79], v[232:235], v[152:155], v[64:79]
v_mfma_f32_32x32x16_bf16 v[80:95], v[236:239], v[152:155], v[80:95]
s_waitcnt lgkmcnt(0)
s_barrier
v_subrev_u32 v10, 0x18000, v10
v_xor_b32 v25, 32, v10
v_xor_b32 v26, 64, v10
v_xor_b32 v27, 96, v10
ds_read_b128 v[160:163], v10 offset:0
ds_read_b128 v[164:167], v25 offset:0
ds_read_b128 v[168:171], v26 offset:0
ds_read_b128 v[172:175], v27 offset:0
v_subrev_u32 v2, 0x18000, v2
v_subrev_u32 v3, 0x18000, v3
v_subrev_u32 v4, 0x18000, v4
v_subrev_u32 v5, 0x18000, v5
ds_read_b64_tr_b16 v[224:225], v2 offset:49152
ds_read_b64_tr_b16 v[226:227], v2 offset:50176
ds_read_b64_tr_b16 v[228:229], v3 offset:49152
ds_read_b64_tr_b16 v[230:231], v3 offset:50176
ds_read_b64_tr_b16 v[232:233], v4 offset:49152
ds_read_b64_tr_b16 v[234:235], v4 offset:50176
v_mfma_f32_32x32x16_bf16 v[32:47], v[240:243], v[156:159], v[32:47]
ds_read_b64_tr_b16 v[236:237], v5 offset:49152
ds_read_b64_tr_b16 v[238:239], v5 offset:50176
v_mfma_f32_32x32x16_bf16 v[48:63], v[244:247], v[156:159], v[48:63]
ds_read_b64_tr_b16 v[240:241], v2 offset:53248
ds_read_b64_tr_b16 v[242:243], v2 offset:54272
v_mfma_f32_32x32x16_bf16 v[64:79], v[248:251], v[156:159], v[64:79]
ds_read_b64_tr_b16 v[244:245], v3 offset:53248
ds_read_b64_tr_b16 v[246:247], v3 offset:54272
v_mfma_f32_32x32x16_bf16 v[80:95], v[252:255], v[156:159], v[80:95]
ds_read_b64_tr_b16 v[248:249], v4 offset:53248
ds_read_b64_tr_b16 v[250:251], v4 offset:54272
s_waitcnt lgkmcnt(10)
v_mfma_f32_32x32x16_bf16 v[32:47], v[224:227], v[160:163], v[32:47]
ds_read_b64_tr_b16 v[252:253], v5 offset:53248
ds_read_b64_tr_b16 v[254:255], v5 offset:54272
v_mfma_f32_32x32x16_bf16 v[48:63], v[228:231], v[160:163], v[48:63]
ds_read_b64_tr_b16 v[224:225], v2 offset:57344
ds_read_b64_tr_b16 v[226:227], v2 offset:58368
s_waitcnt lgkmcnt(10)
v_mfma_f32_32x32x16_bf16 v[64:79], v[232:235], v[160:163], v[64:79]
ds_read_b64_tr_b16 v[228:229], v3 offset:57344
ds_read_b64_tr_b16 v[230:231], v3 offset:58368
v_mfma_f32_32x32x16_bf16 v[80:95], v[236:239], v[160:163], v[80:95]
ds_read_b64_tr_b16 v[232:233], v4 offset:57344
ds_read_b64_tr_b16 v[234:235], v4 offset:58368
s_waitcnt lgkmcnt(10)
v_mfma_f32_32x32x16_bf16 v[32:47], v[240:243], v[164:167], v[32:47]
ds_read_b64_tr_b16 v[236:237], v5 offset:57344
s_nop 0
ds_read_b64_tr_b16 v[238:239], v5 offset:58368
v_mfma_f32_32x32x16_bf16 v[48:63], v[244:247], v[164:167], v[48:63]
ds_read_b64_tr_b16 v[240:241], v2 offset:61440
ds_read_b64_tr_b16 v[242:243], v2 offset:62464
s_waitcnt lgkmcnt(10)
v_mfma_f32_32x32x16_bf16 v[64:79], v[248:251], v[164:167], v[64:79]
ds_read_b64_tr_b16 v[244:245], v3 offset:61440
ds_read_b64_tr_b16 v[246:247], v3 offset:62464
s_nop 0
v_mfma_f32_32x32x16_bf16 v[80:95], v[252:255], v[164:167], v[80:95]
ds_read_b64_tr_b16 v[248:249], v4 offset:61440
ds_read_b64_tr_b16 v[250:251], v4 offset:62464
s_waitcnt lgkmcnt(10)
v_mfma_f32_32x32x16_bf16 v[32:47], v[224:227], v[168:171], v[32:47]
ds_read_b64_tr_b16 v[252:253], v5 offset:61440
ds_read_b64_tr_b16 v[254:255], v5 offset:62464
v_mfma_f32_32x32x16_bf16 v[48:63], v[228:231], v[168:171], v[48:63]
s_waitcnt lgkmcnt(8)
v_mfma_f32_32x32x16_bf16 v[64:79], v[232:235], v[168:171], v[64:79]
v_mfma_f32_32x32x16_bf16 v[80:95], v[236:239], v[168:171], v[80:95]
s_waitcnt lgkmcnt(0)
s_barrier
v_xor_b32 v25, 32, v10
v_xor_b32 v26, 64, v10
v_xor_b32 v27, 96, v10
ds_read_b128 v[176:179], v10 offset:32768
ds_read_b128 v[180:183], v25 offset:32768
ds_read_b128 v[184:187], v26 offset:32768
ds_read_b128 v[188:191], v27 offset:32768
v_add_u32 v2, 0x10000, v2
v_add_u32 v3, 0x10000, v3
v_add_u32 v4, 0x10000, v4
v_add_u32 v5, 0x10000, v5
ds_read_b64_tr_b16 v[224:225], v2 offset:16384
ds_read_b64_tr_b16 v[226:227], v2 offset:17408
ds_read_b64_tr_b16 v[228:229], v3 offset:16384
ds_read_b64_tr_b16 v[230:231], v3 offset:17408
ds_read_b64_tr_b16 v[232:233], v4 offset:16384
ds_read_b64_tr_b16 v[234:235], v4 offset:17408
v_mfma_f32_32x32x16_bf16 v[32:47], v[240:243], v[172:175], v[32:47]
ds_read_b64_tr_b16 v[236:237], v5 offset:16384
ds_read_b64_tr_b16 v[238:239], v5 offset:17408
v_mfma_f32_32x32x16_bf16 v[48:63], v[244:247], v[172:175], v[48:63]
ds_read_b64_tr_b16 v[240:241], v2 offset:20480
ds_read_b64_tr_b16 v[242:243], v2 offset:21504
v_mfma_f32_32x32x16_bf16 v[64:79], v[248:251], v[172:175], v[64:79]
ds_read_b64_tr_b16 v[244:245], v3 offset:20480
ds_read_b64_tr_b16 v[246:247], v3 offset:21504
v_mfma_f32_32x32x16_bf16 v[80:95], v[252:255], v[172:175], v[80:95]
ds_read_b64_tr_b16 v[248:249], v4 offset:20480
ds_read_b64_tr_b16 v[250:251], v4 offset:21504
s_waitcnt lgkmcnt(10)
s_nop 0
v_mfma_f32_32x32x16_bf16 v[32:47], v[224:227], v[176:179], v[32:47]
ds_read_b64_tr_b16 v[252:253], v5 offset:20480
ds_read_b64_tr_b16 v[254:255], v5 offset:21504
v_mfma_f32_32x32x16_bf16 v[48:63], v[228:231], v[176:179], v[48:63]
ds_read_b64_tr_b16 v[224:225], v2 offset:24576
ds_read_b64_tr_b16 v[226:227], v2 offset:25600
s_waitcnt lgkmcnt(10)
v_mfma_f32_32x32x16_bf16 v[64:79], v[232:235], v[176:179], v[64:79]
s_nop 0
ds_read_b64_tr_b16 v[228:229], v3 offset:24576
ds_read_b64_tr_b16 v[230:231], v3 offset:25600
v_mfma_f32_32x32x16_bf16 v[80:95], v[236:239], v[176:179], v[80:95]
ds_read_b64_tr_b16 v[232:233], v4 offset:24576
ds_read_b64_tr_b16 v[234:235], v4 offset:25600
s_waitcnt lgkmcnt(10)
v_mfma_f32_32x32x16_bf16 v[32:47], v[240:243], v[180:183], v[32:47]
ds_read_b64_tr_b16 v[236:237], v5 offset:24576
s_nop 0
ds_read_b64_tr_b16 v[238:239], v5 offset:25600
v_mfma_f32_32x32x16_bf16 v[48:63], v[244:247], v[180:183], v[48:63]
ds_read_b64_tr_b16 v[240:241], v2 offset:28672
ds_read_b64_tr_b16 v[242:243], v2 offset:29696
s_waitcnt lgkmcnt(10)
v_mfma_f32_32x32x16_bf16 v[64:79], v[248:251], v[180:183], v[64:79]
ds_read_b64_tr_b16 v[244:245], v3 offset:28672
ds_read_b64_tr_b16 v[246:247], v3 offset:29696
s_nop 0
v_mfma_f32_32x32x16_bf16 v[80:95], v[252:255], v[180:183], v[80:95]
ds_read_b64_tr_b16 v[248:249], v4 offset:28672
ds_read_b64_tr_b16 v[250:251], v4 offset:29696
s_waitcnt lgkmcnt(10)
v_mfma_f32_32x32x16_bf16 v[32:47], v[224:227], v[184:187], v[32:47]
ds_read_b64_tr_b16 v[252:253], v5 offset:28672
ds_read_b64_tr_b16 v[254:255], v5 offset:29696
v_mfma_f32_32x32x16_bf16 v[48:63], v[228:231], v[184:187], v[48:63]
s_waitcnt lgkmcnt(8)
v_mfma_f32_32x32x16_bf16 v[64:79], v[232:235], v[184:187], v[64:79]
v_mfma_f32_32x32x16_bf16 v[80:95], v[236:239], v[184:187], v[80:95]
s_waitcnt lgkmcnt(0)
s_barrier
v_add_u32 v10, 0x10000, v10
v_xor_b32 v25, 32, v10
v_xor_b32 v26, 64, v10
v_xor_b32 v27, 96, v10
ds_read_b128 v[192:195], v10 offset:0
ds_read_b128 v[196:199], v25 offset:0
ds_read_b128 v[200:203], v26 offset:0
ds_read_b128 v[204:207], v27 offset:0
ds_read_b64_tr_b16 v[224:225], v2 offset:49152
ds_read_b64_tr_b16 v[226:227], v2 offset:50176
ds_read_b64_tr_b16 v[228:229], v3 offset:49152
ds_read_b64_tr_b16 v[230:231], v3 offset:50176
ds_read_b64_tr_b16 v[232:233], v4 offset:49152
ds_read_b64_tr_b16 v[234:235], v4 offset:50176
v_mfma_f32_32x32x16_bf16 v[32:47], v[240:243], v[188:191], v[32:47]
ds_read_b64_tr_b16 v[236:237], v5 offset:49152
ds_read_b64_tr_b16 v[238:239], v5 offset:50176
v_mfma_f32_32x32x16_bf16 v[48:63], v[244:247], v[188:191], v[48:63]
ds_read_b64_tr_b16 v[240:241], v2 offset:53248
ds_read_b64_tr_b16 v[242:243], v2 offset:54272
v_mfma_f32_32x32x16_bf16 v[64:79], v[248:251], v[188:191], v[64:79]
ds_read_b64_tr_b16 v[244:245], v3 offset:53248
ds_read_b64_tr_b16 v[246:247], v3 offset:54272
v_mfma_f32_32x32x16_bf16 v[80:95], v[252:255], v[188:191], v[80:95]
ds_read_b64_tr_b16 v[248:249], v4 offset:53248
ds_read_b64_tr_b16 v[250:251], v4 offset:54272
s_waitcnt lgkmcnt(10)
v_mfma_f32_32x32x16_bf16 v[32:47], v[224:227], v[192:195], v[32:47]
ds_read_b64_tr_b16 v[252:253], v5 offset:53248
ds_read_b64_tr_b16 v[254:255], v5 offset:54272
s_nop 0
v_mfma_f32_32x32x16_bf16 v[48:63], v[228:231], v[192:195], v[48:63]
ds_read_b64_tr_b16 v[224:225], v2 offset:57344
ds_read_b64_tr_b16 v[226:227], v2 offset:58368
s_waitcnt lgkmcnt(10)
v_mfma_f32_32x32x16_bf16 v[64:79], v[232:235], v[192:195], v[64:79]
ds_read_b64_tr_b16 v[228:229], v3 offset:57344
ds_read_b64_tr_b16 v[230:231], v3 offset:58368
v_mfma_f32_32x32x16_bf16 v[80:95], v[236:239], v[192:195], v[80:95]
s_nop 0
ds_read_b64_tr_b16 v[232:233], v4 offset:57344
ds_read_b64_tr_b16 v[234:235], v4 offset:58368
s_waitcnt lgkmcnt(10)
v_mfma_f32_32x32x16_bf16 v[32:47], v[240:243], v[196:199], v[32:47]
ds_read_b64_tr_b16 v[236:237], v5 offset:57344
ds_read_b64_tr_b16 v[238:239], v5 offset:58368
v_mfma_f32_32x32x16_bf16 v[48:63], v[244:247], v[196:199], v[48:63]
ds_read_b64_tr_b16 v[240:241], v2 offset:61440
s_nop 0
ds_read_b64_tr_b16 v[242:243], v2 offset:62464
s_waitcnt lgkmcnt(10)
v_mfma_f32_32x32x16_bf16 v[64:79], v[248:251], v[196:199], v[64:79]
ds_read_b64_tr_b16 v[244:245], v3 offset:61440
ds_read_b64_tr_b16 v[246:247], v3 offset:62464
v_mfma_f32_32x32x16_bf16 v[80:95], v[252:255], v[196:199], v[80:95]
ds_read_b64_tr_b16 v[248:249], v4 offset:61440
ds_read_b64_tr_b16 v[250:251], v4 offset:62464
s_waitcnt lgkmcnt(10)
v_mfma_f32_32x32x16_bf16 v[32:47], v[224:227], v[200:203], v[32:47]
ds_read_b64_tr_b16 v[252:253], v5 offset:61440
ds_read_b64_tr_b16 v[254:255], v5 offset:62464
v_mfma_f32_32x32x16_bf16 v[48:63], v[228:231], v[200:203], v[48:63]
s_waitcnt lgkmcnt(8)
v_mfma_f32_32x32x16_bf16 v[64:79], v[232:235], v[200:203], v[64:79]
v_mfma_f32_32x32x16_bf16 v[80:95], v[236:239], v[200:203], v[80:95]
s_waitcnt lgkmcnt(0)
s_barrier
v_mov_b32 v24, s49
v_xor_b32 v25, 32, v10
v_xor_b32 v26, 64, v10
v_xor_b32 v27, 96, v10
ds_read_b128 v[208:211], v10 offset:32768
ds_read_b128 v[212:215], v25 offset:32768
ds_read_b128 v[216:219], v26 offset:32768
ds_read_b128 v[220:223], v27 offset:32768
v_add_u32 v2, 0x8000, v2
v_add_u32 v3, 0x8000, v3
v_add_u32 v4, 0x8000, v4
v_add_u32 v5, 0x8000, v5
ds_read_b64_tr_b16 v[224:225], v2 offset:49152
ds_read_b64_tr_b16 v[226:227], v2 offset:50176
ds_read_b64_tr_b16 v[228:229], v2 offset:53248
ds_read_b64_tr_b16 v[230:231], v2 offset:54272
ds_read_b64_tr_b16 v[232:233], v2 offset:57344
ds_read_b64_tr_b16 v[234:235], v2 offset:58368
v_mfma_f32_32x32x16_bf16 v[32:47], v[240:243], v[204:207], v[32:47]
ds_read_b64_tr_b16 v[236:237], v2 offset:61440
ds_read_b64_tr_b16 v[238:239], v2 offset:62464
v_mfma_f32_32x32x16_bf16 v[48:63], v[244:247], v[204:207], v[48:63]
ds_read_b64_tr_b16 v[240:241], v3 offset:49152
ds_read_b64_tr_b16 v[242:243], v3 offset:50176
v_mfma_f32_32x32x16_bf16 v[64:79], v[248:251], v[204:207], v[64:79]
ds_read_b64_tr_b16 v[244:245], v3 offset:53248
ds_read_b64_tr_b16 v[246:247], v3 offset:54272
v_mfma_f32_32x32x16_bf16 v[80:95], v[252:255], v[204:207], v[80:95]
ds_read_b64_tr_b16 v[248:249], v3 offset:57344
ds_read_b64_tr_b16 v[250:251], v3 offset:58368
s_waitcnt lgkmcnt(10)
v_mfma_f32_32x32x16_bf16 v[32:47], v[224:227], v[208:211], v[32:47]
ds_read_b64_tr_b16 v[252:253], v3 offset:61440
ds_read_b64_tr_b16 v[254:255], v3 offset:62464
s_nop 0
v_mfma_f32_32x32x16_bf16 v[32:47], v[228:231], v[212:215], v[32:47]
ds_read_b64_tr_b16 v[224:225], v4 offset:49152
ds_read_b64_tr_b16 v[226:227], v4 offset:50176
s_waitcnt lgkmcnt(10)
v_mfma_f32_32x32x16_bf16 v[32:47], v[232:235], v[216:219], v[32:47]
ds_read_b64_tr_b16 v[228:229], v4 offset:53248
ds_read_b64_tr_b16 v[230:231], v4 offset:54272
v_mfma_f32_32x32x16_bf16 v[32:47], v[236:239], v[220:223], v[32:47]
s_nop 0
ds_read_b64_tr_b16 v[232:233], v4 offset:57344
ds_read_b64_tr_b16 v[234:235], v4 offset:58368
s_waitcnt lgkmcnt(10)
v_mfma_f32_32x32x16_bf16 v[48:63], v[240:243], v[208:211], v[48:63]
ds_read_b64_tr_b16 v[236:237], v4 offset:61440
ds_read_b64_tr_b16 v[238:239], v4 offset:62464
v_mfma_f32_32x32x16_bf16 v[48:63], v[244:247], v[212:215], v[48:63]
ds_read_b64_tr_b16 v[240:241], v5 offset:49152
s_nop 0
ds_read_b64_tr_b16 v[242:243], v5 offset:50176
s_nop 2
v_pk_mul_f32 v[32:33], v[32:33], v[24:25] op_sel_hi:[1,0]
v_pk_mul_f32 v[34:35], v[34:35], v[24:25] op_sel_hi:[1,0]
v_pk_mul_f32 v[36:37], v[36:37], v[24:25] op_sel_hi:[1,0]
v_pk_mul_f32 v[38:39], v[38:39], v[24:25] op_sel_hi:[1,0]
s_waitcnt lgkmcnt(10)
v_mfma_f32_32x32x16_bf16 v[48:63], v[248:251], v[216:219], v[48:63]
ds_read_b64_tr_b16 v[244:245], v5 offset:53248
ds_read_b64_tr_b16 v[246:247], v5 offset:54272
v_cvt_pk_bf16_f32 v32, v32, v33
v_cvt_pk_bf16_f32 v33, v34, v35
v_cvt_pk_bf16_f32 v34, v36, v37
v_cvt_pk_bf16_f32 v35, v38, v39
ds_write_b128 v19, v[32:35] offset:0
v_mfma_f32_32x32x16_bf16 v[48:63], v[252:255], v[220:223], v[48:63]
ds_read_b64_tr_b16 v[248:249], v5 offset:57344
ds_read_b64_tr_b16 v[250:251], v5 offset:58368
v_pk_mul_f32 v[40:41], v[40:41], v[24:25] op_sel_hi:[1,0]
v_pk_mul_f32 v[42:43], v[42:43], v[24:25] op_sel_hi:[1,0]
v_pk_mul_f32 v[44:45], v[44:45], v[24:25] op_sel_hi:[1,0]
v_pk_mul_f32 v[46:47], v[46:47], v[24:25] op_sel_hi:[1,0]
s_waitcnt lgkmcnt(11)
v_mfma_f32_32x32x16_bf16 v[64:79], v[224:227], v[208:211], v[64:79]
ds_read_b64_tr_b16 v[252:253], v5 offset:61440
s_nop 0
ds_read_b64_tr_b16 v[254:255], v5 offset:62464
v_cvt_pk_bf16_f32 v40, v40, v41
v_cvt_pk_bf16_f32 v41, v42, v43
v_cvt_pk_bf16_f32 v42, v44, v45
v_cvt_pk_bf16_f32 v43, v46, v47
ds_write_b128 v19, v[40:43] offset:1024
v_mfma_f32_32x32x16_bf16 v[64:79], v[228:231], v[212:215], v[64:79]
v_pk_mul_f32 v[48:49], v[48:49], v[24:25] op_sel_hi:[1,0]
v_pk_mul_f32 v[50:51], v[50:51], v[24:25] op_sel_hi:[1,0]
v_pk_mul_f32 v[52:53], v[52:53], v[24:25] op_sel_hi:[1,0]
v_pk_mul_f32 v[54:55], v[54:55], v[24:25] op_sel_hi:[1,0]
s_waitcnt lgkmcnt(10)
v_mfma_f32_32x32x16_bf16 v[64:79], v[232:235], v[216:219], v[64:79]
v_cvt_pk_bf16_f32 v48, v48, v49
v_cvt_pk_bf16_f32 v49, v50, v51
v_cvt_pk_bf16_f32 v50, v52, v53
s_nop 0
v_cvt_pk_bf16_f32 v51, v54, v55
ds_write_b128 v19, v[48:51] offset:2048
v_mfma_f32_32x32x16_bf16 v[64:79], v[236:239], v[220:223], v[64:79]
v_pk_mul_f32 v[56:57], v[56:57], v[24:25] op_sel_hi:[1,0]
v_pk_mul_f32 v[58:59], v[58:59], v[24:25] op_sel_hi:[1,0]
v_pk_mul_f32 v[60:61], v[60:61], v[24:25] op_sel_hi:[1,0]
v_pk_mul_f32 v[62:63], v[62:63], v[24:25] op_sel_hi:[1,0]
s_waitcnt lgkmcnt(7)
s_nop 0
v_mfma_f32_32x32x16_bf16 v[80:95], v[240:243], v[208:211], v[80:95]
v_cvt_pk_bf16_f32 v56, v56, v57
v_cvt_pk_bf16_f32 v57, v58, v59
v_cvt_pk_bf16_f32 v58, v60, v61
v_cvt_pk_bf16_f32 v59, v62, v63
ds_write_b128 v19, v[56:59] offset:3072
v_mfma_f32_32x32x16_bf16 v[80:95], v[244:247], v[212:215], v[80:95]
v_pk_mul_f32 v[64:65], v[64:65], v[24:25] op_sel_hi:[1,0]
v_pk_mul_f32 v[66:67], v[66:67], v[24:25] op_sel_hi:[1,0]
v_pk_mul_f32 v[68:69], v[68:69], v[24:25] op_sel_hi:[1,0]
v_pk_mul_f32 v[70:71], v[70:71], v[24:25] op_sel_hi:[1,0]
s_waitcnt lgkmcnt(5)
v_mfma_f32_32x32x16_bf16 v[80:95], v[248:251], v[216:219], v[80:95]
v_cvt_pk_bf16_f32 v64, v64, v65
v_cvt_pk_bf16_f32 v65, v66, v67
v_cvt_pk_bf16_f32 v66, v68, v69
s_nop 0
v_cvt_pk_bf16_f32 v67, v70, v71
ds_write_b128 v19, v[64:67] offset:4096
s_waitcnt lgkmcnt(4)
v_mfma_f32_32x32x16_bf16 v[80:95], v[252:255], v[220:223], v[80:95]
v_pk_mul_f32 v[72:73], v[72:73], v[24:25] op_sel_hi:[1,0]
v_pk_mul_f32 v[74:75], v[74:75], v[24:25] op_sel_hi:[1,0]
v_pk_mul_f32 v[76:77], v[76:77], v[24:25] op_sel_hi:[1,0]
v_pk_mul_f32 v[78:79], v[78:79], v[24:25] op_sel_hi:[1,0]
s_nop 0
v_cvt_pk_bf16_f32 v72, v72, v73
v_cvt_pk_bf16_f32 v73, v74, v75
v_cvt_pk_bf16_f32 v74, v76, v77
v_cvt_pk_bf16_f32 v75, v78, v79
ds_write_b128 v19, v[72:75] offset:5120
s_nop 2
v_pk_mul_f32 v[80:81], v[80:81], v[24:25] op_sel_hi:[1,0]
v_pk_mul_f32 v[82:83], v[82:83], v[24:25] op_sel_hi:[1,0]
s_nop 0
v_pk_mul_f32 v[84:85], v[84:85], v[24:25] op_sel_hi:[1,0]
v_pk_mul_f32 v[86:87], v[86:87], v[24:25] op_sel_hi:[1,0]
v_cvt_pk_bf16_f32 v80, v80, v81
v_cvt_pk_bf16_f32 v81, v82, v83
v_cvt_pk_bf16_f32 v82, v84, v85
v_cvt_pk_bf16_f32 v83, v86, v87
ds_write_b128 v19, v[80:83] offset:6144
v_pk_mul_f32 v[88:89], v[88:89], v[24:25] op_sel_hi:[1,0]
v_pk_mul_f32 v[90:91], v[90:91], v[24:25] op_sel_hi:[1,0]
v_pk_mul_f32 v[92:93], v[92:93], v[24:25] op_sel_hi:[1,0]
v_pk_mul_f32 v[94:95], v[94:95], v[24:25] op_sel_hi:[1,0]
v_cvt_pk_bf16_f32 v88, v88, v89
v_cvt_pk_bf16_f32 v89, v90, v91
v_cvt_pk_bf16_f32 v90, v92, v93
v_cvt_pk_bf16_f32 v91, v94, v95
ds_write_b128 v19, v[88:91] offset:7168
s_waitcnt lgkmcnt(0)
s_barrier
s_add_u32 m0, s36, 131072
s_add_u32 s50, s38, 256
buffer_load_dwordx4 v16, s[16:19], s50 offen offset:0 lds
s_add_u32 s51, s38, 32000
buffer_load_dwordx4 v16, s[16:19], s51 offen offset:1024 lds
s_add_u32 s50, s38, 63744
buffer_load_dwordx4 v16, s[16:19], s50 offen offset:2048 lds
s_add_u32 s51, s38, 95488
buffer_load_dwordx4 v16, s[16:19], s51 offen offset:3072 lds
s_add_u32 m0, s36, 147456
s_add_u32 s50, s38, 524544
buffer_load_dwordx4 v16, s[16:19], s50 offen offset:0 lds
s_add_u32 s51, s38, 556288
buffer_load_dwordx4 v16, s[16:19], s51 offen offset:1024 lds
s_add_u32 s50, s38, 588032
buffer_load_dwordx4 v16, s[16:19], s50 offen offset:2048 lds
s_add_u32 s51, s38, 619776
buffer_load_dwordx4 v16, s[16:19], s51 offen offset:3072 lds
s_barrier
s_add_u32 s50, s37, 16384
s_add_u32 m0, s36, 65536
s_nop 0
buffer_load_dwordx4 v15, s[12:15], s50 offen offset:0 nt lds
buffer_load_dwordx4 v15, s[12:15], s50 offen offset:1024 nt lds
buffer_load_dwordx4 v15, s[12:15], s50 offen offset:2048 nt lds
buffer_load_dwordx4 v15, s[12:15], s50 offen offset:3072 nt lds
s_add_u32 s50, s37, 49152
s_add_u32 m0, s36, 0
s_nop 0
buffer_load_dwordx4 v11, s[8:11], s50 offen offset:0 nt lds
buffer_load_dwordx4 v12, s[8:11], s50 offen offset:1024 nt lds
buffer_load_dwordx4 v13, s[8:11], s50 offen offset:2048 nt lds
buffer_load_dwordx4 v14, s[8:11], s50 offen offset:3072 nt lds
s_waitcnt vmcnt(12)
s_barrier
ds_read_b64_tr_b16 v[224:225], v2 offset:32768
ds_read_b64_tr_b16 v[226:227], v2 offset:33792
ds_read_b64_tr_b16 v[228:229], v3 offset:32768
ds_read_b64_tr_b16 v[230:231], v3 offset:33792
ds_read_b64_tr_b16 v[232:233], v4 offset:32768
ds_read_b64_tr_b16 v[234:235], v4 offset:33792
ds_read_b64_tr_b16 v[236:237], v5 offset:32768
ds_read_b64_tr_b16 v[238:239], v5 offset:33792
ds_read_b64_tr_b16 v[240:241], v2 offset:36864
ds_read_b64_tr_b16 v[242:243], v2 offset:37888
ds_read_b64_tr_b16 v[244:245], v3 offset:36864
ds_read_b64_tr_b16 v[246:247], v3 offset:37888
ds_read_b64_tr_b16 v[248:249], v4 offset:36864
ds_read_b64_tr_b16 v[250:251], v4 offset:37888
s_add_u32 m0, s36, 98304
s_add_u32 s50, s38, 1048832
buffer_load_dwordx4 v16, s[16:19], s50 offen offset:0 lds
s_add_u32 s51, s38, 1080576
buffer_load_dwordx4 v16, s[16:19], s51 offen offset:1024 lds
s_waitcnt lgkmcnt(10)
v_mfma_f32_32x32x16_bf16 v[32:47], v[224:227], v[96:99], 0
ds_read_b64_tr_b16 v[252:253], v5 offset:36864
ds_read_b64_tr_b16 v[254:255], v5 offset:37888
s_nop 0
s_add_u32 s50, s38, 1112320
buffer_load_dwordx4 v16, s[16:19], s50 offen offset:2048 lds
v_mfma_f32_32x32x16_bf16 v[48:63], v[228:231], v[96:99], 0
ds_read_b64_tr_b16 v[224:225], v2 offset:40960
ds_read_b64_tr_b16 v[226:227], v2 offset:41984
s_add_u32 s51, s38, 1144064
buffer_load_dwordx4 v16, s[16:19], s51 offen offset:3072 lds
s_waitcnt lgkmcnt(10)
s_nop 0
v_mfma_f32_32x32x16_bf16 v[64:79], v[232:235], v[96:99], 0
ds_read_b64_tr_b16 v[228:229], v3 offset:40960
ds_read_b64_tr_b16 v[230:231], v3 offset:41984
s_add_u32 m0, s36, 114688
s_add_u32 s50, s38, 1573120
buffer_load_dwordx4 v16, s[16:19], s50 offen offset:0 lds
v_mfma_f32_32x32x16_bf16 v[80:95], v[236:239], v[96:99], 0
ds_read_b64_tr_b16 v[232:233], v4 offset:40960
ds_read_b64_tr_b16 v[234:235], v4 offset:41984
s_add_u32 s51, s38, 1604864
buffer_load_dwordx4 v16, s[16:19], s51 offen offset:1024 lds
s_waitcnt lgkmcnt(10)
v_mfma_f32_32x32x16_bf16 v[32:47], v[240:243], v[100:103], v[32:47]
ds_read_b64_tr_b16 v[236:237], v5 offset:40960
ds_read_b64_tr_b16 v[238:239], v5 offset:41984
s_add_u32 s50, s38, 1636608
s_nop 0
buffer_load_dwordx4 v16, s[16:19], s50 offen offset:2048 lds
v_mfma_f32_32x32x16_bf16 v[48:63], v[244:247], v[100:103], v[48:63]
s_add_u32 s51, s38, 1668352
buffer_load_dwordx4 v16, s[16:19], s51 offen offset:3072 lds
s_waitcnt lgkmcnt(8)
v_mfma_f32_32x32x16_bf16 v[64:79], v[248:251], v[100:103], v[64:79]
v_mfma_f32_32x32x16_bf16 v[80:95], v[252:255], v[100:103], v[80:95]
s_waitcnt vmcnt(16)
s_waitcnt lgkmcnt(0)
s_barrier
ds_read_b64_tr_b16 v[240:241], v2 offset:45056
ds_read_b64_tr_b16 v[242:243], v2 offset:46080
ds_read_b64_tr_b16 v[244:245], v3 offset:45056
ds_read_b64_tr_b16 v[246:247], v3 offset:46080
ds_read_b64_tr_b16 v[248:249], v4 offset:45056
ds_read_b64_tr_b16 v[250:251], v4 offset:46080
s_add_u32 s50, s37, 32768
s_add_u32 m0, s36, 81920
s_nop 0
buffer_load_dwordx4 v15, s[12:15], s50 offen offset:0 nt lds
buffer_load_dwordx4 v15, s[12:15], s50 offen offset:1024 nt lds
v_mfma_f32_32x32x16_bf16 v[32:47], v[224:227], v[104:107], v[32:47]
ds_read_b64_tr_b16 v[252:253], v5 offset:45056
ds_read_b64_tr_b16 v[254:255], v5 offset:46080
buffer_load_dwordx4 v15, s[12:15], s50 offen offset:2048 nt lds
v_mfma_f32_32x32x16_bf16 v[48:63], v[228:231], v[104:107], v[48:63]
s_nop 0
ds_read_b64_tr_b16 v[224:225], v2 offset:49152
ds_read_b64_tr_b16 v[226:227], v2 offset:50176
buffer_load_dwordx4 v15, s[12:15], s50 offen offset:3072 nt lds
v_mfma_f32_32x32x16_bf16 v[64:79], v[232:235], v[104:107], v[64:79]
ds_read_b64_tr_b16 v[228:229], v3 offset:49152
ds_read_b64_tr_b16 v[230:231], v3 offset:50176
s_add_u32 s50, s37, 65536
s_add_u32 m0, s36, 16384
s_nop 0
buffer_load_dwordx4 v11, s[8:11], s50 offen offset:0 nt lds
v_mfma_f32_32x32x16_bf16 v[80:95], v[236:239], v[104:107], v[80:95]
ds_read_b64_tr_b16 v[232:233], v4 offset:49152
ds_read_b64_tr_b16 v[234:235], v4 offset:50176
buffer_load_dwordx4 v12, s[8:11], s50 offen offset:1024 nt lds
s_waitcnt lgkmcnt(10)
v_mfma_f32_32x32x16_bf16 v[32:47], v[240:243], v[108:111], v[32:47]
ds_read_b64_tr_b16 v[236:237], v5 offset:49152
ds_read_b64_tr_b16 v[238:239], v5 offset:50176
buffer_load_dwordx4 v13, s[8:11], s50 offen offset:2048 nt lds
v_mfma_f32_32x32x16_bf16 v[48:63], v[244:247], v[108:111], v[48:63]
ds_read_b64_tr_b16 v[240:241], v2 offset:53248
ds_read_b64_tr_b16 v[242:243], v2 offset:54272
buffer_load_dwordx4 v14, s[8:11], s50 offen offset:3072 nt lds
s_waitcnt lgkmcnt(10)
v_mfma_f32_32x32x16_bf16 v[64:79], v[248:251], v[108:111], v[64:79]
s_nop 0
ds_read_b64_tr_b16 v[244:245], v3 offset:53248
ds_read_b64_tr_b16 v[246:247], v3 offset:54272
s_add_u32 s50, s37, 49152
s_add_u32 m0, s36, 49152
s_nop 0
buffer_load_dwordx4 v15, s[12:15], s50 offen offset:0 nt lds
v_mfma_f32_32x32x16_bf16 v[80:95], v[252:255], v[108:111], v[80:95]
ds_read_b64_tr_b16 v[248:249], v4 offset:53248
s_nop 0
ds_read_b64_tr_b16 v[250:251], v4 offset:54272
buffer_load_dwordx4 v15, s[12:15], s50 offen offset:1024 nt lds
s_waitcnt lgkmcnt(10)
v_mfma_f32_32x32x16_bf16 v[32:47], v[224:227], v[112:115], v[32:47]
ds_read_b64_tr_b16 v[252:253], v5 offset:53248
ds_read_b64_tr_b16 v[254:255], v5 offset:54272
buffer_load_dwordx4 v15, s[12:15], s50 offen offset:2048 nt lds
v_mfma_f32_32x32x16_bf16 v[48:63], v[228:231], v[112:115], v[48:63]
s_nop 0
buffer_load_dwordx4 v15, s[12:15], s50 offen offset:3072 nt lds
s_waitcnt lgkmcnt(8)
v_mfma_f32_32x32x16_bf16 v[64:79], v[232:235], v[112:115], v[64:79]
v_mfma_f32_32x32x16_bf16 v[80:95], v[236:239], v[112:115], v[80:95]
s_waitcnt vmcnt(24)
s_waitcnt lgkmcnt(0)
s_barrier
ds_read_b64_tr_b16 v[224:225], v2 offset:57344
ds_read_b64_tr_b16 v[226:227], v2 offset:58368
ds_read_b64_tr_b16 v[228:229], v3 offset:57344
ds_read_b64_tr_b16 v[230:231], v3 offset:58368
ds_read_b64_tr_b16 v[232:233], v4 offset:57344
ds_read_b64_tr_b16 v[234:235], v4 offset:58368
s_add_u32 m0, s36, 131072
s_add_u32 s50, s38, 2097408
buffer_load_dwordx4 v16, s[16:19], s50 offen offset:0 lds
s_add_u32 s51, s38, 2129152
buffer_load_dwordx4 v16, s[16:19], s51 offen offset:1024 lds
v_mfma_f32_32x32x16_bf16 v[32:47], v[240:243], v[116:119], v[32:47]
ds_read_b64_tr_b16 v[236:237], v5 offset:57344
ds_read_b64_tr_b16 v[238:239], v5 offset:58368
s_add_u32 s50, s38, 2160896
buffer_load_dwordx4 v16, s[16:19], s50 offen offset:2048 lds
v_mfma_f32_32x32x16_bf16 v[48:63], v[244:247], v[116:119], v[48:63]
ds_read_b64_tr_b16 v[240:241], v2 offset:61440
ds_read_b64_tr_b16 v[242:243], v2 offset:62464
s_add_u32 s51, s38, 2192640
buffer_load_dwordx4 v16, s[16:19], s51 offen offset:3072 lds
v_mfma_f32_32x32x16_bf16 v[64:79], v[248:251], v[116:119], v[64:79]
ds_read_b64_tr_b16 v[244:245], v3 offset:61440
ds_read_b64_tr_b16 v[246:247], v3 offset:62464
v_mfma_f32_32x32x16_bf16 v[80:95], v[252:255], v[116:119], v[80:95]
ds_read_b64_tr_b16 v[248:249], v4 offset:61440
ds_read_b64_tr_b16 v[250:251], v4 offset:62464
s_waitcnt lgkmcnt(10)
v_mfma_f32_32x32x16_bf16 v[32:47], v[224:227], v[120:123], v[32:47]
ds_read_b64_tr_b16 v[252:253], v5 offset:61440
ds_read_b64_tr_b16 v[254:255], v5 offset:62464
v_mfma_f32_32x32x16_bf16 v[48:63], v[228:231], v[120:123], v[48:63]
s_waitcnt lgkmcnt(8)
v_mfma_f32_32x32x16_bf16 v[64:79], v[232:235], v[120:123], v[64:79]
v_mfma_f32_32x32x16_bf16 v[80:95], v[236:239], v[120:123], v[80:95]
s_waitcnt vmcnt(24)
s_waitcnt vmcnt(20)
s_waitcnt lgkmcnt(0)
s_barrier
ds_read_b64_tr_b16 v[224:225], v2 offset:0
ds_read_b64_tr_b16 v[226:227], v2 offset:1024
ds_read_b64_tr_b16 v[228:229], v3 offset:0
ds_read_b64_tr_b16 v[230:231], v3 offset:1024
ds_read_b64_tr_b16 v[232:233], v4 offset:0
ds_read_b64_tr_b16 v[234:235], v4 offset:1024
s_add_u32 s50, s37, 81920
s_add_u32 m0, s36, 32768
s_nop 0
buffer_load_dwordx4 v11, s[8:11], s50 offen offset:0 nt lds
buffer_load_dwordx4 v12, s[8:11], s50 offen offset:1024 nt lds
v_mfma_f32_32x32x16_bf16 v[32:47], v[240:243], v[124:127], v[32:47]
ds_read_b64_tr_b16 v[236:237], v5 offset:0
ds_read_b64_tr_b16 v[238:239], v5 offset:1024
buffer_load_dwordx4 v13, s[8:11], s50 offen offset:2048 nt lds
s_nop 0
v_mfma_f32_32x32x16_bf16 v[48:63], v[244:247], v[124:127], v[48:63]
ds_read_b64_tr_b16 v[240:241], v2 offset:4096
ds_read_b64_tr_b16 v[242:243], v2 offset:5120
buffer_load_dwordx4 v14, s[8:11], s50 offen offset:3072 nt lds
v_mfma_f32_32x32x16_bf16 v[64:79], v[248:251], v[124:127], v[64:79]
ds_read_b64_tr_b16 v[244:245], v3 offset:4096
ds_read_b64_tr_b16 v[246:247], v3 offset:5120
s_add_u32 s50, s37, 65536
s_add_u32 m0, s36, 65536
s_nop 0
buffer_load_dwordx4 v15, s[12:15], s50 offen offset:0 nt lds
v_mfma_f32_32x32x16_bf16 v[80:95], v[252:255], v[124:127], v[80:95]
ds_read_b64_tr_b16 v[248:249], v4 offset:4096
ds_read_b64_tr_b16 v[250:251], v4 offset:5120
buffer_load_dwordx4 v15, s[12:15], s50 offen offset:1024 nt lds
s_waitcnt lgkmcnt(10)
v_mfma_f32_32x32x16_bf16 v[32:47], v[224:227], v[128:131], v[32:47]
ds_read_b64_tr_b16 v[252:253], v5 offset:4096
ds_read_b64_tr_b16 v[254:255], v5 offset:5120
buffer_load_dwordx4 v15, s[12:15], s50 offen offset:2048 nt lds
v_mfma_f32_32x32x16_bf16 v[48:63], v[228:231], v[128:131], v[48:63]
ds_read_b64_tr_b16 v[224:225], v2 offset:8192
ds_read_b64_tr_b16 v[226:227], v2 offset:9216
buffer_load_dwordx4 v15, s[12:15], s50 offen offset:3072 nt lds
s_waitcnt lgkmcnt(10)
s_nop 0
v_mfma_f32_32x32x16_bf16 v[64:79], v[232:235], v[128:131], v[64:79]
ds_read_b64_tr_b16 v[228:229], v3 offset:8192
ds_read_b64_tr_b16 v[230:231], v3 offset:9216
v_mfma_f32_32x32x16_bf16 v[80:95], v[236:239], v[128:131], v[80:95]
ds_read_b64_tr_b16 v[232:233], v4 offset:8192
ds_read_b64_tr_b16 v[234:235], v4 offset:9216
s_waitcnt lgkmcnt(10)
v_mfma_f32_32x32x16_bf16 v[32:47], v[240:243], v[132:135], v[32:47]
s_nop 0
ds_read_b64_tr_b16 v[236:237], v5 offset:8192
ds_read_b64_tr_b16 v[238:239], v5 offset:9216
v_mfma_f32_32x32x16_bf16 v[48:63], v[244:247], v[132:135], v[48:63]
s_waitcnt lgkmcnt(8)
v_mfma_f32_32x32x16_bf16 v[64:79], v[248:251], v[132:135], v[64:79]
v_mfma_f32_32x32x16_bf16 v[80:95], v[252:255], v[132:135], v[80:95]
s_waitcnt vmcnt(20)
s_waitcnt lgkmcnt(0)
s_barrier
ds_read_b64_tr_b16 v[240:241], v2 offset:12288
ds_read_b64_tr_b16 v[242:243], v2 offset:13312
ds_read_b64_tr_b16 v[244:245], v3 offset:12288
ds_read_b64_tr_b16 v[246:247], v3 offset:13312
ds_read_b64_tr_b16 v[248:249], v4 offset:12288
ds_read_b64_tr_b16 v[250:251], v4 offset:13312
s_add_u32 m0, s36, 147456
s_add_u32 s50, s38, 2621696
buffer_load_dwordx4 v16, s[16:19], s50 offen offset:0 lds
s_add_u32 s51, s38, 2653440
buffer_load_dwordx4 v16, s[16:19], s51 offen offset:1024 lds
v_mfma_f32_32x32x16_bf16 v[32:47], v[224:227], v[136:139], v[32:47]
ds_read_b64_tr_b16 v[252:253], v5 offset:12288
ds_read_b64_tr_b16 v[254:255], v5 offset:13312
s_add_u32 s50, s38, 2685184
buffer_load_dwordx4 v16, s[16:19], s50 offen offset:2048 lds
v_mfma_f32_32x32x16_bf16 v[48:63], v[228:231], v[136:139], v[48:63]
ds_read_b64_tr_b16 v[224:225], v2 offset:16384
ds_read_b64_tr_b16 v[226:227], v2 offset:17408
s_add_u32 s51, s38, 2716928
buffer_load_dwordx4 v16, s[16:19], s51 offen offset:3072 lds
v_mfma_f32_32x32x16_bf16 v[64:79], v[232:235], v[136:139], v[64:79]
ds_read_b64_tr_b16 v[228:229], v3 offset:16384
ds_read_b64_tr_b16 v[230:231], v3 offset:17408
v_mfma_f32_32x32x16_bf16 v[80:95], v[236:239], v[136:139], v[80:95]
ds_read_b64_tr_b16 v[232:233], v4 offset:16384
ds_read_b64_tr_b16 v[234:235], v4 offset:17408
s_waitcnt lgkmcnt(10)
v_mfma_f32_32x32x16_bf16 v[32:47], v[240:243], v[140:143], v[32:47]
ds_read_b64_tr_b16 v[236:237], v5 offset:16384
ds_read_b64_tr_b16 v[238:239], v5 offset:17408
v_mfma_f32_32x32x16_bf16 v[48:63], v[244:247], v[140:143], v[48:63]
ds_read_b64_tr_b16 v[240:241], v2 offset:20480
s_nop 0
ds_read_b64_tr_b16 v[242:243], v2 offset:21504
s_waitcnt lgkmcnt(10)
v_mfma_f32_32x32x16_bf16 v[64:79], v[248:251], v[140:143], v[64:79]
ds_read_b64_tr_b16 v[244:245], v3 offset:20480
ds_read_b64_tr_b16 v[246:247], v3 offset:21504
v_mfma_f32_32x32x16_bf16 v[80:95], v[252:255], v[140:143], v[80:95]
ds_read_b64_tr_b16 v[248:249], v4 offset:20480
ds_read_b64_tr_b16 v[250:251], v4 offset:21504
s_waitcnt lgkmcnt(10)
v_mfma_f32_32x32x16_bf16 v[32:47], v[224:227], v[144:147], v[32:47]
ds_read_b64_tr_b16 v[252:253], v5 offset:20480
ds_read_b64_tr_b16 v[254:255], v5 offset:21504
v_mfma_f32_32x32x16_bf16 v[48:63], v[228:231], v[144:147], v[48:63]
s_waitcnt lgkmcnt(8)
v_mfma_f32_32x32x16_bf16 v[64:79], v[232:235], v[144:147], v[64:79]
v_mfma_f32_32x32x16_bf16 v[80:95], v[236:239], v[144:147], v[80:95]
s_waitcnt vmcnt(20)
s_waitcnt lgkmcnt(0)
s_barrier
ds_read_b64_tr_b16 v[224:225], v2 offset:24576
ds_read_b64_tr_b16 v[226:227], v2 offset:25600
ds_read_b64_tr_b16 v[228:229], v3 offset:24576
ds_read_b64_tr_b16 v[230:231], v3 offset:25600
ds_read_b64_tr_b16 v[232:233], v4 offset:24576
ds_read_b64_tr_b16 v[234:235], v4 offset:25600
s_add_u32 s50, s37, 98304
s_add_u32 m0, s36, 0
s_nop 0
buffer_load_dwordx4 v11, s[8:11], s50 offen offset:0 nt lds
buffer_load_dwordx4 v12, s[8:11], s50 offen offset:1024 nt lds
v_mfma_f32_32x32x16_bf16 v[32:47], v[240:243], v[148:151], v[32:47]
ds_read_b64_tr_b16 v[236:237], v5 offset:24576
ds_read_b64_tr_b16 v[238:239], v5 offset:25600
buffer_load_dwordx4 v13, s[8:11], s50 offen offset:2048 nt lds
v_mfma_f32_32x32x16_bf16 v[48:63], v[244:247], v[148:151], v[48:63]
ds_read_b64_tr_b16 v[240:241], v2 offset:28672
ds_read_b64_tr_b16 v[242:243], v2 offset:29696
buffer_load_dwordx4 v14, s[8:11], s50 offen offset:3072 nt lds
v_mfma_f32_32x32x16_bf16 v[64:79], v[248:251], v[148:151], v[64:79]
ds_read_b64_tr_b16 v[244:245], v3 offset:28672
ds_read_b64_tr_b16 v[246:247], v3 offset:29696
s_add_u32 s50, s37, 81920
s_add_u32 m0, s36, 81920
s_nop 0
s_nop 0
buffer_load_dwordx4 v15, s[12:15], s50 offen offset:0 nt lds
v_mfma_f32_32x32x16_bf16 v[80:95], v[252:255], v[148:151], v[80:95]
ds_read_b64_tr_b16 v[248:249], v4 offset:28672
ds_read_b64_tr_b16 v[250:251], v4 offset:29696
buffer_load_dwordx4 v15, s[12:15], s50 offen offset:1024 nt lds
s_waitcnt lgkmcnt(10)
v_mfma_f32_32x32x16_bf16 v[32:47], v[224:227], v[152:155], v[32:47]
ds_read_b64_tr_b16 v[252:253], v5 offset:28672
s_nop 0
ds_read_b64_tr_b16 v[254:255], v5 offset:29696
buffer_load_dwordx4 v15, s[12:15], s50 offen offset:2048 nt lds
v_mfma_f32_32x32x16_bf16 v[48:63], v[228:231], v[152:155], v[48:63]
buffer_load_dwordx4 v15, s[12:15], s50 offen offset:3072 nt lds
s_waitcnt lgkmcnt(8)
v_mfma_f32_32x32x16_bf16 v[64:79], v[232:235], v[152:155], v[64:79]
v_mfma_f32_32x32x16_bf16 v[80:95], v[236:239], v[152:155], v[80:95]
s_waitcnt vmcnt(24)
s_waitcnt vmcnt(20)
s_waitcnt lgkmcnt(0)
s_barrier
v_mov_b32 v22, 0
global_load_dwordx2 v[20:21], v22, s[60:61] sc1
ds_read_b64_tr_b16 v[224:225], v2 offset:32768
ds_read_b64_tr_b16 v[226:227], v2 offset:33792
ds_read_b64_tr_b16 v[228:229], v3 offset:32768
ds_read_b64_tr_b16 v[230:231], v3 offset:33792
ds_read_b64_tr_b16 v[232:233], v4 offset:32768
ds_read_b64_tr_b16 v[234:235], v4 offset:33792
s_add_u32 m0, s36, 98304
s_add_u32 s50, s38, 3145984
buffer_load_dwordx4 v16, s[16:19], s50 offen offset:0 lds
s_add_u32 s51, s38, 3177728
buffer_load_dwordx4 v16, s[16:19], s51 offen offset:1024 lds
v_mfma_f32_32x32x16_bf16 v[32:47], v[240:243], v[156:159], v[32:47]
ds_read_b64_tr_b16 v[236:237], v5 offset:32768
ds_read_b64_tr_b16 v[238:239], v5 offset:33792
s_add_u32 s50, s38, 3209472
buffer_load_dwordx4 v16, s[16:19], s50 offen offset:2048 lds
v_mfma_f32_32x32x16_bf16 v[48:63], v[244:247], v[156:159], v[48:63]
ds_read_b64_tr_b16 v[240:241], v2 offset:36864
ds_read_b64_tr_b16 v[242:243], v2 offset:37888
s_add_u32 s51, s38, 3241216
buffer_load_dwordx4 v16, s[16:19], s51 offen offset:3072 lds
v_mfma_f32_32x32x16_bf16 v[64:79], v[248:251], v[156:159], v[64:79]
ds_read_b64_tr_b16 v[244:245], v3 offset:36864
ds_read_b64_tr_b16 v[246:247], v3 offset:37888
v_mfma_f32_32x32x16_bf16 v[80:95], v[252:255], v[156:159], v[80:95]
ds_read_b64_tr_b16 v[248:249], v4 offset:36864
ds_read_b64_tr_b16 v[250:251], v4 offset:37888
s_waitcnt lgkmcnt(10)
v_mfma_f32_32x32x16_bf16 v[32:47], v[224:227], v[160:163], v[32:47]
ds_read_b64_tr_b16 v[252:253], v5 offset:36864
s_nop 0
ds_read_b64_tr_b16 v[254:255], v5 offset:37888
v_mfma_f32_32x32x16_bf16 v[48:63], v[228:231], v[160:163], v[48:63]
ds_read_b64_tr_b16 v[224:225], v2 offset:40960
ds_read_b64_tr_b16 v[226:227], v2 offset:41984
s_waitcnt lgkmcnt(10)
v_mfma_f32_32x32x16_bf16 v[64:79], v[232:235], v[160:163], v[64:79]
ds_read_b64_tr_b16 v[228:229], v3 offset:40960
ds_read_b64_tr_b16 v[230:231], v3 offset:41984
s_nop 0
v_mfma_f32_32x32x16_bf16 v[80:95], v[236:239], v[160:163], v[80:95]
ds_read_b64_tr_b16 v[232:233], v4 offset:40960
ds_read_b64_tr_b16 v[234:235], v4 offset:41984
s_waitcnt lgkmcnt(10)
v_mfma_f32_32x32x16_bf16 v[32:47], v[240:243], v[164:167], v[32:47]
ds_read_b64_tr_b16 v[236:237], v5 offset:40960
ds_read_b64_tr_b16 v[238:239], v5 offset:41984
v_mfma_f32_32x32x16_bf16 v[48:63], v[244:247], v[164:167], v[48:63]
s_waitcnt lgkmcnt(8)
v_mfma_f32_32x32x16_bf16 v[64:79], v[248:251], v[164:167], v[64:79]
v_mfma_f32_32x32x16_bf16 v[80:95], v[252:255], v[164:167], v[80:95]
s_waitcnt vmcnt(21)
s_waitcnt vmcnt(13)
s_waitcnt lgkmcnt(0)
s_barrier
ds_read_b64_tr_b16 v[240:241], v2 offset:45056
ds_read_b64_tr_b16 v[242:243], v2 offset:46080
ds_read_b64_tr_b16 v[244:245], v3 offset:45056
ds_read_b64_tr_b16 v[246:247], v3 offset:46080
ds_read_b64_tr_b16 v[248:249], v4 offset:45056
ds_read_b64_tr_b16 v[250:251], v4 offset:46080
s_add_u32 s50, s37, 114688
s_add_u32 m0, s36, 16384
s_nop 0
buffer_load_dwordx4 v11, s[8:11], s50 offen offset:0 nt lds
buffer_load_dwordx4 v12, s[8:11], s50 offen offset:1024 nt lds
v_mfma_f32_32x32x16_bf16 v[32:47], v[224:227], v[168:171], v[32:47]
s_nop 0
ds_read_b64_tr_b16 v[252:253], v5 offset:45056
ds_read_b64_tr_b16 v[254:255], v5 offset:46080
buffer_load_dwordx4 v13, s[8:11], s50 offen offset:2048 nt lds
v_mfma_f32_32x32x16_bf16 v[48:63], v[228:231], v[168:171], v[48:63]
ds_read_b64_tr_b16 v[224:225], v2 offset:49152
ds_read_b64_tr_b16 v[226:227], v2 offset:50176
buffer_load_dwordx4 v14, s[8:11], s50 offen offset:3072 nt lds
v_mfma_f32_32x32x16_bf16 v[64:79], v[232:235], v[168:171], v[64:79]
ds_read_b64_tr_b16 v[228:229], v3 offset:49152
ds_read_b64_tr_b16 v[230:231], v3 offset:50176
s_add_u32 s50, s37, 98304
s_add_u32 m0, s36, 49152
s_nop 0
buffer_load_dwordx4 v15, s[12:15], s50 offen offset:0 nt lds
v_mfma_f32_32x32x16_bf16 v[80:95], v[236:239], v[168:171], v[80:95]
ds_read_b64_tr_b16 v[232:233], v4 offset:49152
s_nop 0
ds_read_b64_tr_b16 v[234:235], v4 offset:50176
buffer_load_dwordx4 v15, s[12:15], s50 offen offset:1024 nt lds
s_waitcnt lgkmcnt(10)
v_mfma_f32_32x32x16_bf16 v[32:47], v[240:243], v[172:175], v[32:47]
ds_read_b64_tr_b16 v[236:237], v5 offset:49152
ds_read_b64_tr_b16 v[238:239], v5 offset:50176
buffer_load_dwordx4 v15, s[12:15], s50 offen offset:2048 nt lds
v_mfma_f32_32x32x16_bf16 v[48:63], v[244:247], v[172:175], v[48:63]
s_nop 0
ds_read_b64_tr_b16 v[240:241], v2 offset:53248
ds_read_b64_tr_b16 v[242:243], v2 offset:54272
buffer_load_dwordx4 v15, s[12:15], s50 offen offset:3072 nt lds
s_waitcnt lgkmcnt(10)
v_mfma_f32_32x32x16_bf16 v[64:79], v[248:251], v[172:175], v[64:79]
ds_read_b64_tr_b16 v[244:245], v3 offset:53248
ds_read_b64_tr_b16 v[246:247], v3 offset:54272
v_mfma_f32_32x32x16_bf16 v[80:95], v[252:255], v[172:175], v[80:95]
s_nop 0
ds_read_b64_tr_b16 v[248:249], v4 offset:53248
ds_read_b64_tr_b16 v[250:251], v4 offset:54272
s_waitcnt lgkmcnt(10)
v_mfma_f32_32x32x16_bf16 v[32:47], v[224:227], v[176:179], v[32:47]
ds_read_b64_tr_b16 v[252:253], v5 offset:53248
ds_read_b64_tr_b16 v[254:255], v5 offset:54272
v_mfma_f32_32x32x16_bf16 v[48:63], v[228:231], v[176:179], v[48:63]
s_waitcnt lgkmcnt(8)
v_mfma_f32_32x32x16_bf16 v[64:79], v[232:235], v[176:179], v[64:79]
v_mfma_f32_32x32x16_bf16 v[80:95], v[236:239], v[176:179], v[80:95]
s_waitcnt lgkmcnt(0)
s_barrier
ds_read_b64_tr_b16 v[224:225], v2 offset:57344
ds_read_b64_tr_b16 v[226:227], v2 offset:58368
ds_read_b64_tr_b16 v[228:229], v3 offset:57344
ds_read_b64_tr_b16 v[230:231], v3 offset:58368
ds_read_b64_tr_b16 v[232:233], v4 offset:57344
ds_read_b64_tr_b16 v[234:235], v4 offset:58368
s_add_u32 m0, s36, 114688
s_add_u32 s50, s38, 3670272
buffer_load_dwordx4 v16, s[16:19], s50 offen offset:0 lds
s_add_u32 s51, s38, 3702016
buffer_load_dwordx4 v16, s[16:19], s51 offen offset:1024 lds
v_mfma_f32_32x32x16_bf16 v[32:47], v[240:243], v[180:183], v[32:47]
ds_read_b64_tr_b16 v[236:237], v5 offset:57344
ds_read_b64_tr_b16 v[238:239], v5 offset:58368
s_add_u32 s50, s38, 3733760
buffer_load_dwordx4 v16, s[16:19], s50 offen offset:2048 lds
v_mfma_f32_32x32x16_bf16 v[48:63], v[244:247], v[180:183], v[48:63]
ds_read_b64_tr_b16 v[240:241], v2 offset:61440
ds_read_b64_tr_b16 v[242:243], v2 offset:62464
s_add_u32 s51, s38, 3765504
buffer_load_dwordx4 v16, s[16:19], s51 offen offset:3072 lds
v_mfma_f32_32x32x16_bf16 v[64:79], v[248:251], v[180:183], v[64:79]
ds_read_b64_tr_b16 v[244:245], v3 offset:61440
ds_read_b64_tr_b16 v[246:247], v3 offset:62464
v_bfe_u32 v25, v1, 3, 2
v_lshlrev_b32 v25, 10, v25
v_and_b32 v26, 7, v1
v_lshlrev_b32 v26, 7, v26
v_add_u32 v25, v25, v26
s_lshl_b32 s52, s54, 20
s_lshr_b32 s53, s56, 1
s_lshl_b32 s53, s53, 18
s_add_u32 s52, s52, s53
s_and_b32 s53, s56, 1
s_lshl_b32 s53, s53, 2
s_add_u32 s53, s53, s55
s_lshl_b32 s53, s53, 14
s_add_u32 s52, s52, s53
s_lshl_b32 s53, s58, 12
s_add_u32 s52, s52, s53
s_add_u32 s52, s52, 0
buffer_load_dword v26, v25, s[24:27], s52 offen
v_mfma_f32_32x32x16_bf16 v[80:95], v[252:255], v[180:183], v[80:95]
ds_read_b64_tr_b16 v[248:249], v4 offset:61440
ds_read_b64_tr_b16 v[250:251], v4 offset:62464
s_waitcnt lgkmcnt(10)
s_nop 0
v_mfma_f32_32x32x16_bf16 v[32:47], v[224:227], v[184:187], v[32:47]
ds_read_b64_tr_b16 v[252:253], v5 offset:61440
ds_read_b64_tr_b16 v[254:255], v5 offset:62464
v_mfma_f32_32x32x16_bf16 v[48:63], v[228:231], v[184:187], v[48:63]
s_waitcnt lgkmcnt(8)
v_mfma_f32_32x32x16_bf16 v[64:79], v[232:235], v[184:187], v[64:79]
v_mfma_f32_32x32x16_bf16 v[80:95], v[236:239], v[184:187], v[80:95]
s_waitcnt vmcnt(22)
s_waitcnt vmcnt(13)
s_waitcnt lgkmcnt(0)
s_barrier
ds_read_b64_tr_b16 v[224:225], v2 offset:0
ds_read_b64_tr_b16 v[226:227], v2 offset:1024
ds_read_b64_tr_b16 v[228:229], v3 offset:0
ds_read_b64_tr_b16 v[230:231], v3 offset:1024
ds_read_b64_tr_b16 v[232:233], v4 offset:0
ds_read_b64_tr_b16 v[234:235], v4 offset:1024
s_add_u32 s50, s37, 131072
s_nop 0
s_add_u32 m0, s36, 32768
s_nop 0
buffer_load_dwordx4 v11, s[8:11], s50 offen offset:0 nt lds
buffer_load_dwordx4 v12, s[8:11], s50 offen offset:1024 nt lds
v_mfma_f32_32x32x16_bf16 v[32:47], v[240:243], v[188:191], v[32:47]
ds_read_b64_tr_b16 v[236:237], v5 offset:0
ds_read_b64_tr_b16 v[238:239], v5 offset:1024
buffer_load_dwordx4 v13, s[8:11], s50 offen offset:2048 nt lds
s_nop 0
v_mfma_f32_32x32x16_bf16 v[48:63], v[244:247], v[188:191], v[48:63]
ds_read_b64_tr_b16 v[240:241], v2 offset:4096
ds_read_b64_tr_b16 v[242:243], v2 offset:5120
buffer_load_dwordx4 v14, s[8:11], s50 offen offset:3072 nt lds
v_mfma_f32_32x32x16_bf16 v[64:79], v[248:251], v[188:191], v[64:79]
ds_read_b64_tr_b16 v[244:245], v3 offset:4096
ds_read_b64_tr_b16 v[246:247], v3 offset:5120
s_add_u32 s50, s37, 114688
s_add_u32 m0, s36, 65536
s_nop 0
buffer_load_dwordx4 v15, s[12:15], s50 offen offset:0 nt lds
v_mfma_f32_32x32x16_bf16 v[80:95], v[252:255], v[188:191], v[80:95]
ds_read_b64_tr_b16 v[248:249], v4 offset:4096
ds_read_b64_tr_b16 v[250:251], v4 offset:5120
buffer_load_dwordx4 v15, s[12:15], s50 offen offset:1024 nt lds
s_waitcnt lgkmcnt(10)
v_mfma_f32_32x32x16_bf16 v[32:47], v[224:227], v[192:195], v[32:47]
ds_read_b64_tr_b16 v[252:253], v5 offset:4096
ds_read_b64_tr_b16 v[254:255], v5 offset:5120
buffer_load_dwordx4 v15, s[12:15], s50 offen offset:2048 nt lds
v_mfma_f32_32x32x16_bf16 v[48:63], v[228:231], v[192:195], v[48:63]
ds_read_b64_tr_b16 v[224:225], v2 offset:8192
ds_read_b64_tr_b16 v[226:227], v2 offset:9216
buffer_load_dwordx4 v15, s[12:15], s50 offen offset:3072 nt lds
s_waitcnt lgkmcnt(10)
s_nop 0
v_mfma_f32_32x32x16_bf16 v[64:79], v[232:235], v[192:195], v[64:79]
ds_read_b64_tr_b16 v[228:229], v3 offset:8192
ds_read_b64_tr_b16 v[230:231], v3 offset:9216
v_mfma_f32_32x32x16_bf16 v[80:95], v[236:239], v[192:195], v[80:95]
ds_read_b64_tr_b16 v[232:233], v4 offset:8192
ds_read_b64_tr_b16 v[234:235], v4 offset:9216
s_waitcnt lgkmcnt(10)
v_mfma_f32_32x32x16_bf16 v[32:47], v[240:243], v[196:199], v[32:47]
s_nop 0
ds_read_b64_tr_b16 v[236:237], v5 offset:8192
ds_read_b64_tr_b16 v[238:239], v5 offset:9216
v_mfma_f32_32x32x16_bf16 v[48:63], v[244:247], v[196:199], v[48:63]
s_waitcnt lgkmcnt(8)
v_mfma_f32_32x32x16_bf16 v[64:79], v[248:251], v[196:199], v[64:79]
v_mfma_f32_32x32x16_bf16 v[80:95], v[252:255], v[196:199], v[80:95]
s_waitcnt vmcnt(9)
s_waitcnt lgkmcnt(0)
s_barrier
ds_read_b64_tr_b16 v[240:241], v2 offset:12288
ds_read_b64_tr_b16 v[242:243], v2 offset:13312
ds_read_b64_tr_b16 v[244:245], v3 offset:12288
ds_read_b64_tr_b16 v[246:247], v3 offset:13312
ds_read_b64_tr_b16 v[248:249], v4 offset:12288
ds_read_b64_tr_b16 v[250:251], v4 offset:13312
v_mfma_f32_32x32x16_bf16 v[32:47], v[224:227], v[200:203], v[32:47]
ds_read_b64_tr_b16 v[252:253], v5 offset:12288
ds_read_b64_tr_b16 v[254:255], v5 offset:13312
v_mfma_f32_32x32x16_bf16 v[48:63], v[228:231], v[200:203], v[48:63]
ds_read_b64_tr_b16 v[224:225], v2 offset:16384
ds_read_b64_tr_b16 v[226:227], v2 offset:17408
v_mfma_f32_32x32x16_bf16 v[64:79], v[232:235], v[200:203], v[64:79]
ds_read_b64_tr_b16 v[228:229], v3 offset:16384
ds_read_b64_tr_b16 v[230:231], v3 offset:17408
v_mfma_f32_32x32x16_bf16 v[80:95], v[236:239], v[200:203], v[80:95]
ds_read_b64_tr_b16 v[232:233], v4 offset:16384
ds_read_b64_tr_b16 v[234:235], v4 offset:17408
s_waitcnt lgkmcnt(10)
v_mfma_f32_32x32x16_bf16 v[32:47], v[240:243], v[204:207], v[32:47]
ds_read_b64_tr_b16 v[236:237], v5 offset:16384
ds_read_b64_tr_b16 v[238:239], v5 offset:17408
v_mfma_f32_32x32x16_bf16 v[48:63], v[244:247], v[204:207], v[48:63]
ds_read_b64_tr_b16 v[240:241], v2 offset:20480
ds_read_b64_tr_b16 v[242:243], v2 offset:21504
s_waitcnt lgkmcnt(10)
v_mfma_f32_32x32x16_bf16 v[64:79], v[248:251], v[204:207], v[64:79]
ds_read_b64_tr_b16 v[244:245], v3 offset:20480
ds_read_b64_tr_b16 v[246:247], v3 offset:21504
v_mfma_f32_32x32x16_bf16 v[80:95], v[252:255], v[204:207], v[80:95]
ds_read_b64_tr_b16 v[248:249], v4 offset:20480
ds_read_b64_tr_b16 v[250:251], v4 offset:21504
s_waitcnt lgkmcnt(10)
v_mfma_f32_32x32x16_bf16 v[32:47], v[224:227], v[208:211], v[32:47]
s_nop 0
ds_read_b64_tr_b16 v[252:253], v5 offset:20480
ds_read_b64_tr_b16 v[254:255], v5 offset:21504
v_mfma_f32_32x32x16_bf16 v[48:63], v[228:231], v[208:211], v[48:63]
s_waitcnt lgkmcnt(8)
v_mfma_f32_32x32x16_bf16 v[64:79], v[232:235], v[208:211], v[64:79]
v_mfma_f32_32x32x16_bf16 v[80:95], v[236:239], v[208:211], v[80:95]
s_waitcnt lgkmcnt(0)
s_barrier
ds_read_b64_tr_b16 v[224:225], v2 offset:24576
s_nop 0
ds_read_b64_tr_b16 v[226:227], v2 offset:25600
ds_read_b64_tr_b16 v[228:229], v3 offset:24576
ds_read_b64_tr_b16 v[230:231], v3 offset:25600
ds_read_b64_tr_b16 v[232:233], v4 offset:24576
ds_read_b64_tr_b16 v[234:235], v4 offset:25600
s_add_u32 s50, s37, 147456
s_add_u32 m0, s36, 0
s_nop 0
buffer_load_dwordx4 v11, s[8:11], s50 offen offset:0 nt lds
buffer_load_dwordx4 v12, s[8:11], s50 offen offset:1024 nt lds
v_mfma_f32_32x32x16_bf16 v[32:47], v[240:243], v[212:215], v[32:47]
ds_read_b64_tr_b16 v[236:237], v5 offset:24576
ds_read_b64_tr_b16 v[238:239], v5 offset:25600
buffer_load_dwordx4 v13, s[8:11], s50 offen offset:2048 nt lds
v_mfma_f32_32x32x16_bf16 v[48:63], v[244:247], v[212:215], v[48:63]
ds_read_b64_tr_b16 v[240:241], v2 offset:28672
ds_read_b64_tr_b16 v[242:243], v2 offset:29696
buffer_load_dwordx4 v14, s[8:11], s50 offen offset:3072 nt lds
v_mfma_f32_32x32x16_bf16 v[64:79], v[248:251], v[212:215], v[64:79]
ds_read_b64_tr_b16 v[244:245], v3 offset:28672
ds_read_b64_tr_b16 v[246:247], v3 offset:29696
s_add_u32 s50, s37, 131072
s_add_u32 m0, s36, 81920
s_nop 0
buffer_load_dwordx4 v15, s[12:15], s50 offen offset:0 nt lds
s_nop 0
v_mfma_f32_32x32x16_bf16 v[80:95], v[252:255], v[212:215], v[80:95]
ds_read_b64_tr_b16 v[248:249], v4 offset:28672
ds_read_b64_tr_b16 v[250:251], v4 offset:29696
buffer_load_dwordx4 v15, s[12:15], s50 offen offset:1024 nt lds
s_waitcnt lgkmcnt(10)
v_mfma_f32_32x32x16_bf16 v[32:47], v[224:227], v[216:219], v[32:47]
ds_read_b64_tr_b16 v[252:253], v5 offset:28672
ds_read_b64_tr_b16 v[254:255], v5 offset:29696
s_nop 0
buffer_load_dwordx4 v15, s[12:15], s50 offen offset:2048 nt lds
v_mfma_f32_32x32x16_bf16 v[48:63], v[228:231], v[216:219], v[48:63]
buffer_load_dwordx4 v15, s[12:15], s50 offen offset:3072 nt lds
s_waitcnt lgkmcnt(8)
v_mfma_f32_32x32x16_bf16 v[64:79], v[232:235], v[216:219], v[64:79]
v_mfma_f32_32x32x16_bf16 v[80:95], v[236:239], v[216:219], v[80:95]
s_waitcnt lgkmcnt(6)
v_mfma_f32_32x32x16_bf16 v[32:47], v[240:243], v[220:223], v[32:47]
s_waitcnt lgkmcnt(4)
s_nop 0
v_mfma_f32_32x32x16_bf16 v[48:63], v[244:247], v[220:223], v[48:63]
s_waitcnt lgkmcnt(2)
v_mfma_f32_32x32x16_bf16 v[64:79], v[248:251], v[220:223], v[64:79]
s_waitcnt lgkmcnt(0)
v_mfma_f32_32x32x16_bf16 v[80:95], v[252:255], v[220:223], v[80:95]
s_nop 5
v_mul_f32 v32, s49, v32
v_mul_f32 v33, s49, v33
v_mul_f32 v34, s49, v34
v_mul_f32 v35, s49, v35
v_mul_f32 v36, s49, v36
v_mul_f32 v37, s49, v37
v_mul_f32 v38, s49, v38
v_mul_f32 v39, s49, v39
v_cvt_pk_bf16_f32 v32, v32, v33
v_cvt_pk_bf16_f32 v33, v34, v35
v_cvt_pk_bf16_f32 v34, v36, v37
v_cvt_pk_bf16_f32 v35, v38, v39
ds_write_b128 v19, v[32:35] offset:32768
v_mul_f32 v40, s49, v40
v_mul_f32 v41, s49, v41
v_mul_f32 v42, s49, v42
v_mul_f32 v43, s49, v43
v_mul_f32 v44, s49, v44
v_mul_f32 v45, s49, v45
v_mul_f32 v46, s49, v46
v_mul_f32 v47, s49, v47
v_cvt_pk_bf16_f32 v40, v40, v41
v_cvt_pk_bf16_f32 v41, v42, v43
v_cvt_pk_bf16_f32 v42, v44, v45
v_cvt_pk_bf16_f32 v43, v46, v47
ds_write_b128 v19, v[40:43] offset:33792
v_mul_f32 v48, s49, v48
v_mul_f32 v49, s49, v49
v_mul_f32 v50, s49, v50
v_mul_f32 v51, s49, v51
v_mul_f32 v52, s49, v52
v_mul_f32 v53, s49, v53
v_mul_f32 v54, s49, v54
v_mul_f32 v55, s49, v55
v_cvt_pk_bf16_f32 v48, v48, v49
v_cvt_pk_bf16_f32 v49, v50, v51
v_cvt_pk_bf16_f32 v50, v52, v53
v_cvt_pk_bf16_f32 v51, v54, v55
ds_write_b128 v19, v[48:51] offset:34816
v_mul_f32 v56, s49, v56
v_mul_f32 v57, s49, v57
v_mul_f32 v58, s49, v58
v_mul_f32 v59, s49, v59
v_mul_f32 v60, s49, v60
v_mul_f32 v61, s49, v61
v_mul_f32 v62, s49, v62
v_mul_f32_e64 v63, s49, v63
v_cvt_pk_bf16_f32 v56, v56, v57
v_cvt_pk_bf16_f32 v57, v58, v59
v_cvt_pk_bf16_f32 v58, v60, v61
v_cvt_pk_bf16_f32 v59, v62, v63
ds_write_b128 v19, v[56:59] offset:35840
v_mul_f32 v64, s49, v64
v_mul_f32 v65, s49, v65
v_mul_f32 v66, s49, v66
v_mul_f32 v67, s49, v67
v_mul_f32 v68, s49, v68
v_mul_f32 v69, s49, v69
v_mul_f32 v70, s49, v70
v_mul_f32 v71, s49, v71
v_cvt_pk_bf16_f32 v64, v64, v65
v_cvt_pk_bf16_f32 v65, v66, v67
v_cvt_pk_bf16_f32 v66, v68, v69
v_cvt_pk_bf16_f32 v67, v70, v71
ds_write_b128 v19, v[64:67] offset:36864
v_mul_f32 v72, s49, v72
v_mul_f32 v73, s49, v73
v_mul_f32 v74, s49, v74
v_mul_f32 v75, s49, v75
v_mul_f32 v76, s49, v76
v_mul_f32 v77, s49, v77
v_mul_f32 v78, s49, v78
v_mul_f32 v79, s49, v79
v_cvt_pk_bf16_f32 v72, v72, v73
v_cvt_pk_bf16_f32 v73, v74, v75
v_cvt_pk_bf16_f32 v74, v76, v77
v_cvt_pk_bf16_f32 v75, v78, v79
ds_write_b128 v19, v[72:75] offset:37888
v_mul_f32 v80, s49, v80
v_mul_f32 v81, s49, v81
v_mul_f32 v82, s49, v82
v_mul_f32 v83, s49, v83
v_mul_f32 v84, s49, v84
v_mul_f32 v85, s49, v85
v_mul_f32 v86, s49, v86
v_mul_f32 v87, s49, v87
v_cvt_pk_bf16_f32 v80, v80, v81
v_cvt_pk_bf16_f32 v81, v82, v83
v_cvt_pk_bf16_f32 v82, v84, v85
v_cvt_pk_bf16_f32 v83, v86, v87
ds_write_b128 v19, v[80:83] offset:38912
v_mul_f32 v88, s49, v88
v_mul_f32 v89, s49, v89
v_mul_f32 v90, s49, v90
v_mul_f32 v91, s49, v91
v_mul_f32 v92, s49, v92
v_mul_f32 v93, s49, v93
v_mul_f32 v94, s49, v94
v_mul_f32 v95, s49, v95
v_cvt_pk_bf16_f32 v88, v88, v89
v_cvt_pk_bf16_f32 v89, v90, v91
v_cvt_pk_bf16_f32 v90, v92, v93
v_cvt_pk_bf16_f32 v91, v94, v95
ds_write_b128 v19, v[88:91] offset:39936
s_waitcnt lgkmcnt(0)
s_barrier
s_add_u32 m0, s36, 98304
s_add_u32 s50, s40, 0
s_nop 0
buffer_load_dwordx4 v17, s[24:27], s50 offen offset:0 lds
s_add_u32 s51, s40, 3072
buffer_load_dwordx4 v17, s[24:27], s51 offen offset:1024 lds
s_add_u32 s50, s40, 6144
buffer_load_dwordx4 v17, s[24:27], s50 offen offset:2048 lds
s_add_u32 s51, s40, 9216
buffer_load_dwordx4 v17, s[24:27], s51 offen offset:3072 lds
s_waitcnt vmcnt(16)
s_barrier
v_readfirstlane_b32 s62, v20
s_nop 3
s_cmp_eq_u32 s62, 0
s_cbranch_scc1 LN16
LM17:
v_mov_b32_e64 v0, s62
v_cmp_gt_u32 vcc, 0x40000000, v18
s_nop 1
v_cndmask_b32 v0, 0, v0, vcc
s_add_u32 s50, s37, 163840
s_add_u32 m0, s36, 16384
s_nop 0
buffer_load_dwordx4 v11, s[8:11], s50 offen offset:0 nt lds
buffer_load_dwordx4 v12, s[8:11], s50 offen offset:1024 nt lds
buffer_load_dwordx4 v13, s[8:11], s50 offen offset:2048 nt lds
buffer_load_dwordx4 v14, s[8:11], s50 offen offset:3072 nt lds
s_add_u32 s50, s37, 147456
s_add_u32 m0, s36, 49152
s_nop 0
buffer_load_dwordx4 v15, s[12:15], s50 offen offset:0 nt lds
buffer_load_dwordx4 v15, s[12:15], s50 offen offset:1024 nt lds
s_nop 0
buffer_load_dwordx4 v15, s[12:15], s50 offen offset:2048 nt lds
buffer_load_dwordx4 v15, s[12:15], s50 offen offset:3072 nt lds
s_waitcnt vmcnt(20)
s_barrier
s_lshr_b32 s52, s44, 3
v_and_b32 v21, 3, v1
v_add_u32 v21, s55, v21
v_and_b32 v21, 3, v21
v_subrev_u32 v21, s55, v21
v_lshlrev_b32 v21, 12, v21
s_add_u32 s52, s52, 8
v_add_u32 v21, s52, v21
s_add_u32 m0, s36, 114688
s_add_u32 s50, s40, 65536
buffer_load_dwordx4 v17, s[24:27], s50 offen offset:0 lds
s_add_u32 s51, s40, 68608
buffer_load_dwordx4 v17, s[24:27], s51 offen offset:1024 lds
s_add_u32 s50, s40, 71680
buffer_load_dwordx4 v17, s[24:27], s50 offen offset:2048 lds
s_add_u32 s51, s40, 74752
buffer_load_dwordx4 v17, s[24:27], s51 offen offset:3072 lds
s_waitcnt vmcnt(20)
s_barrier
s_add_u32 s50, s37, 180224
s_add_u32 m0, s36, 32768
s_nop 0
buffer_load_dwordx4 v11, s[8:11], s50 offen offset:0 nt lds
buffer_load_dwordx4 v12, s[8:11], s50 offen offset:1024 nt lds
buffer_load_dwordx4 v13, s[8:11], s50 offen offset:2048 nt lds
buffer_load_dwordx4 v14, s[8:11], s50 offen offset:3072 nt lds
s_nop 0
s_add_u32 s50, s37, 163840
s_add_u32 m0, s36, 65536
s_nop 0
buffer_load_dwordx4 v15, s[12:15], s50 offen offset:0 nt lds
buffer_load_dwordx4 v15, s[12:15], s50 offen offset:1024 nt lds
buffer_load_dwordx4 v15, s[12:15], s50 offen offset:2048 nt lds
buffer_load_dwordx4 v15, s[12:15], s50 offen offset:3072 nt lds
s_waitcnt vmcnt(24)
s_waitcnt vmcnt(20)
s_barrier
ds_read_b128 v[96:99], v19 offset:32768
ds_read_b128 v[100:103], v19 offset:33792
ds_read_b128 v[104:107], v19 offset:34816
ds_read_b128 v[108:111], v19 offset:35840
ds_read_b128 v[112:115], v19 offset:36864
ds_read_b128 v[116:119], v19 offset:37888
ds_read_b128 v[120:123], v19 offset:38912
ds_read_b128 v[124:127], v19 offset:39936
ds_read_b64_tr_b16 v[224:225], v6 offset:0
ds_read_b64_tr_b16 v[226:227], v6 offset:2048
ds_read_b64_tr_b16 v[228:229], v7 offset:0
ds_read_b64_tr_b16 v[230:231], v7 offset:2048
ds_read_b64_tr_b16 v[232:233], v8 offset:0
ds_read_b64_tr_b16 v[234:235], v8 offset:2048
ds_read_b64_tr_b16 v[236:237], v9 offset:0
ds_read_b64_tr_b16 v[238:239], v9 offset:2048
ds_read_b64_tr_b16 v[240:241], v6 offset:4096
ds_read_b64_tr_b16 v[242:243], v6 offset:6144
ds_read_b64_tr_b16 v[244:245], v7 offset:4096
ds_read_b64_tr_b16 v[246:247], v7 offset:6144
ds_read_b64_tr_b16 v[248:249], v8 offset:4096
ds_read_b64_tr_b16 v[250:251], v8 offset:6144
s_waitcnt lgkmcnt(14)
v_add3_u32 v28, v96, v97, s62
s_nop 0
v_add3_u32 v28, v28, v98, v99
s_add_u32 s53, s44, 0
buffer_store_dwordx4 v[96:99], v18, s[28:31], s53 offen offset:0 sc1
v_add3_u32 v28, v28, v100, v101
v_add3_u32 v28, v28, v102, v103
s_add_u32 s53, s44, 0
buffer_store_dwordx4 v[100:103], v18, s[28:31], s53 offen offset:1024 sc1
s_waitcnt lgkmcnt(10)
v_mfma_f32_32x32x16_bf16 v[32:47], v[224:227], v[96:99], 0
s_nop 0
ds_read_b64_tr_b16 v[252:253], v9 offset:4096
ds_read_b64_tr_b16 v[254:255], v9 offset:6144
v_add3_u32 v28, v28, v104, v105
v_add3_u32 v28, v28, v106, v107
s_add_u32 s53, s44, 0
buffer_store_dwordx4 v[104:107], v18, s[28:31], s53 offen offset:2048 sc1
v_mfma_f32_32x32x16_bf16 v[48:63], v[228:231], v[96:99], 0
v_add3_u32 v28, v28, v108, v109
s_nop 0
v_add3_u32 v28, v28, v110, v111
s_add_u32 s53, s44, 0
buffer_store_dwordx4 v[108:111], v18, s[28:31], s53 offen offset:3072 sc1
s_waitcnt lgkmcnt(8)
v_mfma_f32_32x32x16_bf16 v[64:79], v[232:235], v[96:99], 0
v_add3_u32 v29, v112, v113, s62
v_add3_u32 v29, v29, v114, v115
s_add_u32 s53, s44, 4096
buffer_store_dwordx4 v[112:115], v18, s[28:31], s53 offen offset:0 sc1
v_mfma_f32_32x32x16_bf16 v[80:95], v[236:239], v[96:99], 0
v_add3_u32 v29, v29, v116, v117
v_add3_u32 v29, v29, v118, v119
s_add_u32 s53, s44, 4096
buffer_store_dwordx4 v[116:119], v18, s[28:31], s53 offen offset:1024 sc1
v_add3_u32 v29, v29, v120, v121
v_add3_u32 v29, v29, v122, v123
s_add_u32 s53, s44, 4096
buffer_store_dwordx4 v[120:123], v18, s[28:31], s53 offen offset:2048 sc1
v_add3_u32 v29, v29, v124, v125
v_add3_u32 v29, v29, v126, v127
s_add_u32 s53, s44, 4096
buffer_store_dwordx4 v[124:127], v18, s[28:31], s53 offen offset:3072 sc1
v_mov_b32 v30, s62
v_mov_b32_e64 v31, s62
s_lshr_b32 s53, s44, 3
s_add_u32 s53, s53, 33554432
buffer_store_dwordx4 v[28:31], v18, s[28:31], s53 offen sc1
s_waitcnt vmcnt(25)
s_waitcnt lgkmcnt(0)
s_barrier
ds_read_b64_tr_b16 v[224:225], v6 offset:8192
ds_read_b64_tr_b16 v[226:227], v6 offset:10240
ds_read_b64_tr_b16 v[228:229], v7 offset:8192
ds_read_b64_tr_b16 v[230:231], v7 offset:10240
ds_read_b64_tr_b16 v[232:233], v8 offset:8192
s_nop 0
ds_read_b64_tr_b16 v[234:235], v8 offset:10240
s_add_u32 s50, s37, 196608
s_add_u32 m0, s36, 0
s_nop 0
buffer_load_dwordx4 v11, s[8:11], s50 offen offset:0 nt lds
buffer_load_dwordx4 v12, s[8:11], s50 offen offset:1024 nt lds
v_mfma_f32_32x32x16_bf16 v[32:47], v[240:243], v[100:103], v[32:47]
ds_read_b64_tr_b16 v[236:237], v9 offset:8192
ds_read_b64_tr_b16 v[238:239], v9 offset:10240
buffer_load_dwordx4 v13, s[8:11], s50 offen offset:2048 nt lds
v_mfma_f32_32x32x16_bf16 v[48:63], v[244:247], v[100:103], v[48:63]
ds_read_b64_tr_b16 v[240:241], v6 offset:12288
ds_read_b64_tr_b16 v[242:243], v6 offset:14336
buffer_load_dwordx4 v14, s[8:11], s50 offen offset:3072 nt lds
v_mfma_f32_32x32x16_bf16 v[64:79], v[248:251], v[100:103], v[64:79]
ds_read_b64_tr_b16 v[244:245], v7 offset:12288
ds_read_b64_tr_b16 v[246:247], v7 offset:14336
s_add_u32 s50, s37, 180224
s_add_u32 m0, s36, 81920
s_nop 0
buffer_load_dwordx4 v15, s[12:15], s50 offen offset:0 nt lds
v_mfma_f32_32x32x16_bf16 v[80:95], v[252:255], v[100:103], v[80:95]
ds_read_b64_tr_b16 v[248:249], v8 offset:12288
ds_read_b64_tr_b16 v[250:251], v8 offset:14336
buffer_load_dwordx4 v15, s[12:15], s50 offen offset:1024 nt lds
s_waitcnt lgkmcnt(10)
v_mfma_f32_32x32x16_bf16 v[32:47], v[224:227], v[104:107], v[32:47]
ds_read_b64_tr_b16 v[252:253], v9 offset:12288
ds_read_b64_tr_b16 v[254:255], v9 offset:14336
buffer_load_dwordx4 v15, s[12:15], s50 offen offset:2048 nt lds
v_mfma_f32_32x32x16_bf16 v[48:63], v[228:231], v[104:107], v[48:63]
buffer_load_dwordx4 v15, s[12:15], s50 offen offset:3072 nt lds
s_waitcnt lgkmcnt(8)
v_mfma_f32_32x32x16_bf16 v[64:79], v[232:235], v[104:107], v[64:79]
s_nop 0
v_mfma_f32_32x32x16_bf16 v[80:95], v[236:239], v[104:107], v[80:95]
s_waitcnt vmcnt(29)
s_waitcnt vmcnt(25)
s_waitcnt lgkmcnt(0)
s_barrier
ds_read_b64_tr_b16 v[224:225], v6 offset:16384
ds_read_b64_tr_b16 v[226:227], v6 offset:18432
ds_read_b64_tr_b16 v[228:229], v7 offset:16384
ds_read_b64_tr_b16 v[230:231], v7 offset:18432
ds_read_b64_tr_b16 v[232:233], v8 offset:16384
ds_read_b64_tr_b16 v[234:235], v8 offset:18432
s_add_u32 m0, s36, 131072
s_add_u32 s50, s41, 0
buffer_load_dwordx4 v17, s[24:27], s50 offen offset:0 lds
s_add_u32 s51, s41, 3072
buffer_load_dwordx4 v17, s[24:27], s51 offen offset:1024 lds
v_mfma_f32_32x32x16_bf16 v[32:47], v[240:243], v[108:111], v[32:47]
ds_read_b64_tr_b16 v[236:237], v9 offset:16384
s_nop 0
ds_read_b64_tr_b16 v[238:239], v9 offset:18432
s_add_u32 s50, s41, 6144
buffer_load_dwordx4 v17, s[24:27], s50 offen offset:2048 lds
v_mfma_f32_32x32x16_bf16 v[48:63], v[244:247], v[108:111], v[48:63]
ds_read_b64_tr_b16 v[240:241], v6 offset:20480
ds_read_b64_tr_b16 v[242:243], v6 offset:22528
s_add_u32 s51, s41, 9216
buffer_load_dwordx4 v17, s[24:27], s51 offen offset:3072 lds
v_mfma_f32_32x32x16_bf16 v[64:79], v[248:251], v[108:111], v[64:79]
ds_read_b64_tr_b16 v[244:245], v7 offset:20480
ds_read_b64_tr_b16 v[246:247], v7 offset:22528
s_add_u32 m0, s36, 147456
s_add_u32 s50, s41, 65536
buffer_load_dwordx4 v17, s[24:27], s50 offen offset:0 lds
v_mfma_f32_32x32x16_bf16 v[80:95], v[252:255], v[108:111], v[80:95]
ds_read_b64_tr_b16 v[248:249], v8 offset:20480
ds_read_b64_tr_b16 v[250:251], v8 offset:22528
s_add_u32 s51, s41, 68608
buffer_load_dwordx4 v17, s[24:27], s51 offen offset:1024 lds
s_waitcnt lgkmcnt(10)
v_mfma_f32_32x32x16_bf16 v[32:47], v[224:227], v[112:115], v[32:47]
ds_read_b64_tr_b16 v[252:253], v9 offset:20480
ds_read_b64_tr_b16 v[254:255], v9 offset:22528
s_add_u32 s50, s41, 71680
s_nop 0
buffer_load_dwordx4 v17, s[24:27], s50 offen offset:2048 lds
v_mfma_f32_32x32x16_bf16 v[48:63], v[228:231], v[112:115], v[48:63]
s_add_u32 s51, s41, 74752
buffer_load_dwordx4 v17, s[24:27], s51 offen offset:3072 lds
s_waitcnt lgkmcnt(8)
v_mfma_f32_32x32x16_bf16 v[64:79], v[232:235], v[112:115], v[64:79]
s_mov_b32 s53, 0x2000000
buffer_load_dword v22, v21, s[28:31], s53 offen sc1
s_nop 0
v_mfma_f32_32x32x16_bf16 v[80:95], v[236:239], v[112:115], v[80:95]
s_waitcnt vmcnt(30)
s_waitcnt lgkmcnt(0)
s_barrier
ds_read_b64_tr_b16 v[224:225], v6 offset:24576
ds_read_b64_tr_b16 v[226:227], v6 offset:26624
ds_read_b64_tr_b16 v[228:229], v7 offset:24576
ds_read_b64_tr_b16 v[230:231], v7 offset:26624
ds_read_b64_tr_b16 v[232:233], v8 offset:24576
s_nop 0
ds_read_b64_tr_b16 v[234:235], v8 offset:26624
s_add_u32 s50, s37, 212992
s_add_u32 m0, s36, 16384
s_nop 0
buffer_load_dwordx4 v11, s[8:11], s50 offen offset:0 nt lds
buffer_load_dwordx4 v12, s[8:11], s50 offen offset:1024 nt lds
v_mfma_f32_32x32x16_bf16 v[32:47], v[240:243], v[116:119], v[32:47]
ds_read_b64_tr_b16 v[236:237], v9 offset:24576
s_nop 0
ds_read_b64_tr_b16 v[238:239], v9 offset:26624
buffer_load_dwordx4 v13, s[8:11], s50 offen offset:2048 nt lds
v_mfma_f32_32x32x16_bf16 v[48:63], v[244:247], v[116:119], v[48:63]
ds_read_b64_tr_b16 v[240:241], v6 offset:28672
ds_read_b64_tr_b16 v[242:243], v6 offset:30720
buffer_load_dwordx4 v14, s[8:11], s50 offen offset:3072 nt lds
v_mfma_f32_32x32x16_bf16 v[64:79], v[248:251], v[116:119], v[64:79]
ds_read_b64_tr_b16 v[244:245], v7 offset:28672
ds_read_b64_tr_b16 v[246:247], v7 offset:30720
s_add_u32 s50, s37, 196608
s_add_u32 m0, s36, 49152
s_nop 0
buffer_load_dwordx4 v15, s[12:15], s50 offen offset:0 nt lds
v_mfma_f32_32x32x16_bf16 v[80:95], v[252:255], v[116:119], v[80:95]
ds_read_b64_tr_b16 v[248:249], v8 offset:28672
ds_read_b64_tr_b16 v[250:251], v8 offset:30720
s_nop 0
buffer_load_dwordx4 v15, s[12:15], s50 offen offset:1024 nt lds
s_waitcnt lgkmcnt(10)
v_mfma_f32_32x32x16_bf16 v[32:47], v[224:227], v[120:123], v[32:47]
ds_read_b64_tr_b16 v[252:253], v9 offset:28672
ds_read_b64_tr_b16 v[254:255], v9 offset:30720
buffer_load_dwordx4 v15, s[12:15], s50 offen offset:2048 nt lds
v_mfma_f32_32x32x16_bf16 v[48:63], v[228:231], v[120:123], v[48:63]
buffer_load_dwordx4 v15, s[12:15], s50 offen offset:3072 nt lds
s_waitcnt lgkmcnt(8)
v_mfma_f32_32x32x16_bf16 v[64:79], v[232:235], v[120:123], v[64:79]
v_mfma_f32_32x32x16_bf16 v[80:95], v[236:239], v[120:123], v[80:95]
s_waitcnt vmcnt(34)
s_waitcnt lgkmcnt(0)
s_barrier
s_waitcnt vmcnt(8)
v_cmp_eq_u32 s[98:99], s62, v22
s_nop 3
s_and_b32 s98, s98, 14
s_cmp_lg_u32 s98, 14
s_cbranch_scc1 LG24
LH25:
s_add_u32 m0, s36, 98304
s_add_u32 s50, s42, 0
buffer_load_dwordx4 v17, s[24:27], s50 offen offset:0 lds
s_add_u32 s51, s42, 3072
buffer_load_dwordx4 v17, s[24:27], s51 offen offset:1024 lds
v_mfma_f32_32x32x16_bf16 v[32:47], v[240:243], v[124:127], v[32:47]
s_add_u32 s50, s42, 6144
buffer_load_dwordx4 v17, s[24:27], s50 offen offset:2048 lds
v_mfma_f32_32x32x16_bf16 v[48:63], v[244:247], v[124:127], v[48:63]
s_nop 0
s_add_u32 s51, s42, 9216
buffer_load_dwordx4 v17, s[24:27], s51 offen offset:3072 lds
v_mfma_f32_32x32x16_bf16 v[64:79], v[248:251], v[124:127], v[64:79]
s_add_u32 m0, s36, 114688
s_add_u32 s50, s42, 65536
buffer_load_dwordx4 v17, s[24:27], s50 offen offset:0 lds
v_mfma_f32_32x32x16_bf16 v[80:95], v[252:255], v[124:127], v[80:95]
s_add_u32 s51, s42, 68608
buffer_load_dwordx4 v17, s[24:27], s51 offen offset:1024 lds
s_add_u32 s50, s42, 71680
buffer_load_dwordx4 v17, s[24:27], s50 offen offset:2048 lds
s_add_u32 s51, s42, 74752
buffer_load_dwordx4 v17, s[24:27], s51 offen offset:3072 lds
s_add_u32 s52, s46, 0
buffer_load_dwordx4 v[128:131], v18, s[28:31], s52 offen offset:0 sc1
buffer_load_dwordx4 v[132:135], v18, s[28:31], s52 offen offset:1024 sc1
s_nop 0
buffer_load_dwordx4 v[136:139], v18, s[28:31], s52 offen offset:2048 sc1
buffer_load_dwordx4 v[140:143], v18, s[28:31], s52 offen offset:3072 sc1
s_add_u32 s52, s46, 0
s_lshr_b32 s52, s52, 3
s_add_u32 s52, s52, 33554432
buffer_load_dwordx2 v[26:27], v18, s[28:31], s52 offen sc1
s_barrier
s_add_u32 s52, s46, 4096
buffer_load_dwordx4 v[144:147], v18, s[28:31], s52 offen offset:0 sc1
s_nop 0
buffer_load_dwordx4 v[148:151], v18, s[28:31], s52 offen offset:1024 sc1
buffer_load_dwordx4 v[152:155], v18, s[28:31], s52 offen offset:2048 sc1
buffer_load_dwordx4 v[156:159], v18, s[28:31], s52 offen offset:3072 sc1
s_add_u32 s50, s37, 229376
s_add_u32 m0, s36, 32768
s_nop 0
buffer_load_dwordx4 v11, s[8:11], s50 offen offset:0 nt lds
buffer_load_dwordx4 v12, s[8:11], s50 offen offset:1024 nt lds
s_nop 0
buffer_load_dwordx4 v13, s[8:11], s50 offen offset:2048 nt lds
buffer_load_dwordx4 v14, s[8:11], s50 offen offset:3072 nt lds
s_add_u32 s50, s37, 212992
s_add_u32 m0, s36, 65536
s_nop 0
buffer_load_dwordx4 v15, s[12:15], s50 offen offset:0 nt lds
buffer_load_dwordx4 v15, s[12:15], s50 offen offset:1024 nt lds
buffer_load_dwordx4 v15, s[12:15], s50 offen offset:2048 nt lds
s_nop 0
buffer_load_dwordx4 v15, s[12:15], s50 offen offset:3072 nt lds
s_barrier
ds_read_b64_tr_b16 v[224:225], v6 offset:32768
ds_read_b64_tr_b16 v[226:227], v6 offset:34816
ds_read_b64_tr_b16 v[228:229], v7 offset:32768
ds_read_b64_tr_b16 v[230:231], v7 offset:34816
ds_read_b64_tr_b16 v[232:233], v8 offset:32768
ds_read_b64_tr_b16 v[234:235], v8 offset:34816
s_nop 0
ds_read_b64_tr_b16 v[236:237], v9 offset:32768
ds_read_b64_tr_b16 v[238:239], v9 offset:34816
ds_read_b64_tr_b16 v[240:241], v6 offset:36864
ds_read_b64_tr_b16 v[242:243], v6 offset:38912
ds_read_b64_tr_b16 v[244:245], v7 offset:36864
ds_read_b64_tr_b16 v[246:247], v7 offset:38912
ds_read_b64_tr_b16 v[248:249], v8 offset:36864
ds_read_b64_tr_b16 v[250:251], v8 offset:38912
s_add_u32 s52, s47, 0
buffer_load_dwordx4 v[160:163], v18, s[28:31], s52 offen offset:0 sc1
buffer_load_dwordx4 v[164:167], v18, s[28:31], s52 offen offset:1024 sc1
s_waitcnt vmcnt(18)
v_add3_u32 v20, v128, v129, v0
v_add3_u32 v20, v20, v130, v131
s_waitcnt vmcnt(17)
v_add3_u32 v20, v20, v132, v133
v_add3_u32 v20, v20, v134, v135
s_waitcnt vmcnt(16)
v_add3_u32 v20, v20, v136, v137
v_add3_u32 v20, v20, v138, v139
s_waitcnt vmcnt(15)
v_add3_u32 v20, v20, v140, v141
v_add3_u32 v20, v20, v142, v143
s_waitcnt vmcnt(14)
v_cmp_ne_u32 vcc, v20, v26
s_nop 4
s_cbranch_vccnz LV28
LW29:
s_waitcnt lgkmcnt(10)
v_mfma_f32_32x32x16_bf16 v[32:47], v[224:227], v[128:131], v[32:47]
ds_read_b64_tr_b16 v[252:253], v9 offset:36864
ds_read_b64_tr_b16 v[254:255], v9 offset:38912
buffer_load_dwordx4 v[168:171], v18, s[28:31], s52 offen offset:2048 sc1
v_mfma_f32_32x32x16_bf16 v[48:63], v[228:231], v[128:131], v[48:63]
ds_read_b64_tr_b16 v[224:225], v6 offset:40960
ds_read_b64_tr_b16 v[226:227], v6 offset:43008
buffer_load_dwordx4 v[172:175], v18, s[28:31], s52 offen offset:3072 sc1
s_waitcnt lgkmcnt(10)
s_nop 0
v_mfma_f32_32x32x16_bf16 v[64:79], v[232:235], v[128:131], v[64:79]
ds_read_b64_tr_b16 v[228:229], v7 offset:40960
ds_read_b64_tr_b16 v[230:231], v7 offset:43008
s_add_u32 s52, s47, 0
s_lshr_b32 s52, s52, 3
s_add_u32 s52, s52, 33554432
buffer_load_dwordx2 v[28:29], v18, s[28:31], s52 offen sc1
v_mfma_f32_32x32x16_bf16 v[80:95], v[236:239], v[128:131], v[80:95]
ds_read_b64_tr_b16 v[232:233], v8 offset:40960
ds_read_b64_tr_b16 v[234:235], v8 offset:43008
s_add_u32 s50, s37, 245760
s_add_u32 m0, s36, 0
s_nop 0
buffer_load_dwordx4 v11, s[8:11], s50 offen offset:0 nt lds
s_waitcnt lgkmcnt(10)
v_mfma_f32_32x32x16_bf16 v[32:47], v[240:243], v[132:135], v[32:47]
ds_read_b64_tr_b16 v[236:237], v9 offset:40960
ds_read_b64_tr_b16 v[238:239], v9 offset:43008
s_nop 0
buffer_load_dwordx4 v12, s[8:11], s50 offen offset:1024 nt lds
v_mfma_f32_32x32x16_bf16 v[48:63], v[244:247], v[132:135], v[48:63]
ds_read_b64_tr_b16 v[240:241], v6 offset:45056
ds_read_b64_tr_b16 v[242:243], v6 offset:47104
buffer_load_dwordx4 v13, s[8:11], s50 offen offset:2048 nt lds
s_waitcnt lgkmcnt(10)
v_mfma_f32_32x32x16_bf16 v[64:79], v[248:251], v[132:135], v[64:79]
ds_read_b64_tr_b16 v[244:245], v7 offset:45056
s_nop 0
ds_read_b64_tr_b16 v[246:247], v7 offset:47104
buffer_load_dwordx4 v14, s[8:11], s50 offen offset:3072 nt lds
v_mfma_f32_32x32x16_bf16 v[80:95], v[252:255], v[132:135], v[80:95]
ds_read_b64_tr_b16 v[248:249], v8 offset:45056
ds_read_b64_tr_b16 v[250:251], v8 offset:47104
s_waitcnt lgkmcnt(10)
v_mfma_f32_32x32x16_bf16 v[32:47], v[224:227], v[136:139], v[32:47]
ds_read_b64_tr_b16 v[252:253], v9 offset:45056
s_nop 0
ds_read_b64_tr_b16 v[254:255], v9 offset:47104
v_mfma_f32_32x32x16_bf16 v[48:63], v[228:231], v[136:139], v[48:63]
s_waitcnt lgkmcnt(8)
v_mfma_f32_32x32x16_bf16 v[64:79], v[232:235], v[136:139], v[64:79]
v_mfma_f32_32x32x16_bf16 v[80:95], v[236:239], v[136:139], v[80:95]
s_waitcnt lgkmcnt(0)
s_barrier
ds_read_b64_tr_b16 v[224:225], v6 offset:49152
ds_read_b64_tr_b16 v[226:227], v6 offset:51200
s_nop 0
ds_read_b64_tr_b16 v[228:229], v7 offset:49152
ds_read_b64_tr_b16 v[230:231], v7 offset:51200
ds_read_b64_tr_b16 v[232:233], v8 offset:49152
ds_read_b64_tr_b16 v[234:235], v8 offset:51200
s_add_u32 s52, s47, 4096
buffer_load_dwordx4 v[176:179], v18, s[28:31], s52 offen offset:0 sc1
buffer_load_dwordx4 v[180:183], v18, s[28:31], s52 offen offset:1024 sc1
v_mfma_f32_32x32x16_bf16 v[32:47], v[240:243], v[140:143], v[32:47]
ds_read_b64_tr_b16 v[236:237], v9 offset:49152
ds_read_b64_tr_b16 v[238:239], v9 offset:51200
buffer_load_dwordx4 v[184:187], v18, s[28:31], s52 offen offset:2048 sc1
v_mfma_f32_32x32x16_bf16 v[48:63], v[244:247], v[140:143], v[48:63]
ds_read_b64_tr_b16 v[240:241], v6 offset:53248
ds_read_b64_tr_b16 v[242:243], v6 offset:55296
buffer_load_dwordx4 v[188:191], v18, s[28:31], s52 offen offset:3072 sc1
v_mfma_f32_32x32x16_bf16 v[64:79], v[248:251], v[140:143], v[64:79]
ds_read_b64_tr_b16 v[244:245], v7 offset:53248
ds_read_b64_tr_b16 v[246:247], v7 offset:55296
s_add_u32 s50, s37, 229376
s_add_u32 m0, s36, 81920
s_nop 0
buffer_load_dwordx4 v15, s[12:15], s50 offen offset:0 nt lds
v_mfma_f32_32x32x16_bf16 v[80:95], v[252:255], v[140:143], v[80:95]
ds_read_b64_tr_b16 v[248:249], v8 offset:53248
s_nop 0
ds_read_b64_tr_b16 v[250:251], v8 offset:55296
buffer_load_dwordx4 v15, s[12:15], s50 offen offset:1024 nt lds
s_waitcnt vmcnt(26)
v_add3_u32 v20, v144, v145, v0
v_add3_u32 v20, v20, v146, v147
s_waitcnt vmcnt(25)
v_add3_u32 v20, v20, v148, v149
v_add3_u32 v20, v20, v150, v151
s_waitcnt vmcnt(24)
s_nop 0
v_add3_u32 v20, v20, v152, v153
v_add3_u32 v20, v20, v154, v155
s_waitcnt vmcnt(23)
v_add3_u32 v20, v20, v156, v157
v_add3_u32 v20, v20, v158, v159
v_cmp_ne_u32 vcc, v20, v27
s_nop 4
s_cbranch_vccnz LV30
LW31:
s_waitcnt lgkmcnt(10)
v_mfma_f32_32x32x16_bf16 v[32:47], v[224:227], v[144:147], v[32:47]
s_nop 0
ds_read_b64_tr_b16 v[252:253], v9 offset:53248
ds_read_b64_tr_b16 v[254:255], v9 offset:55296
buffer_load_dwordx4 v15, s[12:15], s50 offen offset:2048 nt lds
v_mfma_f32_32x32x16_bf16 v[48:63], v[228:231], v[144:147], v[48:63]
ds_read_b64_tr_b16 v[224:225], v6 offset:57344
ds_read_b64_tr_b16 v[226:227], v6 offset:59392
buffer_load_dwordx4 v15, s[12:15], s50 offen offset:3072 nt lds
s_waitcnt lgkmcnt(10)
s_nop 0
v_mfma_f32_32x32x16_bf16 v[64:79], v[232:235], v[144:147], v[64:79]
ds_read_b64_tr_b16 v[228:229], v7 offset:57344
ds_read_b64_tr_b16 v[230:231], v7 offset:59392
v_mfma_f32_32x32x16_bf16 v[80:95], v[236:239], v[144:147], v[80:95]
ds_read_b64_tr_b16 v[232:233], v8 offset:57344
ds_read_b64_tr_b16 v[234:235], v8 offset:59392
s_waitcnt lgkmcnt(10)
v_mfma_f32_32x32x16_bf16 v[32:47], v[240:243], v[148:151], v[32:47]
s_nop 0
ds_read_b64_tr_b16 v[236:237], v9 offset:57344
ds_read_b64_tr_b16 v[238:239], v9 offset:59392
v_mfma_f32_32x32x16_bf16 v[48:63], v[244:247], v[148:151], v[48:63]
ds_read_b64_tr_b16 v[240:241], v6 offset:61440
ds_read_b64_tr_b16 v[242:243], v6 offset:63488
s_waitcnt lgkmcnt(10)
v_mfma_f32_32x32x16_bf16 v[64:79], v[248:251], v[148:151], v[64:79]
ds_read_b64_tr_b16 v[244:245], v7 offset:61440
s_nop 0
ds_read_b64_tr_b16 v[246:247], v7 offset:63488
v_mfma_f32_32x32x16_bf16 v[80:95], v[252:255], v[148:151], v[80:95]
ds_read_b64_tr_b16 v[248:249], v8 offset:61440
ds_read_b64_tr_b16 v[250:251], v8 offset:63488
s_waitcnt lgkmcnt(10)
v_mfma_f32_32x32x16_bf16 v[32:47], v[224:227], v[152:155], v[32:47]
ds_read_b64_tr_b16 v[252:253], v9 offset:61440
ds_read_b64_tr_b16 v[254:255], v9 offset:63488
s_nop 0
v_mfma_f32_32x32x16_bf16 v[48:63], v[228:231], v[152:155], v[48:63]
s_waitcnt lgkmcnt(8)
v_mfma_f32_32x32x16_bf16 v[64:79], v[232:235], v[152:155], v[64:79]
v_mfma_f32_32x32x16_bf16 v[80:95], v[236:239], v[152:155], v[80:95]
s_waitcnt lgkmcnt(0)
s_barrier
ds_read_b64_tr_b16 v[224:225], v6 offset:0
ds_read_b64_tr_b16 v[226:227], v6 offset:2048
ds_read_b64_tr_b16 v[228:229], v7 offset:0
s_nop 0
ds_read_b64_tr_b16 v[230:231], v7 offset:2048
ds_read_b64_tr_b16 v[232:233], v8 offset:0
ds_read_b64_tr_b16 v[234:235], v8 offset:2048
s_add_u32 m0, s36, 131072
s_add_u32 s50, s43, 0
buffer_load_dwordx4 v17, s[24:27], s50 offen offset:0 lds
s_add_u32 s51, s43, 3072
buffer_load_dwordx4 v17, s[24:27], s51 offen offset:1024 lds
s_nop 0
v_mfma_f32_32x32x16_bf16 v[32:47], v[240:243], v[156:159], v[32:47]
ds_read_b64_tr_b16 v[236:237], v9 offset:0
ds_read_b64_tr_b16 v[238:239], v9 offset:2048
s_add_u32 s50, s43, 6144
buffer_load_dwordx4 v17, s[24:27], s50 offen offset:2048 lds
v_mfma_f32_32x32x16_bf16 v[48:63], v[244:247], v[156:159], v[48:63]
ds_read_b64_tr_b16 v[240:241], v6 offset:4096
ds_read_b64_tr_b16 v[242:243], v6 offset:6144
s_add_u32 s51, s43, 9216
buffer_load_dwordx4 v17, s[24:27], s51 offen offset:3072 lds
v_mfma_f32_32x32x16_bf16 v[64:79], v[248:251], v[156:159], v[64:79]
ds_read_b64_tr_b16 v[244:245], v7 offset:4096
ds_read_b64_tr_b16 v[246:247], v7 offset:6144
s_add_u32 m0, s36, 16384
s_add_u32 s50, s40, 131072
buffer_load_dwordx4 v17, s[24:27], s50 offen offset:0 lds
v_mfma_f32_32x32x16_bf16 v[80:95], v[252:255], v[156:159], v[80:95]
ds_read_b64_tr_b16 v[248:249], v8 offset:4096
ds_read_b64_tr_b16 v[250:251], v8 offset:6144
s_add_u32 s51, s40, 134144
buffer_load_dwordx4 v17, s[24:27], s51 offen offset:1024 lds
s_waitcnt vmcnt(22)
v_add3_u32 v20, v160, v161, v0
v_add3_u32 v20, v20, v162, v163
s_waitcnt vmcnt(21)
v_add3_u32 v20, v20, v164, v165
v_add3_u32 v20, v20, v166, v167
s_waitcnt vmcnt(20)
v_add3_u32 v20, v20, v168, v169
v_add3_u32 v20, v20, v170, v171
s_waitcnt vmcnt(19)
v_add3_u32 v20, v20, v172, v173
v_add3_u32 v20, v20, v174, v175
s_waitcnt vmcnt(18)
v_cmp_ne_u32 vcc, v20, v28
s_nop 4
s_cbranch_vccnz LV34
LW35:
s_waitcnt lgkmcnt(10)
v_mfma_f32_32x32x16_bf16 v[32:47], v[224:227], v[160:163], v[32:47]
ds_read_b64_tr_b16 v[252:253], v9 offset:4096
ds_read_b64_tr_b16 v[254:255], v9 offset:6144
s_add_u32 s50, s40, 137216
buffer_load_dwordx4 v17, s[24:27], s50 offen offset:2048 lds
v_mfma_f32_32x32x16_bf16 v[48:63], v[228:231], v[160:163], v[48:63]
s_nop 0
ds_read_b64_tr_b16 v[224:225], v6 offset:8192
ds_read_b64_tr_b16 v[226:227], v6 offset:10240
s_add_u32 s51, s40, 140288
buffer_load_dwordx4 v17, s[24:27], s51 offen offset:3072 lds
s_waitcnt lgkmcnt(10)
v_mfma_f32_32x32x16_bf16 v[64:79], v[232:235], v[160:163], v[64:79]
ds_read_b64_tr_b16 v[228:229], v7 offset:8192
ds_read_b64_tr_b16 v[230:231], v7 offset:10240
s_add_u32 s52, s48, 0
buffer_load_dwordx4 v[192:195], v18, s[28:31], s52 offen offset:0 sc1
v_mfma_f32_32x32x16_bf16 v[80:95], v[236:239], v[160:163], v[80:95]
ds_read_b64_tr_b16 v[232:233], v8 offset:8192
ds_read_b64_tr_b16 v[234:235], v8 offset:10240
buffer_load_dwordx4 v[196:199], v18, s[28:31], s52 offen offset:1024 sc1
s_waitcnt lgkmcnt(10)
v_mfma_f32_32x32x16_bf16 v[32:47], v[240:243], v[164:167], v[32:47]
ds_read_b64_tr_b16 v[236:237], v9 offset:8192
s_nop 0
ds_read_b64_tr_b16 v[238:239], v9 offset:10240
buffer_load_dwordx4 v[200:203], v18, s[28:31], s52 offen offset:2048 sc1
v_mfma_f32_32x32x16_bf16 v[48:63], v[244:247], v[164:167], v[48:63]
ds_read_b64_tr_b16 v[240:241], v6 offset:12288
ds_read_b64_tr_b16 v[242:243], v6 offset:14336
buffer_load_dwordx4 v[204:207], v18, s[28:31], s52 offen offset:3072 sc1
s_waitcnt lgkmcnt(10)
v_mfma_f32_32x32x16_bf16 v[64:79], v[248:251], v[164:167], v[64:79]
s_nop 0
ds_read_b64_tr_b16 v[244:245], v7 offset:12288
ds_read_b64_tr_b16 v[246:247], v7 offset:14336
s_add_u32 s52, s48, 0
s_lshr_b32 s52, s52, 3
s_add_u32 s52, s52, 33554432
buffer_load_dwordx2 v[30:31], v18, s[28:31], s52 offen sc1
v_mfma_f32_32x32x16_bf16 v[80:95], v[252:255], v[164:167], v[80:95]
ds_read_b64_tr_b16 v[248:249], v8 offset:12288
ds_read_b64_tr_b16 v[250:251], v8 offset:14336
s_waitcnt lgkmcnt(10)
v_mfma_f32_32x32x16_bf16 v[32:47], v[224:227], v[168:171], v[32:47]
ds_read_b64_tr_b16 v[252:253], v9 offset:12288
ds_read_b64_tr_b16 v[254:255], v9 offset:14336
v_mfma_f32_32x32x16_bf16 v[48:63], v[228:231], v[168:171], v[48:63]
s_waitcnt lgkmcnt(8)
v_mfma_f32_32x32x16_bf16 v[64:79], v[232:235], v[168:171], v[64:79]
v_mfma_f32_32x32x16_bf16 v[80:95], v[236:239], v[168:171], v[80:95]
s_waitcnt lgkmcnt(0)
s_barrier
ds_read_b64_tr_b16 v[224:225], v6 offset:16384
ds_read_b64_tr_b16 v[226:227], v6 offset:18432
ds_read_b64_tr_b16 v[228:229], v7 offset:16384
ds_read_b64_tr_b16 v[230:231], v7 offset:18432
ds_read_b64_tr_b16 v[232:233], v8 offset:16384
ds_read_b64_tr_b16 v[234:235], v8 offset:18432
s_add_u32 m0, s36, 98304
s_add_u32 s50, s40, 196608
buffer_load_dwordx4 v17, s[24:27], s50 offen offset:0 lds
s_add_u32 s51, s40, 199680
buffer_load_dwordx4 v17, s[24:27], s51 offen offset:1024 lds
v_mfma_f32_32x32x16_bf16 v[32:47], v[240:243], v[172:175], v[32:47]
ds_read_b64_tr_b16 v[236:237], v9 offset:16384
ds_read_b64_tr_b16 v[238:239], v9 offset:18432
s_add_u32 s50, s40, 202752
buffer_load_dwordx4 v17, s[24:27], s50 offen offset:2048 lds
v_mfma_f32_32x32x16_bf16 v[48:63], v[244:247], v[172:175], v[48:63]
ds_read_b64_tr_b16 v[240:241], v6 offset:20480
ds_read_b64_tr_b16 v[242:243], v6 offset:22528
s_add_u32 s51, s40, 205824
buffer_load_dwordx4 v17, s[24:27], s51 offen offset:3072 lds
v_mfma_f32_32x32x16_bf16 v[64:79], v[248:251], v[172:175], v[64:79]
ds_read_b64_tr_b16 v[244:245], v7 offset:20480
ds_read_b64_tr_b16 v[246:247], v7 offset:22528
s_add_u32 s52, s48, 4096
buffer_load_dwordx4 v[208:211], v18, s[28:31], s52 offen offset:0 sc1
v_mfma_f32_32x32x16_bf16 v[80:95], v[252:255], v[172:175], v[80:95]
ds_read_b64_tr_b16 v[248:249], v8 offset:20480
ds_read_b64_tr_b16 v[250:251], v8 offset:22528
buffer_load_dwordx4 v[212:215], v18, s[28:31], s52 offen offset:1024 sc1
s_waitcnt vmcnt(26)
v_add3_u32 v20, v176, v177, v0
s_nop 0
v_add3_u32 v20, v20, v178, v179
s_waitcnt vmcnt(25)
v_add3_u32 v20, v20, v180, v181
v_add3_u32 v20, v20, v182, v183
s_waitcnt vmcnt(24)
v_add3_u32 v20, v20, v184, v185
v_add3_u32 v20, v20, v186, v187
s_waitcnt vmcnt(23)
v_add3_u32 v20, v20, v188, v189
s_nop 0
v_add3_u32 v20, v20, v190, v191
v_cmp_ne_u32 vcc, v20, v29
s_nop 4
s_cbranch_vccnz LV36
LW37:
s_waitcnt lgkmcnt(10)
v_mfma_f32_32x32x16_bf16 v[32:47], v[224:227], v[176:179], v[32:47]
ds_read_b64_tr_b16 v[252:253], v9 offset:20480
ds_read_b64_tr_b16 v[254:255], v9 offset:22528
buffer_load_dwordx4 v[216:219], v18, s[28:31], s52 offen offset:2048 sc1
v_mfma_f32_32x32x16_bf16 v[48:63], v[228:231], v[176:179], v[48:63]
ds_read_b64_tr_b16 v[224:225], v6 offset:24576
ds_read_b64_tr_b16 v[226:227], v6 offset:26624
buffer_load_dwordx4 v[220:223], v18, s[28:31], s52 offen offset:3072 sc1
s_waitcnt lgkmcnt(10)
v_mfma_f32_32x32x16_bf16 v[64:79], v[232:235], v[176:179], v[64:79]
ds_read_b64_tr_b16 v[228:229], v7 offset:24576
ds_read_b64_tr_b16 v[230:231], v7 offset:26624
s_add_u32 s50, s37, 245760
s_nop 0
s_add_u32 m0, s36, 49152
s_nop 0
buffer_load_dwordx4 v15, s[12:15], s50 offen offset:0 nt lds
v_mfma_f32_32x32x16_bf16 v[80:95], v[236:239], v[176:179], v[80:95]
ds_read_b64_tr_b16 v[232:233], v8 offset:24576
ds_read_b64_tr_b16 v[234:235], v8 offset:26624
buffer_load_dwordx4 v15, s[12:15], s50 offen offset:1024 nt lds
s_waitcnt lgkmcnt(10)
v_mfma_f32_32x32x16_bf16 v[32:47], v[240:243], v[180:183], v[32:47]
ds_read_b64_tr_b16 v[236:237], v9 offset:24576
ds_read_b64_tr_b16 v[238:239], v9 offset:26624
buffer_load_dwordx4 v15, s[12:15], s50 offen offset:2048 nt lds
v_mfma_f32_32x32x16_bf16 v[48:63], v[244:247], v[180:183], v[48:63]
ds_read_b64_tr_b16 v[240:241], v6 offset:28672
ds_read_b64_tr_b16 v[242:243], v6 offset:30720
buffer_load_dwordx4 v15, s[12:15], s50 offen offset:3072 nt lds
s_waitcnt lgkmcnt(10)
s_nop 0
v_mfma_f32_32x32x16_bf16 v[64:79], v[248:251], v[180:183], v[64:79]
ds_read_b64_tr_b16 v[244:245], v7 offset:28672
ds_read_b64_tr_b16 v[246:247], v7 offset:30720
v_mfma_f32_32x32x16_bf16 v[80:95], v[252:255], v[180:183], v[80:95]
ds_read_b64_tr_b16 v[248:249], v8 offset:28672
ds_read_b64_tr_b16 v[250:251], v8 offset:30720
s_waitcnt lgkmcnt(10)
v_mfma_f32_32x32x16_bf16 v[32:47], v[224:227], v[184:187], v[32:47]
s_nop 0
ds_read_b64_tr_b16 v[252:253], v9 offset:28672
ds_read_b64_tr_b16 v[254:255], v9 offset:30720
v_mfma_f32_32x32x16_bf16 v[48:63], v[228:231], v[184:187], v[48:63]
s_waitcnt lgkmcnt(8)
v_mfma_f32_32x32x16_bf16 v[64:79], v[232:235], v[184:187], v[64:79]
v_mfma_f32_32x32x16_bf16 v[80:95], v[236:239], v[184:187], v[80:95]
s_waitcnt vmcnt(21)
s_waitcnt lgkmcnt(0)
s_barrier
v_lshlrev_b32 v20, 4, v1
s_and_b32 s52, s58, 1
s_lshl_b32 s52, s52, 13
s_lshr_b32 s53, s58, 1
s_mul_i32 s53, s53, 98304
s_add_u32 s52, s52, s53
s_add_u32 s52, s52, 49152
v_add_u32 v19, s52, v20
s_cmp_eq_u32 s58, s54
s_cselect_b32 s37, 0x40000000, 0
s_lshl_b32 s39, s54, 16
s_and_b32 s52, s54, 1
s_lshl_b32 s52, s52, 13
s_lshr_b32 s53, s54, 1
s_mul_i32 s53, s53, 98304
s_add_u32 s52, s52, s53
s_add_u32 s52, s52, 49152
s_lshl_b32 s53, s58, 11
s_add_u32 s38, s52, s53
v_subrev_u32 v2, 0x18000, v6
v_subrev_u32 v11, 0x8000, v6
v_subrev_u32 v3, 0x18000, v7
v_subrev_u32 v12, 0x8000, v7
v_subrev_u32 v4, 0x18000, v8
s_nop 0
v_subrev_u32 v13, 0x8000, v8
v_subrev_u32 v5, 0x18000, v9
v_subrev_u32 v14, 0x8000, v9
s_lshl_b32 s52, s54, 16
s_add_u32 s0, s52, s59
s_lshl_b32 s53, s58, 14
s_add_u32 s0, s0, s53
s_sub_u32 s1, s0, 16777216
s_lshr_b32 s1, s1, 2
s_add_u32 s1, s1, 37748736
s_lshl_b32 s52, s54, 14
s_add_u32 s5, s52, s59
s_sub_u32 s63, s5, 16777216
s_lshr_b32 s63, s63, 2
s_add_u32 s63, s63, 37748736
s_lshl_b32 s53, s58, 8
s_add_u32 s63, s63, s53
s_lshl_b32 s53, s58, 11
s_add_u32 s5, s5, s53
v_and_b32 v15, 31, v1
s_lshl_b32 s50, s54, 5
v_add_u32 v15, s50, v15
v_cmp_gt_u32 vcc, 112, v15
v_lshlrev_b32 v15, 11, v15
v_lshrrev_b32 v16, 5, v1
v_lshlrev_b32 v16, 4, v16
v_add_u32 v15, v15, v16
s_mov_b64 s[6:7], vcc
s_mul_i32 s50, s56, 229376
s_lshl_b32 s51, s57, 10
s_add_u32 s50, s50, s51
s_lshl_b32 s51, s55, 8
s_add_u32 s50, s50, s51
s_lshl_b32 s51, s58, 6
s_add_u32 s54, s50, s51
ds_read_b64_tr_b16 v[224:225], v6 offset:32768
ds_read_b64_tr_b16 v[226:227], v6 offset:34816
ds_read_b64_tr_b16 v[228:229], v7 offset:32768
ds_read_b64_tr_b16 v[230:231], v7 offset:34816
ds_read_b64_tr_b16 v[232:233], v8 offset:32768
ds_read_b64_tr_b16 v[234:235], v8 offset:34816
s_add_u32 m0, s36, 147456
s_add_u32 s50, s43, 65536
buffer_load_dwordx4 v17, s[24:27], s50 offen offset:0 lds
s_add_u32 s51, s43, 68608
buffer_load_dwordx4 v17, s[24:27], s51 offen offset:1024 lds
v_mfma_f32_32x32x16_bf16 v[32:47], v[240:243], v[188:191], v[32:47]
ds_read_b64_tr_b16 v[236:237], v9 offset:32768
ds_read_b64_tr_b16 v[238:239], v9 offset:34816
s_add_u32 s50, s43, 71680
buffer_load_dwordx4 v17, s[24:27], s50 offen offset:2048 lds
v_mfma_f32_32x32x16_bf16 v[48:63], v[244:247], v[188:191], v[48:63]
ds_read_b64_tr_b16 v[240:241], v6 offset:36864
ds_read_b64_tr_b16 v[242:243], v6 offset:38912
s_add_u32 s51, s43, 74752
buffer_load_dwordx4 v17, s[24:27], s51 offen offset:3072 lds
v_mfma_f32_32x32x16_bf16 v[64:79], v[248:251], v[188:191], v[64:79]
ds_read_b64_tr_b16 v[244:245], v7 offset:36864
ds_read_b64_tr_b16 v[246:247], v7 offset:38912
s_add_u32 m0, s36, 32768
s_add_u32 s50, s41, 131072
buffer_load_dwordx4 v17, s[24:27], s50 offen offset:0 lds
v_mfma_f32_32x32x16_bf16 v[80:95], v[252:255], v[188:191], v[80:95]
ds_read_b64_tr_b16 v[248:249], v8 offset:36864
ds_read_b64_tr_b16 v[250:251], v8 offset:38912
s_add_u32 s51, s41, 134144
buffer_load_dwordx4 v17, s[24:27], s51 offen offset:1024 lds
s_waitcnt vmcnt(22)
v_add3_u32 v20, v192, v193, v0
s_nop 0
v_add3_u32 v20, v20, v194, v195
s_waitcnt vmcnt(21)
v_add3_u32 v20, v20, v196, v197
v_add3_u32 v20, v20, v198, v199
s_waitcnt vmcnt(20)
v_add3_u32 v20, v20, v200, v201
v_add3_u32 v20, v20, v202, v203
s_waitcnt vmcnt(19)
v_add3_u32 v20, v20, v204, v205
s_nop 0
v_add3_u32 v20, v20, v206, v207
s_waitcnt vmcnt(18)
v_cmp_ne_u32 vcc, v20, v30
s_nop 4
s_cbranch_vccnz LV40
LW41:
s_waitcnt lgkmcnt(10)
v_mfma_f32_32x32x16_bf16 v[32:47], v[224:227], v[192:195], v[32:47]
ds_read_b64_tr_b16 v[252:253], v9 offset:36864
ds_read_b64_tr_b16 v[254:255], v9 offset:38912
s_add_u32 s50, s41, 137216
s_nop 0
buffer_load_dwordx4 v17, s[24:27], s50 offen offset:2048 lds
v_mfma_f32_32x32x16_bf16 v[48:63], v[228:231], v[192:195], v[48:63]
ds_read_b64_tr_b16 v[224:225], v6 offset:40960
ds_read_b64_tr_b16 v[226:227], v6 offset:43008
s_add_u32 s51, s41, 140288
buffer_load_dwordx4 v17, s[24:27], s51 offen offset:3072 lds
s_waitcnt lgkmcnt(10)
v_mfma_f32_32x32x16_bf16 v[64:79], v[232:235], v[192:195], v[64:79]
s_nop 0
ds_read_b64_tr_b16 v[228:229], v7 offset:40960
ds_read_b64_tr_b16 v[230:231], v7 offset:43008
s_add_u32 m0, s36, 114688
s_add_u32 s50, s41, 196608
buffer_load_dwordx4 v17, s[24:27], s50 offen offset:0 lds
v_mfma_f32_32x32x16_bf16 v[80:95], v[236:239], v[192:195], v[80:95]
ds_read_b64_tr_b16 v[232:233], v8 offset:40960
ds_read_b64_tr_b16 v[234:235], v8 offset:43008
s_add_u32 s51, s41, 199680
buffer_load_dwordx4 v17, s[24:27], s51 offen offset:1024 lds
s_waitcnt lgkmcnt(10)
v_mfma_f32_32x32x16_bf16 v[32:47], v[240:243], v[196:199], v[32:47]
ds_read_b64_tr_b16 v[236:237], v9 offset:40960
ds_read_b64_tr_b16 v[238:239], v9 offset:43008
s_add_u32 s50, s41, 202752
buffer_load_dwordx4 v17, s[24:27], s50 offen offset:2048 lds
s_nop 0
v_mfma_f32_32x32x16_bf16 v[48:63], v[244:247], v[196:199], v[48:63]
ds_read_b64_tr_b16 v[240:241], v6 offset:45056
ds_read_b64_tr_b16 v[242:243], v6 offset:47104
s_add_u32 s51, s41, 205824
buffer_load_dwordx4 v17, s[24:27], s51 offen offset:3072 lds
s_waitcnt lgkmcnt(10)
v_mfma_f32_32x32x16_bf16 v[64:79], v[248:251], v[196:199], v[64:79]
ds_read_b64_tr_b16 v[244:245], v7 offset:45056
s_nop 0
ds_read_b64_tr_b16 v[246:247], v7 offset:47104
v_mfma_f32_32x32x16_bf16 v[80:95], v[252:255], v[196:199], v[80:95]
ds_read_b64_tr_b16 v[248:249], v8 offset:45056
ds_read_b64_tr_b16 v[250:251], v8 offset:47104
s_waitcnt lgkmcnt(10)
v_mfma_f32_32x32x16_bf16 v[32:47], v[224:227], v[200:203], v[32:47]
ds_read_b64_tr_b16 v[252:253], v9 offset:45056
ds_read_b64_tr_b16 v[254:255], v9 offset:47104
s_nop 0
v_mfma_f32_32x32x16_bf16 v[48:63], v[228:231], v[200:203], v[48:63]
s_waitcnt lgkmcnt(8)
v_mfma_f32_32x32x16_bf16 v[64:79], v[232:235], v[200:203], v[64:79]
v_mfma_f32_32x32x16_bf16 v[80:95], v[236:239], v[200:203], v[80:95]
s_waitcnt vmcnt(8)
s_waitcnt lgkmcnt(0)
s_barrier
ds_read_b64_tr_b16 v[224:225], v6 offset:49152
ds_read_b64_tr_b16 v[226:227], v6 offset:51200
ds_read_b64_tr_b16 v[228:229], v7 offset:49152
ds_read_b64_tr_b16 v[230:231], v7 offset:51200
ds_read_b64_tr_b16 v[232:233], v8 offset:49152
ds_read_b64_tr_b16 v[234:235], v8 offset:51200
s_add_u32 m0, s36, 65536
s_add_u32 s50, s42, 131072
buffer_load_dwordx4 v17, s[24:27], s50 offen offset:0 lds
s_add_u32 s51, s42, 134144
buffer_load_dwordx4 v17, s[24:27], s51 offen offset:1024 lds
v_mfma_f32_32x32x16_bf16 v[32:47], v[240:243], v[204:207], v[32:47]
ds_read_b64_tr_b16 v[236:237], v9 offset:49152
ds_read_b64_tr_b16 v[238:239], v9 offset:51200
s_add_u32 s50, s42, 137216
buffer_load_dwordx4 v17, s[24:27], s50 offen offset:2048 lds
v_mfma_f32_32x32x16_bf16 v[48:63], v[244:247], v[204:207], v[48:63]
ds_read_b64_tr_b16 v[240:241], v6 offset:53248
ds_read_b64_tr_b16 v[242:243], v6 offset:55296
s_add_u32 s51, s42, 140288
buffer_load_dwordx4 v17, s[24:27], s51 offen offset:3072 lds
v_mfma_f32_32x32x16_bf16 v[64:79], v[248:251], v[204:207], v[64:79]
ds_read_b64_tr_b16 v[244:245], v7 offset:53248
ds_read_b64_tr_b16 v[246:247], v7 offset:55296
s_add_u32 m0, s36, 131072
s_add_u32 s50, s42, 196608
buffer_load_dwordx4 v17, s[24:27], s50 offen offset:0 lds
v_mfma_f32_32x32x16_bf16 v[80:95], v[252:255], v[204:207], v[80:95]
ds_read_b64_tr_b16 v[248:249], v8 offset:53248
ds_read_b64_tr_b16 v[250:251], v8 offset:55296
s_add_u32 s51, s42, 199680
buffer_load_dwordx4 v17, s[24:27], s51 offen offset:1024 lds
v_add3_u32 v20, v208, v209, v0
v_add3_u32 v20, v20, v210, v211
v_add3_u32 v20, v20, v212, v213
v_add3_u32 v20, v20, v214, v215
v_add3_u32 v20, v20, v216, v217
v_add3_u32 v20, v20, v218, v219
v_add3_u32 v20, v20, v220, v221
v_add3_u32 v20, v20, v222, v223
v_cmp_ne_u32 vcc, v20, v31
s_nop 4
s_cbranch_vccnz LV42
LW43:
s_waitcnt lgkmcnt(10)
v_mfma_f32_32x32x16_bf16 v[32:47], v[224:227], v[208:211], v[32:47]
ds_read_b64_tr_b16 v[252:253], v9 offset:53248
ds_read_b64_tr_b16 v[254:255], v9 offset:55296
s_add_u32 s50, s42, 202752
buffer_load_dwordx4 v17, s[24:27], s50 offen offset:2048 lds
v_mfma_f32_32x32x16_bf16 v[48:63], v[228:231], v[208:211], v[48:63]
ds_read_b64_tr_b16 v[224:225], v6 offset:57344
ds_read_b64_tr_b16 v[226:227], v6 offset:59392
s_add_u32 s51, s42, 205824
buffer_load_dwordx4 v17, s[24:27], s51 offen offset:3072 lds
s_waitcnt lgkmcnt(10)
v_mfma_f32_32x32x16_bf16 v[64:79], v[232:235], v[208:211], v[64:79]
ds_read_b64_tr_b16 v[228:229], v7 offset:57344
ds_read_b64_tr_b16 v[230:231], v7 offset:59392
s_cmp_eq_u32 s58, 3
s_cselect_b32 s53, 0x40000000, 0
v_lshlrev_b32 v22, 29, v1
v_and_b32 v22, s53, v22
v_lshlrev_b32 v10, 7, v1
v_or_b32_e64 v10, v10, v22
v_and_b32 v22, 0x40000380, v10
s_add_u32 s53, s44, 131072
buffer_load_dword v10, v10, s[28:31], s53 offen
v_mfma_f32_32x32x16_bf16 v[80:95], v[236:239], v[208:211], v[80:95]
ds_read_b64_tr_b16 v[232:233], v8 offset:57344
ds_read_b64_tr_b16 v[234:235], v8 offset:59392
s_lshr_b32 s53, s53, 3
s_add_u32 s53, s53, 33554432
s_nop 0
buffer_load_dword v22, v22, s[28:31], s53 offen
s_waitcnt lgkmcnt(10)
v_mfma_f32_32x32x16_bf16 v[32:47], v[240:243], v[212:215], v[32:47]
ds_read_b64_tr_b16 v[236:237], v9 offset:57344
ds_read_b64_tr_b16 v[238:239], v9 offset:59392
v_mfma_f32_32x32x16_bf16 v[48:63], v[244:247], v[212:215], v[48:63]
ds_read_b64_tr_b16 v[240:241], v6 offset:61440
ds_read_b64_tr_b16 v[242:243], v6 offset:63488
s_waitcnt lgkmcnt(10)
v_mfma_f32_32x32x16_bf16 v[64:79], v[248:251], v[212:215], v[64:79]
ds_read_b64_tr_b16 v[244:245], v7 offset:61440
ds_read_b64_tr_b16 v[246:247], v7 offset:63488
v_mfma_f32_32x32x16_bf16 v[80:95], v[252:255], v[212:215], v[80:95]
ds_read_b64_tr_b16 v[248:249], v8 offset:61440
ds_read_b64_tr_b16 v[250:251], v8 offset:63488
s_waitcnt lgkmcnt(10)
v_mfma_f32_32x32x16_bf16 v[32:47], v[224:227], v[216:219], v[32:47]
s_nop 0
ds_read_b64_tr_b16 v[252:253], v9 offset:61440
ds_read_b64_tr_b16 v[254:255], v9 offset:63488
v_mfma_f32_32x32x16_bf16 v[48:63], v[228:231], v[216:219], v[48:63]
s_waitcnt lgkmcnt(8)
v_mfma_f32_32x32x16_bf16 v[64:79], v[232:235], v[216:219], v[64:79]
v_mfma_f32_32x32x16_bf16 v[80:95], v[236:239], v[216:219], v[80:95]
s_waitcnt lgkmcnt(0)
s_barrier
s_add_u32 m0, s36, 0
s_add_u32 s50, s43, 131072
buffer_load_dwordx4 v17, s[24:27], s50 offen offset:0 lds
s_add_u32 s51, s43, 134144
buffer_load_dwordx4 v17, s[24:27], s51 offen offset:1024 lds
v_mfma_f32_32x32x16_bf16 v[32:47], v[240:243], v[220:223], v[32:47]
s_add_u32 s50, s43, 137216
buffer_load_dwordx4 v17, s[24:27], s50 offen offset:2048 lds
v_mfma_f32_32x32x16_bf16 v[48:63], v[244:247], v[220:223], v[48:63]
s_add_u32 s51, s43, 140288
buffer_load_dwordx4 v17, s[24:27], s51 offen offset:3072 lds
v_mfma_f32_32x32x16_bf16 v[64:79], v[248:251], v[220:223], v[64:79]
v_mfma_f32_32x32x16_bf16 v[80:95], v[252:255], v[220:223], v[80:95]
s_barrier
s_add_u32 m0, s36, 81920
s_add_u32 s50, s43, 196608
buffer_load_dwordx4 v17, s[24:27], s50 offen offset:0 lds
s_add_u32 s51, s43, 199680
s_nop 0
buffer_load_dwordx4 v17, s[24:27], s51 offen offset:1024 lds
s_add_u32 s50, s43, 202752
buffer_load_dwordx4 v17, s[24:27], s50 offen offset:2048 lds
s_add_u32 s51, s43, 205824
buffer_load_dwordx4 v17, s[24:27], s51 offen offset:3072 lds
s_barrier
v_or_b32 v17, s37, v18
s_add_u32 s97, s0, 4096
s_waitcnt vmcnt(9)
v_lshrrev_b32 v10, 2, v17
ds_read_b64_tr_b16 v[224:225], v2 offset:16384
ds_read_b64_tr_b16 v[226:227], v2 offset:18432
ds_read_b64_tr_b16 v[228:229], v3 offset:16384
ds_read_b64_tr_b16 v[230:231], v3 offset:18432
ds_read_b64_tr_b16 v[232:233], v4 offset:16384
ds_read_b64_tr_b16 v[234:235], v4 offset:18432
ds_read_b64_tr_b16 v[236:237], v5 offset:16384
ds_read_b64_tr_b16 v[238:239], v5 offset:18432
ds_read_b64_tr_b16 v[240:241], v2 offset:20480
ds_read_b64_tr_b16 v[242:243], v2 offset:22528
ds_read_b64_tr_b16 v[244:245], v3 offset:20480
ds_read_b64_tr_b16 v[246:247], v3 offset:22528
ds_read_b64_tr_b16 v[248:249], v4 offset:20480
ds_read_b64_tr_b16 v[250:251], v4 offset:22528
s_waitcnt vmcnt(0) lgkmcnt(0)
s_barrier
ds_read_b128 v[96:99], v19 offset:0
ds_read_b128 v[100:103], v19 offset:1024
ds_read_b128 v[104:107], v19 offset:2048
ds_read_b128 v[108:111], v19 offset:3072
ds_read_b128 v[112:115], v19 offset:4096
ds_read_b128 v[116:119], v19 offset:5120
ds_read_b128 v[120:123], v19 offset:6144
ds_read_b128 v[124:127], v19 offset:7168
s_waitcnt lgkmcnt(6)
s_nop 0
v_mfma_f32_32x32x16_bf16 v[32:47], v[224:227], v[96:99], v[32:47]
ds_read_b64_tr_b16 v[252:253], v5 offset:20480
ds_read_b64_tr_b16 v[254:255], v5 offset:22528
v_mfma_f32_32x32x16_bf16 v[48:63], v[228:231], v[96:99], v[48:63]
ds_read_b64_tr_b16 v[224:225], v2 offset:24576
ds_read_b64_tr_b16 v[226:227], v2 offset:26624
v_mfma_f32_32x32x16_bf16 v[64:79], v[232:235], v[96:99], v[64:79]
ds_read_b64_tr_b16 v[228:229], v3 offset:24576
ds_read_b64_tr_b16 v[230:231], v3 offset:26624
v_mfma_f32_32x32x16_bf16 v[80:95], v[236:239], v[96:99], v[80:95]
ds_read_b64_tr_b16 v[232:233], v4 offset:24576
ds_read_b64_tr_b16 v[234:235], v4 offset:26624
v_mfma_f32_32x32x16_bf16 v[32:47], v[240:243], v[100:103], v[32:47]
ds_read_b64_tr_b16 v[236:237], v5 offset:24576
ds_read_b64_tr_b16 v[238:239], v5 offset:26624
v_mfma_f32_32x32x16_bf16 v[48:63], v[244:247], v[100:103], v[48:63]
ds_read_b64_tr_b16 v[240:241], v2 offset:28672
ds_read_b64_tr_b16 v[242:243], v2 offset:30720
v_mfma_f32_32x32x16_bf16 v[64:79], v[248:251], v[100:103], v[64:79]
ds_read_b64_tr_b16 v[244:245], v3 offset:28672
ds_read_b64_tr_b16 v[246:247], v3 offset:30720
s_add_u32 s52, s46, 131072
buffer_load_dwordx4 v[128:131], v18, s[28:31], s52 offen offset:0 sc1
s_waitcnt lgkmcnt(10)
s_nop 0
v_mfma_f32_32x32x16_bf16 v[80:95], v[252:255], v[100:103], v[80:95]
ds_read_b64_tr_b16 v[248:249], v4 offset:28672
ds_read_b64_tr_b16 v[250:251], v4 offset:30720
buffer_load_dwordx4 v[132:135], v18, s[28:31], s52 offen offset:1024 sc1
v_mfma_f32_32x32x16_bf16 v[32:47], v[224:227], v[104:107], v[32:47]
ds_read_b64_tr_b16 v[252:253], v5 offset:28672
ds_read_b64_tr_b16 v[254:255], v5 offset:30720
buffer_load_dwordx4 v[136:139], v18, s[28:31], s52 offen offset:2048 sc1
s_waitcnt lgkmcnt(10)
v_mfma_f32_32x32x16_bf16 v[48:63], v[228:231], v[104:107], v[48:63]
ds_read_b64_tr_b16 v[224:225], v6 offset:0
ds_read_b64_tr_b16 v[226:227], v6 offset:2048
buffer_load_dwordx4 v[140:143], v18, s[28:31], s52 offen offset:3072 sc1
v_mfma_f32_32x32x16_bf16 v[64:79], v[232:235], v[104:107], v[64:79]
ds_read_b64_tr_b16 v[228:229], v7 offset:0
ds_read_b64_tr_b16 v[230:231], v7 offset:2048
s_nop 0
s_add_u32 s52, s46, 131072
s_lshr_b32 s52, s52, 3
s_add_u32 s52, s52, 33554432
buffer_load_dwordx2 v[26:27], v18, s[28:31], s52 offen sc1
s_waitcnt lgkmcnt(10)
v_mfma_f32_32x32x16_bf16 v[80:95], v[236:239], v[104:107], v[80:95]
ds_read_b64_tr_b16 v[232:233], v8 offset:0
ds_read_b64_tr_b16 v[234:235], v8 offset:2048
s_add_u32 s52, s46, 135168
buffer_load_dwordx4 v[144:147], v18, s[28:31], s52 offen offset:0 sc1
v_mfma_f32_32x32x16_bf16 v[32:47], v[240:243], v[108:111], v[32:47]
ds_read_b64_tr_b16 v[236:237], v9 offset:0
ds_read_b64_tr_b16 v[238:239], v9 offset:2048
s_waitcnt lgkmcnt(10)
v_mfma_f32_32x32x16_bf16 v[48:63], v[244:247], v[108:111], v[48:63]
ds_read_b64_tr_b16 v[240:241], v6 offset:4096
ds_read_b64_tr_b16 v[242:243], v6 offset:6144
s_nop 0
buffer_load_dwordx4 v[148:151], v18, s[28:31], s52 offen offset:1024 sc1
v_mfma_f32_32x32x16_bf16 v[64:79], v[248:251], v[108:111], v[64:79]
ds_read_b64_tr_b16 v[244:245], v7 offset:4096
ds_read_b64_tr_b16 v[246:247], v7 offset:6144
s_waitcnt lgkmcnt(10)
v_mfma_f32_32x32x16_bf16 v[80:95], v[252:255], v[108:111], v[80:95]
ds_read_b64_tr_b16 v[248:249], v8 offset:4096
ds_read_b64_tr_b16 v[250:251], v8 offset:6144
s_nop 0
buffer_load_dwordx4 v[152:155], v18, s[28:31], s52 offen offset:2048 sc1
v_mfma_f32_32x32x16_bf16 v[32:47], v[224:227], v[112:115], v[32:47]
ds_read_b64_tr_b16 v[252:253], v9 offset:4096
ds_read_b64_tr_b16 v[254:255], v9 offset:6144
s_waitcnt lgkmcnt(10)
v_mfma_f32_32x32x16_bf16 v[48:63], v[228:231], v[112:115], v[48:63]
ds_read_b64_tr_b16 v[224:225], v6 offset:8192
ds_read_b64_tr_b16 v[226:227], v6 offset:10240
s_nop 0
buffer_load_dwordx4 v[156:159], v18, s[28:31], s52 offen offset:3072 sc1
v_mfma_f32_32x32x16_bf16 v[64:79], v[232:235], v[112:115], v[64:79]
ds_read_b64_tr_b16 v[228:229], v7 offset:8192
ds_read_b64_tr_b16 v[230:231], v7 offset:10240
s_waitcnt lgkmcnt(10)
v_mfma_f32_32x32x16_bf16 v[80:95], v[236:239], v[112:115], v[80:95]
ds_read_b64_tr_b16 v[232:233], v8 offset:8192
ds_read_b64_tr_b16 v[234:235], v8 offset:10240
s_nop 0
s_add_u32 s52, s47, 131072
buffer_load_dwordx4 v[160:163], v18, s[28:31], s52 offen offset:0 sc1
v_mfma_f32_32x32x16_bf16 v[32:47], v[240:243], v[116:119], v[32:47]
ds_read_b64_tr_b16 v[236:237], v9 offset:8192
ds_read_b64_tr_b16 v[238:239], v9 offset:10240
s_waitcnt lgkmcnt(10)
v_mfma_f32_32x32x16_bf16 v[48:63], v[244:247], v[116:119], v[48:63]
ds_read_b64_tr_b16 v[240:241], v6 offset:12288
s_nop 0
ds_read_b64_tr_b16 v[242:243], v6 offset:14336
buffer_load_dwordx4 v[164:167], v18, s[28:31], s52 offen offset:1024 sc1
v_mfma_f32_32x32x16_bf16 v[64:79], v[248:251], v[116:119], v[64:79]
ds_read_b64_tr_b16 v[244:245], v7 offset:12288
ds_read_b64_tr_b16 v[246:247], v7 offset:14336
s_waitcnt lgkmcnt(10)
v_mfma_f32_32x32x16_bf16 v[80:95], v[252:255], v[116:119], v[80:95]
ds_read_b64_tr_b16 v[248:249], v8 offset:12288
s_nop 0
ds_read_b64_tr_b16 v[250:251], v8 offset:14336
buffer_load_dwordx4 v[168:171], v18, s[28:31], s52 offen offset:2048 sc1
v_mfma_f32_32x32x16_bf16 v[32:47], v[224:227], v[120:123], v[32:47]
ds_read_b64_tr_b16 v[252:253], v9 offset:12288
ds_read_b64_tr_b16 v[254:255], v9 offset:14336
s_waitcnt lgkmcnt(10)
v_mfma_f32_32x32x16_bf16 v[48:63], v[228:231], v[120:123], v[48:63]
ds_read_b64_tr_b16 v[224:225], v2 offset:32768
s_nop 0
ds_read_b64_tr_b16 v[226:227], v2 offset:34816
buffer_load_dwordx4 v[172:175], v18, s[28:31], s52 offen offset:3072 sc1
v_mfma_f32_32x32x16_bf16 v[64:79], v[232:235], v[120:123], v[64:79]
ds_read_b64_tr_b16 v[228:229], v3 offset:32768
ds_read_b64_tr_b16 v[230:231], v3 offset:34816
s_waitcnt lgkmcnt(10)
v_mfma_f32_32x32x16_bf16 v[80:95], v[236:239], v[120:123], v[80:95]
ds_read_b64_tr_b16 v[232:233], v4 offset:32768
s_nop 0
ds_read_b64_tr_b16 v[234:235], v4 offset:34816
s_add_u32 s52, s47, 131072
s_lshr_b32 s52, s52, 3
s_add_u32 s52, s52, 33554432
buffer_load_dwordx2 v[28:29], v18, s[28:31], s52 offen sc1
v_mfma_f32_32x32x16_bf16 v[32:47], v[240:243], v[124:127], v[32:47]
ds_read_b64_tr_b16 v[236:237], v5 offset:32768
ds_read_b64_tr_b16 v[238:239], v5 offset:34816
s_waitcnt lgkmcnt(10)
v_mfma_f32_32x32x16_bf16 v[48:63], v[244:247], v[124:127], v[48:63]
ds_read_b64_tr_b16 v[240:241], v2 offset:36864
ds_read_b64_tr_b16 v[242:243], v2 offset:38912
s_add_u32 s52, s47, 135168
buffer_load_dwordx4 v[176:179], v18, s[28:31], s52 offen offset:0 sc1
v_mfma_f32_32x32x16_bf16 v[64:79], v[248:251], v[124:127], v[64:79]
ds_read_b64_tr_b16 v[244:245], v3 offset:36864
ds_read_b64_tr_b16 v[246:247], v3 offset:38912
s_waitcnt vmcnt(10)
v_add3_u32 v20, v128, v129, v0
v_add3_u32 v20, v20, v130, v131
v_add3_u32 v20, v20, v132, v133
v_add3_u32 v20, v20, v134, v135
v_add3_u32 v20, v20, v136, v137
s_waitcnt lgkmcnt(10)
v_mfma_f32_32x32x16_bf16 v[80:95], v[252:255], v[124:127], v[80:95]
ds_read_b64_tr_b16 v[248:249], v4 offset:36864
ds_read_b64_tr_b16 v[250:251], v4 offset:38912
buffer_load_dwordx4 v[180:183], v18, s[28:31], s52 offen offset:1024 sc1
v_add3_u32 v20, v20, v138, v139
v_add3_u32 v20, v20, v140, v141
v_add3_u32 v20, v20, v142, v143
v_cmp_ne_u32 vcc, v20, v26
s_nop 4
s_cbranch_vccnz LV50
LW51:
v_mfma_f32_32x32x16_bf16 v[32:47], v[224:227], v[128:131], v[32:47]
s_nop 0
ds_read_b64_tr_b16 v[252:253], v5 offset:36864
ds_read_b64_tr_b16 v[254:255], v5 offset:38912
s_waitcnt lgkmcnt(10)
v_mfma_f32_32x32x16_bf16 v[48:63], v[228:231], v[128:131], v[48:63]
ds_read_b64_tr_b16 v[224:225], v2 offset:40960
ds_read_b64_tr_b16 v[226:227], v2 offset:43008
buffer_load_dwordx4 v[184:187], v18, s[28:31], s52 offen offset:2048 sc1
v_mfma_f32_32x32x16_bf16 v[64:79], v[232:235], v[128:131], v[64:79]
s_nop 0
ds_read_b64_tr_b16 v[228:229], v3 offset:40960
ds_read_b64_tr_b16 v[230:231], v3 offset:43008
s_waitcnt lgkmcnt(10)
v_mfma_f32_32x32x16_bf16 v[80:95], v[236:239], v[128:131], v[80:95]
ds_read_b64_tr_b16 v[232:233], v4 offset:40960
ds_read_b64_tr_b16 v[234:235], v4 offset:43008
buffer_load_dwordx4 v[188:191], v18, s[28:31], s52 offen offset:3072 sc1
v_mfma_f32_32x32x16_bf16 v[32:47], v[240:243], v[132:135], v[32:47]
s_nop 0
ds_read_b64_tr_b16 v[236:237], v5 offset:40960
ds_read_b64_tr_b16 v[238:239], v5 offset:43008
s_waitcnt lgkmcnt(10)
v_mfma_f32_32x32x16_bf16 v[48:63], v[244:247], v[132:135], v[48:63]
ds_read_b64_tr_b16 v[240:241], v2 offset:45056
ds_read_b64_tr_b16 v[242:243], v2 offset:47104
s_add_u32 s52, s48, 131072
buffer_load_dwordx4 v[192:195], v18, s[28:31], s52 offen offset:0 sc1
s_nop 0
v_mfma_f32_32x32x16_bf16 v[64:79], v[248:251], v[132:135], v[64:79]
ds_read_b64_tr_b16 v[244:245], v3 offset:45056
ds_read_b64_tr_b16 v[246:247], v3 offset:47104
s_waitcnt lgkmcnt(10)
v_mfma_f32_32x32x16_bf16 v[80:95], v[252:255], v[132:135], v[80:95]
ds_read_b64_tr_b16 v[248:249], v4 offset:45056
ds_read_b64_tr_b16 v[250:251], v4 offset:47104
buffer_load_dwordx4 v[196:199], v18, s[28:31], s52 offen offset:1024 sc1
s_nop 0
v_mfma_f32_32x32x16_bf16 v[32:47], v[224:227], v[136:139], v[32:47]
ds_read_b64_tr_b16 v[252:253], v5 offset:45056
ds_read_b64_tr_b16 v[254:255], v5 offset:47104
s_waitcnt lgkmcnt(10)
v_mfma_f32_32x32x16_bf16 v[48:63], v[228:231], v[136:139], v[48:63]
ds_read_b64_tr_b16 v[224:225], v6 offset:16384
ds_read_b64_tr_b16 v[226:227], v6 offset:18432
buffer_load_dwordx4 v[200:203], v18, s[28:31], s52 offen offset:2048 sc1
s_nop 0
v_mfma_f32_32x32x16_bf16 v[64:79], v[232:235], v[136:139], v[64:79]
ds_read_b64_tr_b16 v[228:229], v7 offset:16384
ds_read_b64_tr_b16 v[230:231], v7 offset:18432
s_waitcnt lgkmcnt(10)
v_mfma_f32_32x32x16_bf16 v[80:95], v[236:239], v[136:139], v[80:95]
ds_read_b64_tr_b16 v[232:233], v8 offset:16384
ds_read_b64_tr_b16 v[234:235], v8 offset:18432
buffer_load_dwordx4 v[204:207], v18, s[28:31], s52 offen offset:3072 sc1
s_nop 0
v_mfma_f32_32x32x16_bf16 v[32:47], v[240:243], v[140:143], v[32:47]
ds_read_b64_tr_b16 v[236:237], v9 offset:16384
ds_read_b64_tr_b16 v[238:239], v9 offset:18432
s_waitcnt vmcnt(13)
v_add3_u32 v20, v144, v145, v0
v_add3_u32 v20, v20, v146, v147
v_add3_u32 v20, v20, v148, v149
s_waitcnt lgkmcnt(10)
v_mfma_f32_32x32x16_bf16 v[48:63], v[244:247], v[140:143], v[48:63]
ds_read_b64_tr_b16 v[240:241], v6 offset:20480
ds_read_b64_tr_b16 v[242:243], v6 offset:22528
s_add_u32 s52, s48, 131072
s_lshr_b32 s52, s52, 3
s_add_u32 s52, s52, 33554432
buffer_load_dwordx2 v[30:31], v18, s[28:31], s52 offen sc1
v_add3_u32 v20, v20, v150, v151
v_add3_u32 v20, v20, v152, v153
s_nop 0
v_add3_u32 v20, v20, v154, v155
v_mfma_f32_32x32x16_bf16 v[64:79], v[248:251], v[140:143], v[64:79]
ds_read_b64_tr_b16 v[244:245], v7 offset:20480
ds_read_b64_tr_b16 v[246:247], v7 offset:22528
v_add3_u32 v20, v20, v156, v157
v_add3_u32 v20, v20, v158, v159
v_cmp_ne_u32 vcc, v20, v27
s_waitcnt lgkmcnt(10)
v_mfma_f32_32x32x16_bf16 v[80:95], v[252:255], v[140:143], v[80:95]
ds_read_b64_tr_b16 v[248:249], v8 offset:20480
ds_read_b64_tr_b16 v[250:251], v8 offset:22528
s_add_u32 s52, s48, 135168
buffer_load_dwordx4 v[208:211], v18, s[28:31], s52 offen offset:0 sc1
s_cbranch_vccnz LV52
LW53:
v_mfma_f32_32x32x16_bf16 v[32:47], v[224:227], v[144:147], v[32:47]
ds_read_b64_tr_b16 v[252:253], v9 offset:20480
ds_read_b64_tr_b16 v[254:255], v9 offset:22528
s_waitcnt lgkmcnt(10)
v_mfma_f32_32x32x16_bf16 v[48:63], v[228:231], v[144:147], v[48:63]
ds_read_b64_tr_b16 v[224:225], v6 offset:24576
ds_read_b64_tr_b16 v[226:227], v6 offset:26624
buffer_load_dwordx4 v[212:215], v18, s[28:31], s52 offen offset:1024 sc1
v_mfma_f32_32x32x16_bf16 v[64:79], v[232:235], v[144:147], v[64:79]
ds_read_b64_tr_b16 v[228:229], v7 offset:24576
ds_read_b64_tr_b16 v[230:231], v7 offset:26624
s_waitcnt lgkmcnt(10)
s_nop 0
v_mfma_f32_32x32x16_bf16 v[80:95], v[236:239], v[144:147], v[80:95]
ds_read_b64_tr_b16 v[232:233], v8 offset:24576
ds_read_b64_tr_b16 v[234:235], v8 offset:26624
buffer_load_dwordx4 v[216:219], v18, s[28:31], s52 offen offset:2048 sc1
v_mfma_f32_32x32x16_bf16 v[32:47], v[240:243], v[148:151], v[32:47]
ds_read_b64_tr_b16 v[236:237], v9 offset:24576
ds_read_b64_tr_b16 v[238:239], v9 offset:26624
s_waitcnt lgkmcnt(10)
s_nop 0
v_mfma_f32_32x32x16_bf16 v[48:63], v[244:247], v[148:151], v[48:63]
ds_read_b64_tr_b16 v[240:241], v6 offset:28672
ds_read_b64_tr_b16 v[242:243], v6 offset:30720
buffer_load_dwordx4 v[220:223], v18, s[28:31], s52 offen offset:3072 sc1
v_mfma_f32_32x32x16_bf16 v[64:79], v[248:251], v[148:151], v[64:79]
ds_read_b64_tr_b16 v[244:245], v7 offset:28672
ds_read_b64_tr_b16 v[246:247], v7 offset:30720
s_waitcnt lgkmcnt(10)
s_nop 0
v_mfma_f32_32x32x16_bf16 v[80:95], v[252:255], v[148:151], v[80:95]
ds_read_b64_tr_b16 v[248:249], v8 offset:28672
ds_read_b64_tr_b16 v[250:251], v8 offset:30720
v_mfma_f32_32x32x16_bf16 v[32:47], v[224:227], v[152:155], v[32:47]
ds_read_b64_tr_b16 v[252:253], v9 offset:28672
ds_read_b64_tr_b16 v[254:255], v9 offset:30720
s_waitcnt lgkmcnt(10)
v_mfma_f32_32x32x16_bf16 v[48:63], v[228:231], v[152:155], v[48:63]
s_nop 0
ds_read_b64_tr_b16 v[224:225], v11 offset:0
ds_read_b64_tr_b16 v[226:227], v11 offset:2048
v_mfma_f32_32x32x16_bf16 v[64:79], v[232:235], v[152:155], v[64:79]
ds_read_b64_tr_b16 v[228:229], v11 offset:4096
ds_read_b64_tr_b16 v[230:231], v11 offset:6144
s_waitcnt lgkmcnt(10)
v_mfma_f32_32x32x16_bf16 v[80:95], v[236:239], v[152:155], v[80:95]
ds_read_b64_tr_b16 v[232:233], v11 offset:8192
s_nop 0
ds_read_b64_tr_b16 v[234:235], v11 offset:10240
v_mfma_f32_32x32x16_bf16 v[32:47], v[240:243], v[156:159], v[32:47]
ds_read_b64_tr_b16 v[236:237], v11 offset:12288
ds_read_b64_tr_b16 v[238:239], v11 offset:14336
s_waitcnt vmcnt(13)
v_add3_u32 v20, v160, v161, v0
v_add3_u32 v20, v20, v162, v163
v_add3_u32 v20, v20, v164, v165
s_waitcnt lgkmcnt(10)
v_mfma_f32_32x32x16_bf16 v[48:63], v[244:247], v[156:159], v[48:63]
ds_read_b64_tr_b16 v[240:241], v6 offset:32768
ds_read_b64_tr_b16 v[242:243], v6 offset:34816
v_add3_u32 v20, v20, v166, v167
v_add3_u32 v20, v20, v168, v169
v_add3_u32 v20, v20, v170, v171
v_mfma_f32_32x32x16_bf16 v[64:79], v[248:251], v[156:159], v[64:79]
ds_read_b64_tr_b16 v[244:245], v6 offset:36864
ds_read_b64_tr_b16 v[246:247], v6 offset:38912
v_add3_u32 v20, v20, v172, v173
v_add3_u32 v20, v20, v174, v175
v_cmp_ne_u32 vcc, v20, v28
s_waitcnt lgkmcnt(10)
v_mfma_f32_32x32x16_bf16 v[80:95], v[252:255], v[156:159], v[80:95]
ds_read_b64_tr_b16 v[248:249], v6 offset:40960
ds_read_b64_tr_b16 v[250:251], v6 offset:43008
s_nop 0
s_cbranch_vccnz LV54
LW55:
v_mfma_f32_32x32x16_bf16 v[32:47], v[224:227], v[160:163], v[32:47]
ds_read_b64_tr_b16 v[252:253], v6 offset:45056
ds_read_b64_tr_b16 v[254:255], v6 offset:47104
s_waitcnt vmcnt(9)
v_add3_u32 v20, v176, v177, v0
v_add3_u32 v20, v20, v178, v179
v_add3_u32 v20, v20, v180, v181
s_waitcnt lgkmcnt(10)
v_mfma_f32_32x32x16_bf16 v[32:47], v[228:231], v[164:167], v[32:47]
ds_read_b64_tr_b16 v[224:225], v2 offset:0
ds_read_b64_tr_b16 v[226:227], v2 offset:2048
v_add3_u32 v20, v20, v182, v183
v_add3_u32 v20, v20, v184, v185
v_add3_u32 v20, v20, v186, v187
v_mfma_f32_32x32x16_bf16 v[32:47], v[232:235], v[168:171], v[32:47]
ds_read_b64_tr_b16 v[228:229], v2 offset:4096
ds_read_b64_tr_b16 v[230:231], v2 offset:6144
v_add3_u32 v20, v20, v188, v189
v_add3_u32 v20, v20, v190, v191
v_cmp_ne_u32 vcc, v20, v29
s_waitcnt lgkmcnt(10)
v_mfma_f32_32x32x16_bf16 v[32:47], v[236:239], v[172:175], v[32:47]
ds_read_b64_tr_b16 v[232:233], v2 offset:8192
ds_read_b64_tr_b16 v[234:235], v2 offset:10240
s_nop 0
s_cbranch_vccnz LV56
LW57:
v_mfma_f32_32x32x16_bf16 v[32:47], v[240:243], v[176:179], v[32:47]
ds_read_b64_tr_b16 v[236:237], v2 offset:12288
ds_read_b64_tr_b16 v[238:239], v2 offset:14336
s_waitcnt vmcnt(4)
v_add3_u32 v20, v192, v193, v0
v_add3_u32 v20, v20, v194, v195
v_add3_u32 v20, v20, v196, v197
s_waitcnt lgkmcnt(10)
v_mfma_f32_32x32x16_bf16 v[32:47], v[244:247], v[180:183], v[32:47]
ds_read_b64_tr_b16 v[240:241], v11 offset:16384
ds_read_b64_tr_b16 v[242:243], v11 offset:18432
v_add3_u32 v20, v20, v198, v199
v_add3_u32 v20, v20, v200, v201
v_add3_u32 v20, v20, v202, v203
v_mfma_f32_32x32x16_bf16 v[32:47], v[248:251], v[184:187], v[32:47]
ds_read_b64_tr_b16 v[244:245], v11 offset:20480
ds_read_b64_tr_b16 v[246:247], v11 offset:22528
v_add3_u32 v20, v20, v204, v205
v_add3_u32 v20, v20, v206, v207
v_cmp_ne_u32 vcc, v20, v30
s_waitcnt lgkmcnt(10)
v_mfma_f32_32x32x16_bf16 v[32:47], v[252:255], v[188:191], v[32:47]
ds_read_b64_tr_b16 v[248:249], v11 offset:24576
ds_read_b64_tr_b16 v[250:251], v11 offset:26624
s_nop 0
s_cbranch_vccnz LV58
LW59:
v_mfma_f32_32x32x16_bf16 v[32:47], v[224:227], v[192:195], v[32:47]
ds_read_b64_tr_b16 v[252:253], v11 offset:28672
ds_read_b64_tr_b16 v[254:255], v11 offset:30720
s_waitcnt vmcnt(0)
v_add3_u32 v20, v208, v209, v0
v_add3_u32 v20, v20, v210, v211
v_add3_u32 v20, v20, v212, v213
s_waitcnt lgkmcnt(10)
v_mfma_f32_32x32x16_bf16 v[32:47], v[228:231], v[196:199], v[32:47]
ds_read_b64_tr_b16 v[224:225], v12 offset:0
ds_read_b64_tr_b16 v[226:227], v12 offset:2048
v_add3_u32 v20, v20, v214, v215
v_add3_u32 v20, v20, v216, v217
v_add3_u32 v20, v20, v218, v219
v_mfma_f32_32x32x16_bf16 v[32:47], v[232:235], v[200:203], v[32:47]
ds_read_b64_tr_b16 v[228:229], v12 offset:4096
ds_read_b64_tr_b16 v[230:231], v12 offset:6144
v_add3_u32 v20, v20, v220, v221
v_add3_u32 v20, v20, v222, v223
v_cmp_ne_u32 vcc, v20, v31
s_waitcnt lgkmcnt(10)
v_mfma_f32_32x32x16_bf16 v[32:47], v[236:239], v[204:207], v[32:47]
ds_read_b64_tr_b16 v[232:233], v12 offset:8192
ds_read_b64_tr_b16 v[234:235], v12 offset:10240
s_nop 0
s_cbranch_vccnz LV60
LW61:
v_mfma_f32_32x32x16_bf16 v[32:47], v[240:243], v[208:211], v[32:47]
ds_read_b64_tr_b16 v[236:237], v12 offset:12288
ds_read_b64_tr_b16 v[238:239], v12 offset:14336
s_waitcnt lgkmcnt(10)
v_mfma_f32_32x32x16_bf16 v[32:47], v[244:247], v[212:215], v[32:47]
ds_read_b64_tr_b16 v[240:241], v7 offset:32768
ds_read_b64_tr_b16 v[242:243], v7 offset:34816
v_mfma_f32_32x32x16_bf16 v[32:47], v[248:251], v[216:219], v[32:47]
ds_read_b64_tr_b16 v[244:245], v7 offset:36864
ds_read_b64_tr_b16 v[246:247], v7 offset:38912
s_waitcnt lgkmcnt(10)
v_mfma_f32_32x32x16_bf16 v[32:47], v[252:255], v[220:223], v[32:47]
ds_read_b64_tr_b16 v[248:249], v7 offset:40960
ds_read_b64_tr_b16 v[250:251], v7 offset:43008
v_mfma_f32_32x32x16_bf16 v[48:63], v[224:227], v[160:163], v[48:63]
ds_read_b64_tr_b16 v[252:253], v7 offset:45056
ds_read_b64_tr_b16 v[254:255], v7 offset:47104
s_waitcnt lgkmcnt(10)
v_mfma_f32_32x32x16_bf16 v[48:63], v[228:231], v[164:167], v[48:63]
ds_read_b64_tr_b16 v[224:225], v3 offset:0
s_nop 0
ds_read_b64_tr_b16 v[226:227], v3 offset:2048
s_nop 2
v_cvt_pk_bf16_f32 v32, v32, v33
v_cvt_pk_bf16_f32 v33, v34, v35
v_mfma_f32_32x32x16_bf16 v[48:63], v[232:235], v[168:171], v[48:63]
ds_read_b64_tr_b16 v[228:229], v3 offset:4096
ds_read_b64_tr_b16 v[230:231], v3 offset:6144
v_cvt_pk_bf16_f32 v34, v36, v37
s_nop 0
v_cvt_pk_bf16_f32 v35, v38, v39
s_waitcnt lgkmcnt(10)
v_mfma_f32_32x32x16_bf16 v[48:63], v[236:239], v[172:175], v[48:63]
ds_read_b64_tr_b16 v[232:233], v3 offset:8192
ds_read_b64_tr_b16 v[234:235], v3 offset:10240
buffer_store_dwordx4 v[32:35], v17, s[28:31], s0 offen offset:0 sc1
ds_write_b128 v19, v[32:35] offset:0
v_mfma_f32_32x32x16_bf16 v[48:63], v[240:243], v[176:179], v[48:63]
s_nop 0
ds_read_b64_tr_b16 v[236:237], v3 offset:12288
ds_read_b64_tr_b16 v[238:239], v3 offset:14336
v_cvt_pk_bf16_f32 v36, v40, v41
v_cvt_pk_bf16_f32 v37, v42, v43
s_waitcnt lgkmcnt(11)
v_mfma_f32_32x32x16_bf16 v[48:63], v[244:247], v[180:183], v[48:63]
ds_read_b64_tr_b16 v[240:241], v12 offset:16384
ds_read_b64_tr_b16 v[242:243], v12 offset:18432
s_nop 0
v_cvt_pk_bf16_f32 v38, v44, v45
v_cvt_pk_bf16_f32 v39, v46, v47
v_mfma_f32_32x32x16_bf16 v[48:63], v[248:251], v[184:187], v[48:63]
ds_read_b64_tr_b16 v[244:245], v12 offset:20480
ds_read_b64_tr_b16 v[246:247], v12 offset:22528
buffer_store_dwordx4 v[36:39], v17, s[28:31], s0 offen offset:1024 sc1
ds_write_b128 v19, v[36:39] offset:1024
s_waitcnt lgkmcnt(12)
s_nop 0
v_mfma_f32_32x32x16_bf16 v[48:63], v[252:255], v[188:191], v[48:63]
ds_read_b64_tr_b16 v[248:249], v12 offset:24576
ds_read_b64_tr_b16 v[250:251], v12 offset:26624
v_add3_u32 v96, v32, v33, s62
v_add3_u32 v96, v96, v34, v35
v_mfma_f32_32x32x16_bf16 v[48:63], v[224:227], v[192:195], v[48:63]
ds_read_b64_tr_b16 v[252:253], v12 offset:28672
ds_read_b64_tr_b16 v[254:255], v12 offset:30720
v_add3_u32 v96, v96, v36, v37
v_add3_u32 v96, v96, v38, v39
s_waitcnt lgkmcnt(12)
v_mfma_f32_32x32x16_bf16 v[48:63], v[228:231], v[196:199], v[48:63]
ds_read_b64_tr_b16 v[224:225], v13 offset:0
ds_read_b64_tr_b16 v[226:227], v13 offset:2048
buffer_store_dword v96, v10, s[28:31], s1 offen offset:0 sc1
v_mfma_f32_32x32x16_bf16 v[48:63], v[232:235], v[200:203], v[48:63]
s_nop 0
ds_read_b64_tr_b16 v[228:229], v13 offset:4096
ds_read_b64_tr_b16 v[230:231], v13 offset:6144
s_waitcnt lgkmcnt(11)
v_mfma_f32_32x32x16_bf16 v[48:63], v[236:239], v[204:207], v[48:63]
ds_read_b64_tr_b16 v[232:233], v13 offset:8192
ds_read_b64_tr_b16 v[234:235], v13 offset:10240
v_mfma_f32_32x32x16_bf16 v[48:63], v[240:243], v[208:211], v[48:63]
ds_read_b64_tr_b16 v[236:237], v13 offset:12288
s_nop 0
ds_read_b64_tr_b16 v[238:239], v13 offset:14336
s_waitcnt lgkmcnt(11)
v_mfma_f32_32x32x16_bf16 v[48:63], v[244:247], v[212:215], v[48:63]
ds_read_b64_tr_b16 v[240:241], v8 offset:32768
ds_read_b64_tr_b16 v[242:243], v8 offset:34816
s_waitcnt lgkmcnt(10)
v_mfma_f32_32x32x16_bf16 v[48:63], v[248:251], v[216:219], v[48:63]
ds_read_b64_tr_b16 v[244:245], v8 offset:36864
ds_read_b64_tr_b16 v[246:247], v8 offset:38912
v_mfma_f32_32x32x16_bf16 v[48:63], v[252:255], v[220:223], v[48:63]
ds_read_b64_tr_b16 v[248:249], v8 offset:40960
ds_read_b64_tr_b16 v[250:251], v8 offset:43008
s_waitcnt lgkmcnt(10)
v_mfma_f32_32x32x16_bf16 v[64:79], v[224:227], v[160:163], v[64:79]
ds_read_b64_tr_b16 v[252:253], v8 offset:45056
ds_read_b64_tr_b16 v[254:255], v8 offset:47104
v_mfma_f32_32x32x16_bf16 v[64:79], v[228:231], v[164:167], v[64:79]
s_nop 0
ds_read_b64_tr_b16 v[224:225], v4 offset:0
ds_read_b64_tr_b16 v[226:227], v4 offset:2048
s_nop 2
v_cvt_pk_bf16_f32 v48, v48, v49
v_cvt_pk_bf16_f32 v49, v50, v51
s_waitcnt lgkmcnt(10)
v_mfma_f32_32x32x16_bf16 v[64:79], v[232:235], v[168:171], v[64:79]
ds_read_b64_tr_b16 v[228:229], v4 offset:4096
ds_read_b64_tr_b16 v[230:231], v4 offset:6144
v_cvt_pk_bf16_f32 v50, v52, v53
v_cvt_pk_bf16_f32 v51, v54, v55
v_mfma_f32_32x32x16_bf16 v[64:79], v[236:239], v[172:175], v[64:79]
ds_read_b64_tr_b16 v[232:233], v4 offset:8192
ds_read_b64_tr_b16 v[234:235], v4 offset:10240
buffer_store_dwordx4 v[48:51], v17, s[28:31], s0 offen offset:2048 sc1
ds_write_b128 v19, v[48:51] offset:2048
s_waitcnt lgkmcnt(11)
s_nop 0
v_mfma_f32_32x32x16_bf16 v[64:79], v[240:243], v[176:179], v[64:79]
ds_read_b64_tr_b16 v[236:237], v4 offset:12288
ds_read_b64_tr_b16 v[238:239], v4 offset:14336
v_cvt_pk_bf16_f32 v52, v56, v57
v_cvt_pk_bf16_f32 v53, v58, v59
v_mfma_f32_32x32x16_bf16 v[64:79], v[244:247], v[180:183], v[64:79]
ds_read_b64_tr_b16 v[240:241], v13 offset:16384
ds_read_b64_tr_b16 v[242:243], v13 offset:18432
v_cvt_pk_bf16_f32 v54, v60, v61
v_cvt_pk_bf16_f32 v55, v62, v63
s_waitcnt lgkmcnt(11)
v_mfma_f32_32x32x16_bf16 v[64:79], v[248:251], v[184:187], v[64:79]
ds_read_b64_tr_b16 v[244:245], v13 offset:20480
ds_read_b64_tr_b16 v[246:247], v13 offset:22528
buffer_store_dwordx4 v[52:55], v17, s[28:31], s0 offen offset:3072 sc1
ds_write_b128 v19, v[52:55] offset:3072
s_nop 0
v_mfma_f32_32x32x16_bf16 v[64:79], v[252:255], v[188:191], v[64:79]
ds_read_b64_tr_b16 v[248:249], v13 offset:24576
ds_read_b64_tr_b16 v[250:251], v13 offset:26624
v_add3_u32 v97, v48, v49, s62
v_add3_u32 v97, v97, v50, v51
s_waitcnt lgkmcnt(12)
v_mfma_f32_32x32x16_bf16 v[64:79], v[224:227], v[192:195], v[64:79]
ds_read_b64_tr_b16 v[252:253], v13 offset:28672
s_nop 0
ds_read_b64_tr_b16 v[254:255], v13 offset:30720
v_add3_u32 v97, v97, v52, v53
v_add3_u32 v97, v97, v54, v55
v_mfma_f32_32x32x16_bf16 v[64:79], v[228:231], v[196:199], v[64:79]
ds_read_b64_tr_b16 v[224:225], v14 offset:0
ds_read_b64_tr_b16 v[226:227], v14 offset:2048
buffer_store_dword v97, v10, s[28:31], s1 offen offset:256 sc1
s_waitcnt lgkmcnt(12)
s_nop 0
v_mfma_f32_32x32x16_bf16 v[64:79], v[232:235], v[200:203], v[64:79]
ds_read_b64_tr_b16 v[228:229], v14 offset:4096
ds_read_b64_tr_b16 v[230:231], v14 offset:6144
s_waitcnt lgkmcnt(11)
v_mfma_f32_32x32x16_bf16 v[64:79], v[236:239], v[204:207], v[64:79]
ds_read_b64_tr_b16 v[232:233], v14 offset:8192
ds_read_b64_tr_b16 v[234:235], v14 offset:10240
v_mfma_f32_32x32x16_bf16 v[64:79], v[240:243], v[208:211], v[64:79]
s_nop 0
ds_read_b64_tr_b16 v[236:237], v14 offset:12288
ds_read_b64_tr_b16 v[238:239], v14 offset:14336
s_waitcnt lgkmcnt(11)
v_mfma_f32_32x32x16_bf16 v[64:79], v[244:247], v[212:215], v[64:79]
ds_read_b64_tr_b16 v[240:241], v9 offset:32768
ds_read_b64_tr_b16 v[242:243], v9 offset:34816
s_waitcnt lgkmcnt(10)
v_mfma_f32_32x32x16_bf16 v[64:79], v[248:251], v[216:219], v[64:79]
ds_read_b64_tr_b16 v[244:245], v9 offset:36864
ds_read_b64_tr_b16 v[246:247], v9 offset:38912
v_mfma_f32_32x32x16_bf16 v[64:79], v[252:255], v[220:223], v[64:79]
ds_read_b64_tr_b16 v[248:249], v9 offset:40960
ds_read_b64_tr_b16 v[250:251], v9 offset:43008
s_waitcnt lgkmcnt(10)
v_mfma_f32_32x32x16_bf16 v[80:95], v[224:227], v[160:163], v[80:95]
ds_read_b64_tr_b16 v[252:253], v9 offset:45056
ds_read_b64_tr_b16 v[254:255], v9 offset:47104
s_nop 0
v_mfma_f32_32x32x16_bf16 v[80:95], v[228:231], v[164:167], v[80:95]
ds_read_b64_tr_b16 v[224:225], v5 offset:0
ds_read_b64_tr_b16 v[226:227], v5 offset:2048
s_nop 2
v_cvt_pk_bf16_f32 v64, v64, v65
v_cvt_pk_bf16_f32 v65, v66, v67
s_waitcnt lgkmcnt(10)
v_mfma_f32_32x32x16_bf16 v[80:95], v[232:235], v[168:171], v[80:95]
ds_read_b64_tr_b16 v[228:229], v5 offset:4096
ds_read_b64_tr_b16 v[230:231], v5 offset:6144
v_cvt_pk_bf16_f32 v66, v68, v69
v_cvt_pk_bf16_f32 v67, v70, v71
v_mfma_f32_32x32x16_bf16 v[80:95], v[236:239], v[172:175], v[80:95]
ds_read_b64_tr_b16 v[232:233], v5 offset:8192
ds_read_b64_tr_b16 v[234:235], v5 offset:10240
buffer_store_dwordx4 v[64:67], v17, s[28:31], s97 offen offset:0 sc1
ds_write_b128 v19, v[64:67] offset:4096
s_waitcnt lgkmcnt(11)
v_mfma_f32_32x32x16_bf16 v[80:95], v[240:243], v[176:179], v[80:95]
ds_read_b64_tr_b16 v[236:237], v5 offset:12288
ds_read_b64_tr_b16 v[238:239], v5 offset:14336
v_cvt_pk_bf16_f32 v68, v72, v73
v_cvt_pk_bf16_f32 v69, v74, v75
v_mfma_f32_32x32x16_bf16 v[80:95], v[244:247], v[180:183], v[80:95]
ds_read_b64_tr_b16 v[240:241], v14 offset:16384
s_nop 0
ds_read_b64_tr_b16 v[242:243], v14 offset:18432
v_cvt_pk_bf16_f32 v70, v76, v77
v_cvt_pk_bf16_f32 v71, v78, v79
s_waitcnt lgkmcnt(11)
v_mfma_f32_32x32x16_bf16 v[80:95], v[248:251], v[184:187], v[80:95]
ds_read_b64_tr_b16 v[244:245], v14 offset:20480
ds_read_b64_tr_b16 v[246:247], v14 offset:22528
buffer_store_dwordx4 v[68:71], v17, s[28:31], s97 offen offset:1024 sc1
s_nop 0
ds_write_b128 v19, v[68:71] offset:5120
v_mfma_f32_32x32x16_bf16 v[80:95], v[252:255], v[188:191], v[80:95]
ds_read_b64_tr_b16 v[248:249], v14 offset:24576
ds_read_b64_tr_b16 v[250:251], v14 offset:26624
v_add3_u32 v98, v64, v65, s62
v_add3_u32 v98, v98, v66, v67
s_waitcnt lgkmcnt(12)
v_mfma_f32_32x32x16_bf16 v[80:95], v[224:227], v[192:195], v[80:95]
s_nop 0
ds_read_b64_tr_b16 v[252:253], v14 offset:28672
ds_read_b64_tr_b16 v[254:255], v14 offset:30720
v_add3_u32 v98, v98, v68, v69
v_add3_u32 v98, v98, v70, v71
v_mfma_f32_32x32x16_bf16 v[80:95], v[228:231], v[196:199], v[80:95]
buffer_store_dword v98, v10, s[28:31], s1 offen offset:512 sc1
s_waitcnt lgkmcnt(10)
v_mfma_f32_32x32x16_bf16 v[80:95], v[232:235], v[200:203], v[80:95]
s_waitcnt lgkmcnt(7)
v_mfma_f32_32x32x16_bf16 v[80:95], v[236:239], v[204:207], v[80:95]
v_mfma_f32_32x32x16_bf16 v[80:95], v[240:243], v[208:211], v[80:95]
s_waitcnt lgkmcnt(5)
v_mfma_f32_32x32x16_bf16 v[80:95], v[244:247], v[212:215], v[80:95]
s_waitcnt lgkmcnt(2)
v_mfma_f32_32x32x16_bf16 v[80:95], v[248:251], v[216:219], v[80:95]
s_waitcnt lgkmcnt(0)
v_mfma_f32_32x32x16_bf16 v[80:95], v[252:255], v[220:223], v[80:95]
s_nop 11
v_cvt_pk_bf16_f32 v80, v80, v81
v_cvt_pk_bf16_f32 v81, v82, v83
v_cvt_pk_bf16_f32 v82, v84, v85
v_cvt_pk_bf16_f32 v83, v86, v87
buffer_store_dwordx4 v[80:83], v17, s[28:31], s97 offen offset:2048 sc1
ds_write_b128 v19, v[80:83] offset:6144
v_cvt_pk_bf16_f32 v84, v88, v89
v_cvt_pk_bf16_f32 v85, v90, v91
v_cvt_pk_bf16_f32 v86, v92, v93
v_cvt_pk_bf16_f32 v87, v94, v95
buffer_store_dwordx4 v[84:87], v17, s[28:31], s97 offen offset:3072 sc1
ds_write_b128 v19, v[84:87] offset:7168
v_add3_u32 v99, v80, v81, s62
v_add3_u32 v99, v99, v82, v83
v_add3_u32 v99, v99, v84, v85
v_add3_u32 v99, v99, v86, v87
buffer_store_dword v99, v10, s[28:31], s1 offen offset:768 sc1
v_lshlrev_b32 v12, 4, v1
v_lshlrev_b32 v11, 2, v1
v_add_u32 v13, s38, v12
s_waitcnt lgkmcnt(0)
s_barrier
ds_read_b128 v[112:115], v13
ds_read_b128 v[116:119], v13 offset:1024
s_mov_b64 exec, s[6:7]
s_cmp_lg_u32 s58, 0
s_cbranch_scc1 LP62
s_sleep 4
LP62:
s_cmp_lg_u32 s58, 1
s_cbranch_scc1 LP63
s_sleep 4
LP63:
s_cmp_lg_u32 s58, 2
s_cbranch_scc1 LP64
s_sleep 8
LP64:
s_cmp_lg_u32 s58, 3
s_cbranch_scc1 LP65
s_sleep 16
LP65:
LF66:
s_sub_u32 s4, s4, 1
s_cbranch_scc1 L_end
s_add_u32 s50, s39, 65536
s_and_b32 s50, s50, 0x30000
s_add_u32 s52, s5, s50
s_lshr_b32 s50, s50, 2
s_add_u32 s53, s63, s50
s_nop 0
buffer_load_dwordx4 v[120:123], v12, s[28:31], s52 offen offset:0 sc1
buffer_load_dwordx4 v[124:127], v12, s[28:31], s52 offen offset:1024 sc1
buffer_load_dword v25, v11, s[28:31], s53 offen sc1
s_add_u32 s50, s39, 131072
s_and_b32 s50, s50, 0x30000
s_add_u32 s52, s5, s50
s_lshr_b32 s50, s50, 2
s_add_u32 s53, s63, s50
buffer_load_dwordx4 v[128:131], v12, s[28:31], s52 offen offset:0 sc1
s_nop 0
buffer_load_dwordx4 v[132:135], v12, s[28:31], s52 offen offset:1024 sc1
buffer_load_dword v26, v11, s[28:31], s53 offen sc1
s_add_u32 s50, s39, 196608
s_and_b32 s50, s50, 0x30000
s_add_u32 s52, s5, s50
s_lshr_b32 s50, s50, 2
s_add_u32 s53, s63, s50
buffer_load_dwordx4 v[136:139], v12, s[28:31], s52 offen offset:0 sc1
buffer_load_dwordx4 v[140:143], v12, s[28:31], s52 offen offset:1024 sc1
s_nop 0
buffer_load_dword v27, v11, s[28:31], s53 offen sc1
s_waitcnt vmcnt(0)
v_add3_u32 v20, v120, v121, s62
v_add3_u32 v20, v20, v122, v123
v_add3_u32 v20, v20, v124, v125
v_add3_u32 v20, v20, v126, v127
v_cmp_ne_u32 s[50:51], v20, v25
v_add3_u32 v20, v128, v129, s62
s_nop 0
v_add3_u32 v20, v20, v130, v131
v_add3_u32 v20, v20, v132, v133
v_add3_u32 v20, v20, v134, v135
v_cmp_ne_u32 vcc, v20, v26
s_nop 3
s_or_b64 s[50:51], s[50:51], vcc
v_add3_u32 v20, v136, v137, s62
v_add3_u32 v20, v20, v138, v139
v_add3_u32 v20, v20, v140, v141
s_nop 0
v_add3_u32 v20, v20, v142, v143
v_cmp_ne_u32 vcc, v20, v27
s_nop 3
s_or_b64 s[50:51], s[50:51], vcc
s_cmp_lg_u64 s[50:51], 0
s_cbranch_scc1 LF66
s_waitcnt lgkmcnt(1)
v_lshlrev_b32 v160, 16, v112
v_and_b32 v161, 0xffff0000, v112
v_lshlrev_b32 v162, 16, v113
v_and_b32 v163, 0xffff0000, v113
v_lshlrev_b32_e64 v164, 16, v114
v_and_b32 v165, 0xffff0000, v114
v_lshlrev_b32 v166, 16, v115
v_and_b32 v167, 0xffff0000, v115
s_waitcnt lgkmcnt(0)
v_lshlrev_b32 v168, 16, v116
v_and_b32 v169, 0xffff0000, v116
v_lshlrev_b32 v170, 16, v117
v_and_b32 v171, 0xffff0000, v117
v_lshlrev_b32 v172, 16, v118
v_and_b32 v173, 0xffff0000, v118
v_lshlrev_b32 v174, 16, v119
v_and_b32 v175, 0xffff0000, v119
v_lshlrev_b32 v176, 16, v120
v_and_b32 v177, 0xffff0000, v120
v_lshlrev_b32 v178, 16, v121
v_and_b32 v179, 0xffff0000, v121
v_lshlrev_b32 v180, 16, v122
v_and_b32 v181, 0xffff0000, v122
v_lshlrev_b32 v182, 16, v123
v_and_b32 v183, 0xffff0000, v123
v_lshlrev_b32_e64 v184, 16, v124
v_and_b32 v185, 0xffff0000, v124
v_lshlrev_b32 v186, 16, v125
v_and_b32 v187, 0xffff0000, v125
v_lshlrev_b32 v188, 16, v126
v_and_b32 v189, 0xffff0000, v126
v_lshlrev_b32_e64 v190, 16, v127
v_and_b32 v191, 0xffff0000, v127
v_pk_add_f32 v[160:161], v[160:161], v[176:177]
v_pk_add_f32 v[162:163], v[162:163], v[178:179]
v_pk_add_f32 v[164:165], v[164:165], v[180:181]
v_pk_add_f32 v[166:167], v[166:167], v[182:183]
v_pk_add_f32 v[168:169], v[168:169], v[184:185]
v_pk_add_f32 v[170:171], v[170:171], v[186:187]
v_pk_add_f32 v[172:173], v[172:173], v[188:189]
v_pk_add_f32 v[174:175], v[174:175], v[190:191]
v_lshlrev_b32 v192, 16, v128
v_and_b32 v193, 0xffff0000, v128
v_lshlrev_b32 v194, 16, v129
v_and_b32 v195, 0xffff0000, v129
v_lshlrev_b32 v196, 16, v130
v_and_b32 v197, 0xffff0000, v130
v_lshlrev_b32 v198, 16, v131
v_and_b32 v199, 0xffff0000, v131
v_lshlrev_b32 v200, 16, v132
v_and_b32 v201, 0xffff0000, v132
v_lshlrev_b32 v202, 16, v133
v_and_b32 v203, 0xffff0000, v133
v_lshlrev_b32_e64 v204, 16, v134
v_and_b32 v205, 0xffff0000, v134
v_lshlrev_b32_e64 v206, 16, v135
v_and_b32 v207, 0xffff0000, v135
v_pk_add_f32 v[160:161], v[160:161], v[192:193]
v_pk_add_f32 v[162:163], v[162:163], v[194:195]
v_pk_add_f32 v[164:165], v[164:165], v[196:197]
v_pk_add_f32 v[166:167], v[166:167], v[198:199]
v_pk_add_f32 v[168:169], v[168:169], v[200:201]
v_pk_add_f32 v[170:171], v[170:171], v[202:203]
v_pk_add_f32 v[172:173], v[172:173], v[204:205]
v_pk_add_f32 v[174:175], v[174:175], v[206:207]
v_lshlrev_b32 v176, 16, v136
v_and_b32 v177, 0xffff0000, v136
v_lshlrev_b32 v178, 16, v137
v_and_b32 v179, 0xffff0000, v137
v_lshlrev_b32 v180, 16, v138
v_and_b32 v181, 0xffff0000, v138
v_lshlrev_b32 v182, 16, v139
v_and_b32 v183, 0xffff0000, v139
v_lshlrev_b32 v184, 16, v140
v_and_b32 v185, 0xffff0000, v140
v_lshlrev_b32 v186, 16, v141
v_and_b32 v187, 0xffff0000, v141
v_lshlrev_b32 v188, 16, v142
v_and_b32 v189, 0xffff0000, v142
v_lshlrev_b32 v190, 16, v143
v_and_b32 v191, 0xffff0000, v143
v_pk_add_f32 v[160:161], v[160:161], v[176:177]
v_pk_add_f32 v[162:163], v[162:163], v[178:179]
v_pk_add_f32 v[164:165], v[164:165], v[180:181]
v_pk_add_f32 v[166:167], v[166:167], v[182:183]
v_pk_add_f32 v[168:169], v[168:169], v[184:185]
v_pk_add_f32 v[170:171], v[170:171], v[186:187]
v_pk_add_f32 v[172:173], v[172:173], v[188:189]
v_pk_add_f32 v[174:175], v[174:175], v[190:191]
v_cvt_pk_bf16_f32 v208, v160, v161
v_cvt_pk_bf16_f32 v209, v162, v163
v_cvt_pk_bf16_f32 v210, v164, v165
v_cvt_pk_bf16_f32 v211, v166, v167
v_cvt_pk_bf16_f32 v212, v168, v169
v_cvt_pk_bf16_f32 v213, v170, v171
v_cvt_pk_bf16_f32 v214, v172, v173
v_cvt_pk_bf16_f32 v215, v174, v175
v_permlane32_swap_b32 v208, v210
v_permlane32_swap_b32 v209, v211
v_permlane32_swap_b32 v212, v214
v_permlane32_swap_b32 v213, v215
s_mov_b64 exec, s[6:7]
buffer_store_dwordx4 v[208:211], v15, s[32:35], s54 offen offset:0
buffer_store_dwordx4 v[212:215], v15, s[32:35], s54 offen offset:32
s_endpgm
LN2:
s_sub_u32 s4, s4, 1
s_cbranch_scc1 L_end
s_sleep 1
global_load_dwordx2 v[24:25], v26, s[60:61] sc1
s_waitcnt vmcnt(0)
v_readfirstlane_b32 s62, v24
s_nop 3
s_cmp_eq_u32 s62, 0
s_cbranch_scc1 LN2
s_branch LM3
LX4:
v_max_f32 v17, 0, v15
v_sub_f32 v18, 0, v17
v_exp_f32 v18, v18
v_sub_f32 v96, v96, v17
v_sub_f32 v97, v97, v17
v_sub_f32 v98, v98, v17
v_sub_f32 v99, v99, v17
v_sub_f32 v100, v100, v17
v_sub_f32 v101, v101, v17
v_sub_f32 v102, v102, v17
v_sub_f32 v103, v103, v17
v_sub_f32 v104, v104, v17
v_sub_f32 v105, v105, v17
v_sub_f32 v106, v106, v17
v_sub_f32 v107, v107, v17
v_sub_f32 v108, v108, v17
v_sub_f32 v109, v109, v17
v_sub_f32 v110, v110, v17
v_sub_f32 v111, v111, v17
v_sub_f32 v112, v112, v17
v_sub_f32 v113, v113, v17
v_sub_f32 v114, v114, v17
v_sub_f32 v115, v115, v17
v_sub_f32 v116, v116, v17
v_sub_f32 v117, v117, v17
v_sub_f32 v118, v118, v17
v_sub_f32 v119, v119, v17
v_sub_f32 v120, v120, v17
v_sub_f32 v121, v121, v17
v_sub_f32 v122, v122, v17
v_sub_f32 v123, v123, v17
v_sub_f32 v124, v124, v17
v_sub_f32 v125, v125, v17
v_sub_f32 v126, v126, v17
v_sub_f32 v127, v127, v17
v_sub_f32 v240, v240, v17
v_sub_f32 v241, v241, v17
v_sub_f32 v242, v242, v17
v_sub_f32 v243, v243, v17
v_sub_f32 v244, v244, v17
v_sub_f32 v245, v245, v17
v_sub_f32 v246, v246, v17
v_sub_f32 v247, v247, v17
v_sub_f32 v248, v248, v17
v_sub_f32 v249, v249, v17
v_sub_f32 v250, v250, v17
v_sub_f32 v251, v251, v17
v_sub_f32 v252, v252, v17
v_sub_f32 v253, v253, v17
v_sub_f32 v254, v254, v17
v_sub_f32 v255, v255, v17
v_mul_f32 v14, v14, v18
v_mul_f32 v128, v128, v18
v_mul_f32 v129, v129, v18
v_mul_f32 v130, v130, v18
v_mul_f32 v131, v131, v18
v_mul_f32 v132, v132, v18
v_mul_f32 v133, v133, v18
v_mul_f32 v134, v134, v18
v_mul_f32 v135, v135, v18
v_mul_f32 v136, v136, v18
v_mul_f32 v137, v137, v18
v_mul_f32 v138, v138, v18
v_mul_f32 v139, v139, v18
v_mul_f32 v140, v140, v18
v_mul_f32 v141, v141, v18
v_mul_f32 v142, v142, v18
v_mul_f32 v143, v143, v18
v_mul_f32 v144, v144, v18
v_mul_f32 v145, v145, v18
v_mul_f32 v146, v146, v18
v_mul_f32 v147, v147, v18
v_mul_f32 v148, v148, v18
v_mul_f32 v149, v149, v18
v_mul_f32 v150, v150, v18
v_mul_f32 v151, v151, v18
v_mul_f32 v152, v152, v18
v_mul_f32 v153, v153, v18
v_mul_f32 v154, v154, v18
v_mul_f32 v155, v155, v18
v_mul_f32 v156, v156, v18
v_mul_f32 v157, v157, v18
v_mul_f32 v158, v158, v18
v_mul_f32 v159, v159, v18
v_mul_f32 v160, v160, v18
v_mul_f32 v161, v161, v18
v_mul_f32 v162, v162, v18
v_mul_f32 v163, v163, v18
v_mul_f32 v164, v164, v18
v_mul_f32 v165, v165, v18
v_mul_f32 v166, v166, v18
v_mul_f32 v167, v167, v18
v_mul_f32 v168, v168, v18
v_mul_f32 v169, v169, v18
v_mul_f32 v170, v170, v18
v_mul_f32 v171, v171, v18
v_mul_f32 v172, v172, v18
v_mul_f32 v173, v173, v18
v_mul_f32 v174, v174, v18
v_mul_f32 v175, v175, v18
v_mul_f32 v176, v176, v18
v_mul_f32 v177, v177, v18
v_mul_f32 v178, v178, v18
v_mul_f32 v179, v179, v18
v_mul_f32 v180, v180, v18
v_mul_f32 v181, v181, v18
v_mul_f32 v182, v182, v18
v_mul_f32 v183, v183, v18
v_mul_f32 v184, v184, v18
v_mul_f32 v185, v185, v18
v_mul_f32 v186, v186, v18
v_mul_f32 v187, v187, v18
v_mul_f32 v188, v188, v18
v_mul_f32 v189, v189, v18
v_mul_f32 v190, v190, v18
v_mul_f32 v191, v191, v18
s_nop 3
s_branch LB5
LX6:
v_max_f32 v17, 0, v15
v_sub_f32 v18, 0, v17
v_exp_f32 v18, v18
v_sub_f32 v64, v64, v17
v_sub_f32 v65, v65, v17
v_sub_f32 v66, v66, v17
v_sub_f32 v67, v67, v17
v_sub_f32 v68, v68, v17
v_sub_f32 v69, v69, v17
v_sub_f32 v70, v70, v17
v_sub_f32 v71, v71, v17
v_sub_f32 v72, v72, v17
v_sub_f32 v73, v73, v17
v_sub_f32 v74, v74, v17
v_sub_f32 v75, v75, v17
v_sub_f32 v76, v76, v17
v_sub_f32 v77, v77, v17
v_sub_f32 v78, v78, v17
v_sub_f32 v79, v79, v17
v_sub_f32 v80, v80, v17
v_sub_f32 v81, v81, v17
v_sub_f32 v82, v82, v17
v_sub_f32 v83, v83, v17
v_sub_f32 v84, v84, v17
v_sub_f32 v85, v85, v17
v_sub_f32 v86, v86, v17
v_sub_f32 v87, v87, v17
v_sub_f32 v88, v88, v17
v_sub_f32 v89, v89, v17
v_sub_f32 v90, v90, v17
v_sub_f32 v91, v91, v17
v_sub_f32 v92, v92, v17
v_sub_f32 v93, v93, v17
v_sub_f32 v94, v94, v17
v_sub_f32 v95, v95, v17
v_sub_f32 v240, v240, v17
v_sub_f32 v241, v241, v17
v_sub_f32 v242, v242, v17
v_sub_f32 v243, v243, v17
v_sub_f32 v244, v244, v17
v_sub_f32 v245, v245, v17
v_sub_f32 v246, v246, v17
v_sub_f32 v247, v247, v17
v_sub_f32 v248, v248, v17
v_sub_f32 v249, v249, v17
v_sub_f32 v250, v250, v17
v_sub_f32 v251, v251, v17
v_sub_f32 v252, v252, v17
v_sub_f32 v253, v253, v17
v_sub_f32 v254, v254, v17
v_sub_f32 v255, v255, v17
v_mul_f32 v14, v14, v18
v_mul_f32 v128, v128, v18
v_mul_f32 v129, v129, v18
v_mul_f32 v130, v130, v18
v_mul_f32 v131, v131, v18
v_mul_f32 v132, v132, v18
v_mul_f32 v133, v133, v18
v_mul_f32 v134, v134, v18
v_mul_f32 v135, v135, v18
v_mul_f32 v136, v136, v18
v_mul_f32 v137, v137, v18
v_mul_f32 v138, v138, v18
v_mul_f32 v139, v139, v18
v_mul_f32 v140, v140, v18
v_mul_f32 v141, v141, v18
v_mul_f32 v142, v142, v18
v_mul_f32 v143, v143, v18
v_mul_f32 v144, v144, v18
v_mul_f32 v145, v145, v18
v_mul_f32 v146, v146, v18
v_mul_f32 v147, v147, v18
v_mul_f32 v148, v148, v18
v_mul_f32 v149, v149, v18
v_mul_f32 v150, v150, v18
v_mul_f32 v151, v151, v18
v_mul_f32 v152, v152, v18
v_mul_f32 v153, v153, v18
v_mul_f32 v154, v154, v18
v_mul_f32 v155, v155, v18
v_mul_f32 v156, v156, v18
v_mul_f32 v157, v157, v18
v_mul_f32 v158, v158, v18
v_mul_f32 v159, v159, v18
v_mul_f32 v160, v160, v18
v_mul_f32 v161, v161, v18
v_mul_f32 v162, v162, v18
v_mul_f32 v163, v163, v18
v_mul_f32 v164, v164, v18
v_mul_f32 v165, v165, v18
v_mul_f32 v166, v166, v18
v_mul_f32 v167, v167, v18
v_mul_f32 v168, v168, v18
v_mul_f32 v169, v169, v18
v_mul_f32 v170, v170, v18
v_mul_f32 v171, v171, v18
v_mul_f32 v172, v172, v18
v_mul_f32 v173, v173, v18
v_mul_f32 v174, v174, v18
v_mul_f32 v175, v175, v18
v_mul_f32 v176, v176, v18
v_mul_f32 v177, v177, v18
v_mul_f32 v178, v178, v18
v_mul_f32 v179, v179, v18
v_mul_f32 v180, v180, v18
v_mul_f32 v181, v181, v18
v_mul_f32 v182, v182, v18
v_mul_f32 v183, v183, v18
v_mul_f32 v184, v184, v18
v_mul_f32 v185, v185, v18
v_mul_f32 v186, v186, v18
v_mul_f32 v187, v187, v18
v_mul_f32 v188, v188, v18
v_mul_f32 v189, v189, v18
v_mul_f32 v190, v190, v18
v_mul_f32 v191, v191, v18
s_nop 3
s_branch LB7
LX8:
v_max_f32 v17, 0, v15
v_sub_f32 v18, 0, v17
v_exp_f32 v18, v18
v_sub_f32 v96, v96, v17
v_sub_f32 v97, v97, v17
v_sub_f32 v98, v98, v17
v_sub_f32 v99, v99, v17
v_sub_f32 v100, v100, v17
v_sub_f32 v101, v101, v17
v_sub_f32 v102, v102, v17
v_sub_f32 v103, v103, v17
v_sub_f32 v104, v104, v17
v_sub_f32 v105, v105, v17
v_sub_f32 v106, v106, v17
v_sub_f32 v107, v107, v17
v_sub_f32 v108, v108, v17
v_sub_f32 v109, v109, v17
v_sub_f32 v110, v110, v17
v_sub_f32 v111, v111, v17
v_sub_f32 v112, v112, v17
v_sub_f32 v113, v113, v17
v_sub_f32 v114, v114, v17
v_sub_f32 v115, v115, v17
v_sub_f32 v116, v116, v17
v_sub_f32 v117, v117, v17
v_sub_f32 v118, v118, v17
v_sub_f32 v119, v119, v17
v_sub_f32 v120, v120, v17
v_sub_f32 v121, v121, v17
v_sub_f32 v122, v122, v17
v_sub_f32 v123, v123, v17
v_sub_f32 v124, v124, v17
v_sub_f32 v125, v125, v17
v_sub_f32 v126, v126, v17
v_sub_f32 v127, v127, v17
v_sub_f32 v240, v240, v17
v_sub_f32 v241, v241, v17
v_sub_f32 v242, v242, v17
v_sub_f32 v243, v243, v17
v_sub_f32 v244, v244, v17
v_sub_f32 v245, v245, v17
v_sub_f32 v246, v246, v17
v_sub_f32 v247, v247, v17
v_sub_f32 v248, v248, v17
v_sub_f32 v249, v249, v17
v_sub_f32 v250, v250, v17
v_sub_f32 v251, v251, v17
v_sub_f32 v252, v252, v17
v_sub_f32 v253, v253, v17
v_sub_f32 v254, v254, v17
v_sub_f32 v255, v255, v17
v_mul_f32 v14, v14, v18
v_mul_f32 v128, v128, v18
v_mul_f32 v129, v129, v18
v_mul_f32 v130, v130, v18
v_mul_f32 v131, v131, v18
v_mul_f32 v132, v132, v18
v_mul_f32 v133, v133, v18
v_mul_f32 v134, v134, v18
v_mul_f32 v135, v135, v18
v_mul_f32 v136, v136, v18
v_mul_f32 v137, v137, v18
v_mul_f32 v138, v138, v18
v_mul_f32 v139, v139, v18
v_mul_f32 v140, v140, v18
v_mul_f32 v141, v141, v18
v_mul_f32 v142, v142, v18
v_mul_f32 v143, v143, v18
v_mul_f32 v144, v144, v18
v_mul_f32 v145, v145, v18
v_mul_f32 v146, v146, v18
v_mul_f32 v147, v147, v18
v_mul_f32 v148, v148, v18
v_mul_f32 v149, v149, v18
v_mul_f32 v150, v150, v18
v_mul_f32 v151, v151, v18
v_mul_f32 v152, v152, v18
v_mul_f32 v153, v153, v18
v_mul_f32 v154, v154, v18
v_mul_f32 v155, v155, v18
v_mul_f32 v156, v156, v18
v_mul_f32 v157, v157, v18
v_mul_f32 v158, v158, v18
v_mul_f32 v159, v159, v18
v_mul_f32 v160, v160, v18
v_mul_f32 v161, v161, v18
v_mul_f32 v162, v162, v18
v_mul_f32 v163, v163, v18
v_mul_f32 v164, v164, v18
v_mul_f32 v165, v165, v18
v_mul_f32 v166, v166, v18
v_mul_f32 v167, v167, v18
v_mul_f32 v168, v168, v18
v_mul_f32 v169, v169, v18
v_mul_f32 v170, v170, v18
v_mul_f32 v171, v171, v18
v_mul_f32 v172, v172, v18
v_mul_f32 v173, v173, v18
v_mul_f32 v174, v174, v18
v_mul_f32 v175, v175, v18
v_mul_f32 v176, v176, v18
v_mul_f32 v177, v177, v18
v_mul_f32 v178, v178, v18
v_mul_f32 v179, v179, v18
v_mul_f32 v180, v180, v18
v_mul_f32 v181, v181, v18
v_mul_f32 v182, v182, v18
v_mul_f32 v183, v183, v18
v_mul_f32 v184, v184, v18
v_mul_f32 v185, v185, v18
v_mul_f32 v186, v186, v18
v_mul_f32 v187, v187, v18
v_mul_f32 v188, v188, v18
v_mul_f32 v189, v189, v18
v_mul_f32 v190, v190, v18
v_mul_f32 v191, v191, v18
s_nop 3
s_branch LB9
LX10:
v_max_f32 v17, 0, v15
v_sub_f32 v18, 0, v17
v_exp_f32 v18, v18
v_sub_f32 v64, v64, v17
v_sub_f32 v65, v65, v17
v_sub_f32 v66, v66, v17
v_sub_f32 v67, v67, v17
v_sub_f32 v68, v68, v17
v_sub_f32 v69, v69, v17
v_sub_f32 v70, v70, v17
v_sub_f32 v71, v71, v17
v_sub_f32 v72, v72, v17
v_sub_f32 v73, v73, v17
v_sub_f32 v74, v74, v17
v_sub_f32 v75, v75, v17
v_sub_f32 v76, v76, v17
v_sub_f32 v77, v77, v17
v_sub_f32 v78, v78, v17
v_sub_f32 v79, v79, v17
v_sub_f32 v80, v80, v17
v_sub_f32 v81, v81, v17
v_sub_f32 v82, v82, v17
v_sub_f32 v83, v83, v17
v_sub_f32 v84, v84, v17
v_sub_f32 v85, v85, v17
v_sub_f32 v86, v86, v17
v_sub_f32 v87, v87, v17
v_sub_f32 v88, v88, v17
v_sub_f32 v89, v89, v17
v_sub_f32 v90, v90, v17
v_sub_f32 v91, v91, v17
v_sub_f32 v92, v92, v17
v_sub_f32 v93, v93, v17
v_sub_f32 v94, v94, v17
v_sub_f32 v95, v95, v17
v_sub_f32 v240, v240, v17
v_sub_f32 v241, v241, v17
v_sub_f32 v242, v242, v17
v_sub_f32 v243, v243, v17
v_sub_f32 v244, v244, v17
v_sub_f32 v245, v245, v17
v_sub_f32 v246, v246, v17
v_sub_f32 v247, v247, v17
v_sub_f32 v248, v248, v17
v_sub_f32 v249, v249, v17
v_sub_f32 v250, v250, v17
v_sub_f32 v251, v251, v17
v_sub_f32 v252, v252, v17
v_sub_f32 v253, v253, v17
v_sub_f32 v254, v254, v17
v_sub_f32 v255, v255, v17
v_mul_f32 v14, v14, v18
v_mul_f32 v128, v128, v18
v_mul_f32 v129, v129, v18
v_mul_f32 v130, v130, v18
v_mul_f32 v131, v131, v18
v_mul_f32 v132, v132, v18
v_mul_f32 v133, v133, v18
v_mul_f32 v134, v134, v18
v_mul_f32 v135, v135, v18
v_mul_f32 v136, v136, v18
v_mul_f32 v137, v137, v18
v_mul_f32 v138, v138, v18
v_mul_f32 v139, v139, v18
v_mul_f32 v140, v140, v18
v_mul_f32 v141, v141, v18
v_mul_f32 v142, v142, v18
v_mul_f32 v143, v143, v18
v_mul_f32 v144, v144, v18
v_mul_f32 v145, v145, v18
v_mul_f32 v146, v146, v18
v_mul_f32 v147, v147, v18
v_mul_f32 v148, v148, v18
v_mul_f32 v149, v149, v18
v_mul_f32 v150, v150, v18
v_mul_f32 v151, v151, v18
v_mul_f32 v152, v152, v18
v_mul_f32 v153, v153, v18
v_mul_f32 v154, v154, v18
v_mul_f32 v155, v155, v18
v_mul_f32 v156, v156, v18
v_mul_f32 v157, v157, v18
v_mul_f32 v158, v158, v18
v_mul_f32 v159, v159, v18
v_mul_f32 v160, v160, v18
v_mul_f32 v161, v161, v18
v_mul_f32 v162, v162, v18
v_mul_f32 v163, v163, v18
v_mul_f32 v164, v164, v18
v_mul_f32 v165, v165, v18
v_mul_f32 v166, v166, v18
v_mul_f32 v167, v167, v18
v_mul_f32 v168, v168, v18
v_mul_f32 v169, v169, v18
v_mul_f32 v170, v170, v18
v_mul_f32 v171, v171, v18
v_mul_f32 v172, v172, v18
v_mul_f32 v173, v173, v18
v_mul_f32 v174, v174, v18
v_mul_f32 v175, v175, v18
v_mul_f32 v176, v176, v18
v_mul_f32 v177, v177, v18
v_mul_f32 v178, v178, v18
v_mul_f32 v179, v179, v18
v_mul_f32 v180, v180, v18
v_mul_f32 v181, v181, v18
v_mul_f32 v182, v182, v18
v_mul_f32 v183, v183, v18
v_mul_f32 v184, v184, v18
v_mul_f32 v185, v185, v18
v_mul_f32 v186, v186, v18
v_mul_f32 v187, v187, v18
v_mul_f32 v188, v188, v18
v_mul_f32 v189, v189, v18
v_mul_f32 v190, v190, v18
v_mul_f32 v191, v191, v18
s_nop 3
s_branch LB11
LX12:
v_max_f32 v17, 0, v15
v_sub_f32 v18, 0, v17
v_exp_f32 v18, v18
v_sub_f32 v96, v96, v17
v_sub_f32 v97, v97, v17
v_sub_f32 v98, v98, v17
v_sub_f32 v99, v99, v17
v_sub_f32 v100, v100, v17
v_sub_f32 v101, v101, v17
v_sub_f32 v102, v102, v17
v_sub_f32 v103, v103, v17
v_sub_f32 v104, v104, v17
v_sub_f32 v105, v105, v17
v_sub_f32 v106, v106, v17
v_sub_f32 v107, v107, v17
v_sub_f32 v108, v108, v17
v_sub_f32 v109, v109, v17
v_sub_f32 v110, v110, v17
v_sub_f32 v111, v111, v17
v_sub_f32 v112, v112, v17
v_sub_f32 v113, v113, v17
v_sub_f32 v114, v114, v17
v_sub_f32 v115, v115, v17
v_sub_f32 v116, v116, v17
v_sub_f32 v117, v117, v17
v_sub_f32 v118, v118, v17
v_sub_f32 v119, v119, v17
v_sub_f32 v120, v120, v17
v_sub_f32 v121, v121, v17
v_sub_f32 v122, v122, v17
v_sub_f32 v123, v123, v17
v_sub_f32 v124, v124, v17
v_sub_f32 v125, v125, v17
v_sub_f32 v126, v126, v17
v_sub_f32 v127, v127, v17
v_sub_f32 v240, v240, v17
v_sub_f32 v241, v241, v17
v_sub_f32 v242, v242, v17
v_sub_f32 v243, v243, v17
v_sub_f32 v244, v244, v17
v_sub_f32 v245, v245, v17
v_sub_f32 v246, v246, v17
v_sub_f32 v247, v247, v17
v_sub_f32 v248, v248, v17
v_sub_f32 v249, v249, v17
v_sub_f32 v250, v250, v17
v_sub_f32 v251, v251, v17
v_sub_f32 v252, v252, v17
v_sub_f32 v253, v253, v17
v_sub_f32 v254, v254, v17
v_sub_f32 v255, v255, v17
v_mul_f32 v14, v14, v18
v_mul_f32 v128, v128, v18
v_mul_f32 v129, v129, v18
v_mul_f32 v130, v130, v18
v_mul_f32 v131, v131, v18
v_mul_f32 v132, v132, v18
v_mul_f32 v133, v133, v18
v_mul_f32 v134, v134, v18
v_mul_f32 v135, v135, v18
v_mul_f32 v136, v136, v18
v_mul_f32 v137, v137, v18
v_mul_f32 v138, v138, v18
v_mul_f32 v139, v139, v18
v_mul_f32 v140, v140, v18
v_mul_f32 v141, v141, v18
v_mul_f32 v142, v142, v18
v_mul_f32 v143, v143, v18
v_mul_f32 v144, v144, v18
v_mul_f32 v145, v145, v18
v_mul_f32 v146, v146, v18
v_mul_f32 v147, v147, v18
v_mul_f32 v148, v148, v18
v_mul_f32 v149, v149, v18
v_mul_f32 v150, v150, v18
v_mul_f32 v151, v151, v18
v_mul_f32 v152, v152, v18
v_mul_f32 v153, v153, v18
v_mul_f32 v154, v154, v18
v_mul_f32 v155, v155, v18
v_mul_f32 v156, v156, v18
v_mul_f32 v157, v157, v18
v_mul_f32 v158, v158, v18
v_mul_f32 v159, v159, v18
v_mul_f32 v160, v160, v18
v_mul_f32 v161, v161, v18
v_mul_f32 v162, v162, v18
v_mul_f32 v163, v163, v18
v_mul_f32 v164, v164, v18
v_mul_f32 v165, v165, v18
v_mul_f32 v166, v166, v18
v_mul_f32 v167, v167, v18
v_mul_f32 v168, v168, v18
v_mul_f32 v169, v169, v18
v_mul_f32 v170, v170, v18
v_mul_f32 v171, v171, v18
v_mul_f32 v172, v172, v18
v_mul_f32 v173, v173, v18
v_mul_f32 v174, v174, v18
v_mul_f32 v175, v175, v18
v_mul_f32 v176, v176, v18
v_mul_f32 v177, v177, v18
v_mul_f32 v178, v178, v18
v_mul_f32 v179, v179, v18
v_mul_f32 v180, v180, v18
v_mul_f32 v181, v181, v18
v_mul_f32 v182, v182, v18
v_mul_f32 v183, v183, v18
v_mul_f32 v184, v184, v18
v_mul_f32 v185, v185, v18
v_mul_f32 v186, v186, v18
v_mul_f32 v187, v187, v18
v_mul_f32 v188, v188, v18
v_mul_f32 v189, v189, v18
v_mul_f32 v190, v190, v18
v_mul_f32 v191, v191, v18
s_nop 3
s_branch LB13
LX14:
v_max_f32 v17, 0, v15
v_sub_f32 v18, 0, v17
v_exp_f32 v18, v18
v_sub_f32 v64, v64, v17
v_sub_f32 v65, v65, v17
v_sub_f32 v66, v66, v17
v_sub_f32 v67, v67, v17
v_sub_f32 v68, v68, v17
v_sub_f32 v69, v69, v17
v_sub_f32 v70, v70, v17
v_sub_f32 v71, v71, v17
v_sub_f32 v72, v72, v17
v_sub_f32 v73, v73, v17
v_sub_f32 v74, v74, v17
v_sub_f32 v75, v75, v17
v_sub_f32 v76, v76, v17
v_sub_f32 v77, v77, v17
v_sub_f32 v78, v78, v17
v_sub_f32 v79, v79, v17
v_sub_f32 v80, v80, v17
v_sub_f32 v81, v81, v17
v_sub_f32 v82, v82, v17
v_sub_f32 v83, v83, v17
v_sub_f32 v84, v84, v17
v_sub_f32 v85, v85, v17
v_sub_f32 v86, v86, v17
v_sub_f32 v87, v87, v17
v_sub_f32 v88, v88, v17
v_sub_f32 v89, v89, v17
v_sub_f32 v90, v90, v17
v_sub_f32 v91, v91, v17
v_sub_f32 v92, v92, v17
v_sub_f32 v93, v93, v17
v_sub_f32 v94, v94, v17
v_sub_f32 v95, v95, v17
v_sub_f32 v240, v240, v17
v_sub_f32 v241, v241, v17
v_sub_f32 v242, v242, v17
v_sub_f32 v243, v243, v17
v_sub_f32 v244, v244, v17
v_sub_f32 v245, v245, v17
v_sub_f32 v246, v246, v17
v_sub_f32 v247, v247, v17
v_sub_f32 v248, v248, v17
v_sub_f32 v249, v249, v17
v_sub_f32 v250, v250, v17
v_sub_f32 v251, v251, v17
v_sub_f32 v252, v252, v17
v_sub_f32 v253, v253, v17
v_sub_f32 v254, v254, v17
v_sub_f32 v255, v255, v17
v_mul_f32 v14, v14, v18
v_mul_f32 v128, v128, v18
v_mul_f32 v129, v129, v18
v_mul_f32 v130, v130, v18
v_mul_f32 v131, v131, v18
v_mul_f32 v132, v132, v18
v_mul_f32 v133, v133, v18
v_mul_f32 v134, v134, v18
v_mul_f32 v135, v135, v18
v_mul_f32 v136, v136, v18
v_mul_f32 v137, v137, v18
v_mul_f32 v138, v138, v18
v_mul_f32 v139, v139, v18
v_mul_f32 v140, v140, v18
v_mul_f32 v141, v141, v18
v_mul_f32 v142, v142, v18
v_mul_f32 v143, v143, v18
v_mul_f32 v144, v144, v18
v_mul_f32 v145, v145, v18
v_mul_f32 v146, v146, v18
v_mul_f32 v147, v147, v18
v_mul_f32 v148, v148, v18
v_mul_f32 v149, v149, v18
v_mul_f32 v150, v150, v18
v_mul_f32 v151, v151, v18
v_mul_f32 v152, v152, v18
v_mul_f32 v153, v153, v18
v_mul_f32 v154, v154, v18
v_mul_f32 v155, v155, v18
v_mul_f32 v156, v156, v18
v_mul_f32 v157, v157, v18
v_mul_f32 v158, v158, v18
v_mul_f32 v159, v159, v18
v_mul_f32 v160, v160, v18
v_mul_f32 v161, v161, v18
v_mul_f32 v162, v162, v18
v_mul_f32 v163, v163, v18
v_mul_f32 v164, v164, v18
v_mul_f32 v165, v165, v18
v_mul_f32 v166, v166, v18
v_mul_f32 v167, v167, v18
v_mul_f32 v168, v168, v18
v_mul_f32 v169, v169, v18
v_mul_f32 v170, v170, v18
v_mul_f32 v171, v171, v18
v_mul_f32 v172, v172, v18
v_mul_f32 v173, v173, v18
v_mul_f32 v174, v174, v18
v_mul_f32 v175, v175, v18
v_mul_f32 v176, v176, v18
v_mul_f32 v177, v177, v18
v_mul_f32 v178, v178, v18
v_mul_f32 v179, v179, v18
v_mul_f32 v180, v180, v18
v_mul_f32 v181, v181, v18
v_mul_f32 v182, v182, v18
v_mul_f32 v183, v183, v18
v_mul_f32 v184, v184, v18
v_mul_f32 v185, v185, v18
v_mul_f32 v186, v186, v18
v_mul_f32 v187, v187, v18
v_mul_f32 v188, v188, v18
v_mul_f32 v189, v189, v18
v_mul_f32 v190, v190, v18
v_mul_f32 v191, v191, v18
s_nop 3
s_branch LB15
LN16:
s_sub_u32 s4, s4, 1
s_cbranch_scc1 L_end
s_sleep 1
global_load_dwordx2 v[20:21], v22, s[60:61] sc1
s_waitcnt vmcnt(0)
v_readfirstlane_b32 s62, v20
s_nop 3
s_cmp_eq_u32 s62, 0
s_cbranch_scc1 LN16
s_branch LM17
LX18:
v_max_f32 v17, 0, v15
v_sub_f32 v18, 0, v17
v_exp_f32 v18, v18
v_sub_f32 v96, v96, v17
v_sub_f32 v97, v97, v17
v_sub_f32 v98, v98, v17
v_sub_f32 v99, v99, v17
v_sub_f32 v100, v100, v17
v_sub_f32 v101, v101, v17
v_sub_f32 v102, v102, v17
v_sub_f32 v103, v103, v17
v_sub_f32 v104, v104, v17
v_sub_f32 v105, v105, v17
v_sub_f32 v106, v106, v17
v_sub_f32 v107, v107, v17
v_sub_f32 v108, v108, v17
v_sub_f32 v109, v109, v17
v_sub_f32 v110, v110, v17
v_sub_f32 v111, v111, v17
v_sub_f32 v112, v112, v17
v_sub_f32 v113, v113, v17
v_sub_f32 v114, v114, v17
v_sub_f32 v115, v115, v17
v_sub_f32 v116, v116, v17
v_sub_f32 v117, v117, v17
v_sub_f32 v118, v118, v17
v_sub_f32 v119, v119, v17
v_sub_f32 v120, v120, v17
v_sub_f32 v121, v121, v17
v_sub_f32 v122, v122, v17
v_sub_f32 v123, v123, v17
v_sub_f32 v124, v124, v17
v_sub_f32 v125, v125, v17
v_sub_f32 v126, v126, v17
v_sub_f32 v127, v127, v17
v_sub_f32 v240, v240, v17
v_sub_f32 v241, v241, v17
v_sub_f32 v242, v242, v17
v_sub_f32 v243, v243, v17
v_sub_f32 v244, v244, v17
v_sub_f32 v245, v245, v17
v_sub_f32 v246, v246, v17
v_sub_f32 v247, v247, v17
v_sub_f32 v248, v248, v17
v_sub_f32 v249, v249, v17
v_sub_f32 v250, v250, v17
v_sub_f32 v251, v251, v17
v_sub_f32 v252, v252, v17
v_sub_f32 v253, v253, v17
v_sub_f32 v254, v254, v17
v_sub_f32 v255, v255, v17
v_mul_f32 v14, v14, v18
v_mul_f32 v128, v128, v18
v_mul_f32 v129, v129, v18
v_mul_f32 v130, v130, v18
v_mul_f32 v131, v131, v18
v_mul_f32 v132, v132, v18
v_mul_f32 v133, v133, v18
v_mul_f32 v134, v134, v18
v_mul_f32 v135, v135, v18
v_mul_f32 v136, v136, v18
v_mul_f32 v137, v137, v18
v_mul_f32 v138, v138, v18
v_mul_f32 v139, v139, v18
v_mul_f32 v140, v140, v18
v_mul_f32 v141, v141, v18
v_mul_f32 v142, v142, v18
v_mul_f32 v143, v143, v18
v_mul_f32 v144, v144, v18
v_mul_f32 v145, v145, v18
v_mul_f32 v146, v146, v18
v_mul_f32 v147, v147, v18
v_mul_f32 v148, v148, v18
v_mul_f32 v149, v149, v18
v_mul_f32 v150, v150, v18
v_mul_f32 v151, v151, v18
v_mul_f32 v152, v152, v18
v_mul_f32 v153, v153, v18
v_mul_f32 v154, v154, v18
v_mul_f32 v155, v155, v18
v_mul_f32 v156, v156, v18
v_mul_f32 v157, v157, v18
v_mul_f32 v158, v158, v18
v_mul_f32 v159, v159, v18
v_mul_f32 v160, v160, v18
v_mul_f32 v161, v161, v18
v_mul_f32 v162, v162, v18
v_mul_f32 v163, v163, v18
v_mul_f32 v164, v164, v18
v_mul_f32 v165, v165, v18
v_mul_f32 v166, v166, v18
v_mul_f32 v167, v167, v18
v_mul_f32 v168, v168, v18
v_mul_f32 v169, v169, v18
v_mul_f32 v170, v170, v18
v_mul_f32 v171, v171, v18
v_mul_f32 v172, v172, v18
v_mul_f32 v173, v173, v18
v_mul_f32 v174, v174, v18
v_mul_f32 v175, v175, v18
v_mul_f32 v176, v176, v18
v_mul_f32 v177, v177, v18
v_mul_f32 v178, v178, v18
v_mul_f32 v179, v179, v18
v_mul_f32 v180, v180, v18
v_mul_f32 v181, v181, v18
v_mul_f32 v182, v182, v18
v_mul_f32 v183, v183, v18
v_mul_f32 v184, v184, v18
v_mul_f32 v185, v185, v18
v_mul_f32 v186, v186, v18
v_mul_f32 v187, v187, v18
v_mul_f32 v188, v188, v18
v_mul_f32 v189, v189, v18
v_mul_f32 v190, v190, v18
v_mul_f32 v191, v191, v18
s_nop 3
s_branch LB19
LX20:
v_max_f32 v17, 0, v15
v_sub_f32 v18, 0, v17
v_exp_f32 v18, v18
v_sub_f32 v96, v96, v17
v_sub_f32 v97, v97, v17
v_sub_f32 v98, v98, v17
v_sub_f32 v99, v99, v17
v_sub_f32 v100, v100, v17
v_sub_f32 v101, v101, v17
v_sub_f32 v102, v102, v17
v_sub_f32 v103, v103, v17
v_sub_f32 v104, v104, v17
v_sub_f32 v105, v105, v17
v_sub_f32 v106, v106, v17
v_sub_f32 v107, v107, v17
v_sub_f32 v108, v108, v17
v_sub_f32 v109, v109, v17
v_sub_f32 v110, v110, v17
v_sub_f32 v111, v111, v17
v_sub_f32 v112, v112, v17
v_sub_f32 v113, v113, v17
v_sub_f32 v114, v114, v17
v_sub_f32 v115, v115, v17
v_sub_f32 v116, v116, v17
v_sub_f32 v117, v117, v17
v_sub_f32 v118, v118, v17
v_sub_f32 v119, v119, v17
v_sub_f32 v120, v120, v17
v_sub_f32 v121, v121, v17
v_sub_f32 v122, v122, v17
v_sub_f32 v123, v123, v17
v_sub_f32 v124, v124, v17
v_sub_f32 v125, v125, v17
v_sub_f32 v126, v126, v17
v_sub_f32 v127, v127, v17
v_sub_f32 v240, v240, v17
v_sub_f32 v241, v241, v17
v_sub_f32 v242, v242, v17
v_sub_f32 v243, v243, v17
v_sub_f32 v244, v244, v17
v_sub_f32 v245, v245, v17
v_sub_f32 v246, v246, v17
v_sub_f32 v247, v247, v17
v_sub_f32 v248, v248, v17
v_sub_f32 v249, v249, v17
v_sub_f32 v250, v250, v17
v_sub_f32 v251, v251, v17
v_sub_f32 v252, v252, v17
v_sub_f32 v253, v253, v17
v_sub_f32 v254, v254, v17
v_sub_f32 v255, v255, v17
v_mul_f32 v14, v14, v18
v_mul_f32 v128, v128, v18
v_mul_f32 v129, v129, v18
v_mul_f32 v130, v130, v18
v_mul_f32 v131, v131, v18
v_mul_f32 v132, v132, v18
v_mul_f32 v133, v133, v18
v_mul_f32 v134, v134, v18
v_mul_f32 v135, v135, v18
v_mul_f32 v136, v136, v18
v_mul_f32 v137, v137, v18
v_mul_f32 v138, v138, v18
v_mul_f32 v139, v139, v18
v_mul_f32 v140, v140, v18
v_mul_f32 v141, v141, v18
v_mul_f32 v142, v142, v18
v_mul_f32 v143, v143, v18
v_mul_f32 v144, v144, v18
v_mul_f32 v145, v145, v18
v_mul_f32 v146, v146, v18
v_mul_f32 v147, v147, v18
v_mul_f32 v148, v148, v18
v_mul_f32 v149, v149, v18
v_mul_f32 v150, v150, v18
v_mul_f32 v151, v151, v18
v_mul_f32 v152, v152, v18
v_mul_f32 v153, v153, v18
v_mul_f32 v154, v154, v18
v_mul_f32 v155, v155, v18
v_mul_f32 v156, v156, v18
v_mul_f32 v157, v157, v18
v_mul_f32 v158, v158, v18
v_mul_f32 v159, v159, v18
v_mul_f32 v160, v160, v18
v_mul_f32 v161, v161, v18
v_mul_f32 v162, v162, v18
v_mul_f32 v163, v163, v18
v_mul_f32 v164, v164, v18
v_mul_f32 v165, v165, v18
v_mul_f32 v166, v166, v18
v_mul_f32 v167, v167, v18
v_mul_f32 v168, v168, v18
v_mul_f32 v169, v169, v18
v_mul_f32 v170, v170, v18
v_mul_f32 v171, v171, v18
v_mul_f32 v172, v172, v18
v_mul_f32 v173, v173, v18
v_mul_f32 v174, v174, v18
v_mul_f32 v175, v175, v18
v_mul_f32 v176, v176, v18
v_mul_f32 v177, v177, v18
v_mul_f32 v178, v178, v18
v_mul_f32 v179, v179, v18
v_mul_f32 v180, v180, v18
v_mul_f32 v181, v181, v18
v_mul_f32 v182, v182, v18
v_mul_f32 v183, v183, v18
v_mul_f32 v184, v184, v18
v_mul_f32 v185, v185, v18
v_mul_f32 v186, v186, v18
v_mul_f32 v187, v187, v18
v_mul_f32 v188, v188, v18
v_mul_f32 v189, v189, v18
v_mul_f32 v190, v190, v18
v_mul_f32 v191, v191, v18
s_nop 3
s_branch LB21
LX22:
v_max_f32 v17, 0, v15
v_sub_f32 v18, 0, v17
v_exp_f32 v18, v18
v_sub_f32 v64, v64, v17
v_sub_f32 v65, v65, v17
v_sub_f32 v66, v66, v17
v_sub_f32 v67, v67, v17
v_sub_f32 v68, v68, v17
v_sub_f32 v69, v69, v17
v_sub_f32 v70, v70, v17
v_sub_f32 v71, v71, v17
v_sub_f32 v72, v72, v17
v_sub_f32 v73, v73, v17
v_sub_f32 v74, v74, v17
v_sub_f32 v75, v75, v17
v_sub_f32 v76, v76, v17
v_sub_f32 v77, v77, v17
v_sub_f32 v78, v78, v17
v_sub_f32 v79, v79, v17
v_sub_f32 v80, v80, v17
v_sub_f32 v81, v81, v17
v_sub_f32 v82, v82, v17
v_sub_f32 v83, v83, v17
v_sub_f32 v84, v84, v17
v_sub_f32 v85, v85, v17
v_sub_f32 v86, v86, v17
v_sub_f32 v87, v87, v17
v_sub_f32 v88, v88, v17
v_sub_f32 v89, v89, v17
v_sub_f32 v90, v90, v17
v_sub_f32 v91, v91, v17
v_sub_f32 v92, v92, v17
v_sub_f32 v93, v93, v17
v_sub_f32 v94, v94, v17
v_sub_f32 v95, v95, v17
v_sub_f32 v240, v240, v17
v_sub_f32 v241, v241, v17
v_sub_f32 v242, v242, v17
v_sub_f32 v243, v243, v17
v_sub_f32 v244, v244, v17
v_sub_f32 v245, v245, v17
v_sub_f32 v246, v246, v17
v_sub_f32 v247, v247, v17
v_sub_f32 v248, v248, v17
v_sub_f32 v249, v249, v17
v_sub_f32 v250, v250, v17
v_sub_f32 v251, v251, v17
v_sub_f32 v252, v252, v17
v_sub_f32 v253, v253, v17
v_sub_f32 v254, v254, v17
v_sub_f32 v255, v255, v17
v_mul_f32 v14, v14, v18
v_mul_f32 v128, v128, v18
v_mul_f32 v129, v129, v18
v_mul_f32 v130, v130, v18
v_mul_f32 v131, v131, v18
v_mul_f32 v132, v132, v18
v_mul_f32 v133, v133, v18
v_mul_f32 v134, v134, v18
v_mul_f32 v135, v135, v18
v_mul_f32 v136, v136, v18
v_mul_f32 v137, v137, v18
v_mul_f32 v138, v138, v18
v_mul_f32 v139, v139, v18
v_mul_f32 v140, v140, v18
v_mul_f32 v141, v141, v18
v_mul_f32 v142, v142, v18
v_mul_f32 v143, v143, v18
v_mul_f32 v144, v144, v18
v_mul_f32 v145, v145, v18
v_mul_f32 v146, v146, v18
v_mul_f32 v147, v147, v18
v_mul_f32 v148, v148, v18
v_mul_f32 v149, v149, v18
v_mul_f32 v150, v150, v18
v_mul_f32 v151, v151, v18
v_mul_f32 v152, v152, v18
v_mul_f32 v153, v153, v18
v_mul_f32 v154, v154, v18
v_mul_f32 v155, v155, v18
v_mul_f32 v156, v156, v18
v_mul_f32 v157, v157, v18
v_mul_f32 v158, v158, v18
v_mul_f32 v159, v159, v18
v_mul_f32 v160, v160, v18
v_mul_f32 v161, v161, v18
v_mul_f32 v162, v162, v18
v_mul_f32 v163, v163, v18
v_mul_f32 v164, v164, v18
v_mul_f32 v165, v165, v18
v_mul_f32 v166, v166, v18
v_mul_f32 v167, v167, v18
v_mul_f32 v168, v168, v18
v_mul_f32 v169, v169, v18
v_mul_f32 v170, v170, v18
v_mul_f32 v171, v171, v18
v_mul_f32 v172, v172, v18
v_mul_f32 v173, v173, v18
v_mul_f32 v174, v174, v18
v_mul_f32 v175, v175, v18
v_mul_f32 v176, v176, v18
v_mul_f32 v177, v177, v18
v_mul_f32 v178, v178, v18
v_mul_f32 v179, v179, v18
v_mul_f32 v180, v180, v18
v_mul_f32 v181, v181, v18
v_mul_f32 v182, v182, v18
v_mul_f32 v183, v183, v18
v_mul_f32 v184, v184, v18
v_mul_f32 v185, v185, v18
v_mul_f32 v186, v186, v18
v_mul_f32 v187, v187, v18
v_mul_f32 v188, v188, v18
v_mul_f32 v189, v189, v18
v_mul_f32 v190, v190, v18
v_mul_f32 v191, v191, v18
s_nop 3
s_branch LB23
LG24:
s_sub_u32 s4, s4, 1
s_cbranch_scc1 L_end
s_sleep 2
s_mov_b32 s98, 0x2000000
buffer_load_dword v22, v21, s[28:31], s98 offen sc1
s_waitcnt vmcnt(0)
v_cmp_eq_u32 s[98:99], s62, v22
s_nop 3
s_and_b32 s98, s98, 14
s_cmp_lg_u32 s98, 14
s_cbranch_scc1 LG24
s_branch LH25
LX26:
v_max_f32 v17, 0, v15
v_sub_f32 v18, 0, v17
v_exp_f32 v18, v18
v_sub_f32 v96, v96, v17
v_sub_f32 v97, v97, v17
v_sub_f32 v98, v98, v17
v_sub_f32 v99, v99, v17
v_sub_f32 v100, v100, v17
v_sub_f32 v101, v101, v17
v_sub_f32 v102, v102, v17
v_sub_f32 v103, v103, v17
v_sub_f32 v104, v104, v17
v_sub_f32 v105, v105, v17
v_sub_f32 v106, v106, v17
v_sub_f32 v107, v107, v17
v_sub_f32 v108, v108, v17
v_sub_f32 v109, v109, v17
v_sub_f32 v110, v110, v17
v_sub_f32 v111, v111, v17
v_sub_f32 v112, v112, v17
v_sub_f32 v113, v113, v17
v_sub_f32 v114, v114, v17
v_sub_f32 v115, v115, v17
v_sub_f32 v116, v116, v17
v_sub_f32 v117, v117, v17
v_sub_f32 v118, v118, v17
v_sub_f32 v119, v119, v17
v_sub_f32 v120, v120, v17
v_sub_f32 v121, v121, v17
v_sub_f32 v122, v122, v17
v_sub_f32 v123, v123, v17
v_sub_f32 v124, v124, v17
v_sub_f32 v125, v125, v17
v_sub_f32 v126, v126, v17
v_sub_f32 v127, v127, v17
v_sub_f32 v240, v240, v17
v_sub_f32 v241, v241, v17
v_sub_f32 v242, v242, v17
v_sub_f32 v243, v243, v17
v_sub_f32 v244, v244, v17
v_sub_f32 v245, v245, v17
v_sub_f32 v246, v246, v17
v_sub_f32 v247, v247, v17
v_sub_f32 v248, v248, v17
v_sub_f32 v249, v249, v17
v_sub_f32 v250, v250, v17
v_sub_f32 v251, v251, v17
v_sub_f32 v252, v252, v17
v_sub_f32 v253, v253, v17
v_sub_f32 v254, v254, v17
v_sub_f32 v255, v255, v17
v_mul_f32 v14, v14, v18
v_mul_f32 v128, v128, v18
v_mul_f32 v129, v129, v18
v_mul_f32 v130, v130, v18
v_mul_f32 v131, v131, v18
v_mul_f32 v132, v132, v18
v_mul_f32 v133, v133, v18
v_mul_f32 v134, v134, v18
v_mul_f32 v135, v135, v18
v_mul_f32 v136, v136, v18
v_mul_f32 v137, v137, v18
v_mul_f32 v138, v138, v18
v_mul_f32 v139, v139, v18
v_mul_f32 v140, v140, v18
v_mul_f32 v141, v141, v18
v_mul_f32 v142, v142, v18
v_mul_f32 v143, v143, v18
v_mul_f32 v144, v144, v18
v_mul_f32 v145, v145, v18
v_mul_f32 v146, v146, v18
v_mul_f32 v147, v147, v18
v_mul_f32 v148, v148, v18
v_mul_f32 v149, v149, v18
v_mul_f32 v150, v150, v18
v_mul_f32 v151, v151, v18
v_mul_f32 v152, v152, v18
v_mul_f32 v153, v153, v18
v_mul_f32 v154, v154, v18
v_mul_f32 v155, v155, v18
v_mul_f32 v156, v156, v18
v_mul_f32 v157, v157, v18
v_mul_f32 v158, v158, v18
v_mul_f32 v159, v159, v18
v_mul_f32 v160, v160, v18
v_mul_f32 v161, v161, v18
v_mul_f32 v162, v162, v18
v_mul_f32 v163, v163, v18
v_mul_f32 v164, v164, v18
v_mul_f32 v165, v165, v18
v_mul_f32 v166, v166, v18
v_mul_f32 v167, v167, v18
v_mul_f32 v168, v168, v18
v_mul_f32 v169, v169, v18
v_mul_f32 v170, v170, v18
v_mul_f32 v171, v171, v18
v_mul_f32 v172, v172, v18
v_mul_f32 v173, v173, v18
v_mul_f32 v174, v174, v18
v_mul_f32 v175, v175, v18
v_mul_f32 v176, v176, v18
v_mul_f32 v177, v177, v18
v_mul_f32 v178, v178, v18
v_mul_f32 v179, v179, v18
v_mul_f32 v180, v180, v18
v_mul_f32 v181, v181, v18
v_mul_f32 v182, v182, v18
v_mul_f32 v183, v183, v18
v_mul_f32 v184, v184, v18
v_mul_f32 v185, v185, v18
v_mul_f32 v186, v186, v18
v_mul_f32 v187, v187, v18
v_mul_f32 v188, v188, v18
v_mul_f32 v189, v189, v18
v_mul_f32 v190, v190, v18
v_mul_f32_e64 v191, v191, v18
s_nop 3
s_branch LB27
LV28:
s_sub_u32 s4, s4, 1
s_cbranch_scc1 L_end
s_sleep 2
s_add_u32 s98, s46, 0
buffer_load_dwordx4 v[128:131], v18, s[28:31], s98 offen offset:0 sc1
buffer_load_dwordx4 v[132:135], v18, s[28:31], s98 offen offset:1024 sc1
buffer_load_dwordx4 v[136:139], v18, s[28:31], s98 offen offset:2048 sc1
buffer_load_dwordx4 v[140:143], v18, s[28:31], s98 offen offset:3072 sc1
s_add_u32 s98, s46, 0
s_lshr_b32 s98, s98, 3
s_add_u32 s98, s98, 33554432
buffer_load_dwordx2 v[26:27], v18, s[28:31], s98 offen sc1
s_waitcnt vmcnt(0)
v_add3_u32 v20, v128, v129, v0
s_nop 0
v_add3_u32 v20, v20, v130, v131
v_add3_u32 v20, v20, v132, v133
v_add3_u32 v20, v20, v134, v135
v_add3_u32 v20, v20, v136, v137
v_add3_u32 v20, v20, v138, v139
v_add3_u32 v20, v20, v140, v141
v_add3_u32 v20, v20, v142, v143
v_cmp_ne_u32 vcc, v20, v26
s_nop 4
s_cbranch_vccnz LV28
s_branch LW29
LV30:
s_sub_u32 s4, s4, 1
s_cbranch_scc1 L_end
s_sleep 2
s_add_u32 s98, s46, 4096
buffer_load_dwordx4 v[144:147], v18, s[28:31], s98 offen offset:0 sc1
buffer_load_dwordx4 v[148:151], v18, s[28:31], s98 offen offset:1024 sc1
buffer_load_dwordx4 v[152:155], v18, s[28:31], s98 offen offset:2048 sc1
buffer_load_dwordx4 v[156:159], v18, s[28:31], s98 offen offset:3072 sc1
s_add_u32 s98, s46, 0
s_lshr_b32 s98, s98, 3
s_add_u32 s98, s98, 33554432
buffer_load_dwordx2 v[26:27], v18, s[28:31], s98 offen sc1
s_waitcnt vmcnt(0)
v_add3_u32 v20, v144, v145, v0
v_add3_u32 v20, v20, v146, v147
v_add3_u32 v20, v20, v148, v149
v_add3_u32 v20, v20, v150, v151
v_add3_u32 v20, v20, v152, v153
v_add3_u32 v20, v20, v154, v155
v_add3_u32 v20, v20, v156, v157
v_add3_u32 v20, v20, v158, v159
v_cmp_ne_u32 vcc, v20, v27
s_nop 4
s_cbranch_vccnz LV30
s_branch LW31
LX32:
v_max_f32 v17, 0, v15
v_sub_f32 v18, 0, v17
v_exp_f32 v18, v18
v_sub_f32 v64, v64, v17
v_sub_f32 v65, v65, v17
v_sub_f32 v66, v66, v17
v_sub_f32 v67, v67, v17
v_sub_f32 v68, v68, v17
v_sub_f32 v69, v69, v17
v_sub_f32 v70, v70, v17
v_sub_f32 v71, v71, v17
v_sub_f32 v72, v72, v17
v_sub_f32 v73, v73, v17
v_sub_f32 v74, v74, v17
v_sub_f32 v75, v75, v17
v_sub_f32 v76, v76, v17
v_sub_f32 v77, v77, v17
v_sub_f32 v78, v78, v17
v_sub_f32 v79, v79, v17
v_sub_f32 v80, v80, v17
v_sub_f32 v81, v81, v17
v_sub_f32 v82, v82, v17
v_sub_f32 v83, v83, v17
v_sub_f32 v84, v84, v17
v_sub_f32 v85, v85, v17
v_sub_f32 v86, v86, v17
v_sub_f32 v87, v87, v17
v_sub_f32 v88, v88, v17
v_sub_f32 v89, v89, v17
v_sub_f32 v90, v90, v17
v_sub_f32 v91, v91, v17
v_sub_f32 v92, v92, v17
v_sub_f32 v93, v93, v17
v_sub_f32 v94, v94, v17
v_sub_f32 v95, v95, v17
v_sub_f32 v240, v240, v17
v_sub_f32 v241, v241, v17
v_sub_f32 v242, v242, v17
v_sub_f32 v243, v243, v17
v_sub_f32 v244, v244, v17
v_sub_f32 v245, v245, v17
v_sub_f32 v246, v246, v17
v_sub_f32 v247, v247, v17
v_sub_f32 v248, v248, v17
v_sub_f32 v249, v249, v17
v_sub_f32 v250, v250, v17
v_sub_f32 v251, v251, v17
v_sub_f32 v252, v252, v17
v_sub_f32 v253, v253, v17
v_sub_f32 v254, v254, v17
v_sub_f32 v255, v255, v17
v_mul_f32 v14, v14, v18
v_mul_f32 v128, v128, v18
v_mul_f32 v129, v129, v18
v_mul_f32 v130, v130, v18
v_mul_f32 v131, v131, v18
v_mul_f32 v132, v132, v18
v_mul_f32 v133, v133, v18
v_mul_f32 v134, v134, v18
v_mul_f32 v135, v135, v18
v_mul_f32 v136, v136, v18
v_mul_f32 v137, v137, v18
v_mul_f32 v138, v138, v18
v_mul_f32 v139, v139, v18
v_mul_f32 v140, v140, v18
v_mul_f32 v141, v141, v18
v_mul_f32 v142, v142, v18
v_mul_f32 v143, v143, v18
v_mul_f32 v144, v144, v18
v_mul_f32 v145, v145, v18
v_mul_f32 v146, v146, v18
v_mul_f32 v147, v147, v18
v_mul_f32 v148, v148, v18
v_mul_f32 v149, v149, v18
v_mul_f32 v150, v150, v18
v_mul_f32 v151, v151, v18
v_mul_f32 v152, v152, v18
v_mul_f32 v153, v153, v18
v_mul_f32 v154, v154, v18
v_mul_f32 v155, v155, v18
v_mul_f32 v156, v156, v18
v_mul_f32 v157, v157, v18
v_mul_f32 v158, v158, v18
v_mul_f32 v159, v159, v18
v_mul_f32 v160, v160, v18
v_mul_f32 v161, v161, v18
v_mul_f32 v162, v162, v18
v_mul_f32 v163, v163, v18
v_mul_f32 v164, v164, v18
v_mul_f32 v165, v165, v18
v_mul_f32 v166, v166, v18
v_mul_f32 v167, v167, v18
v_mul_f32 v168, v168, v18
v_mul_f32 v169, v169, v18
v_mul_f32 v170, v170, v18
v_mul_f32 v171, v171, v18
v_mul_f32 v172, v172, v18
v_mul_f32 v173, v173, v18
v_mul_f32 v174, v174, v18
v_mul_f32 v175, v175, v18
v_mul_f32 v176, v176, v18
v_mul_f32 v177, v177, v18
v_mul_f32 v178, v178, v18
v_mul_f32 v179, v179, v18
v_mul_f32 v180, v180, v18
v_mul_f32 v181, v181, v18
v_mul_f32 v182, v182, v18
v_mul_f32 v183, v183, v18
v_mul_f32 v184, v184, v18
v_mul_f32 v185, v185, v18
v_mul_f32 v186, v186, v18
v_mul_f32 v187, v187, v18
v_mul_f32 v188, v188, v18
v_mul_f32 v189, v189, v18
v_mul_f32 v190, v190, v18
v_mul_f32 v191, v191, v18
s_nop 3
s_branch LB33
LV34:
s_sub_u32 s4, s4, 1
s_cbranch_scc1 L_end
s_sleep 2
s_add_u32 s98, s47, 0
buffer_load_dwordx4 v[160:163], v18, s[28:31], s98 offen offset:0 sc1
buffer_load_dwordx4 v[164:167], v18, s[28:31], s98 offen offset:1024 sc1
buffer_load_dwordx4 v[168:171], v18, s[28:31], s98 offen offset:2048 sc1
buffer_load_dwordx4 v[172:175], v18, s[28:31], s98 offen offset:3072 sc1
s_add_u32 s98, s47, 0
s_lshr_b32 s98, s98, 3
s_add_u32 s98, s98, 33554432
buffer_load_dwordx2 v[28:29], v18, s[28:31], s98 offen sc1
s_waitcnt vmcnt(0)
v_add3_u32 v20, v160, v161, v0
v_add3_u32 v20, v20, v162, v163
v_add3_u32 v20, v20, v164, v165
v_add3_u32 v20, v20, v166, v167
v_add3_u32 v20, v20, v168, v169
v_add3_u32 v20, v20, v170, v171
s_nop 0
v_add3_u32 v20, v20, v172, v173
v_add3_u32 v20, v20, v174, v175
v_cmp_ne_u32 vcc, v20, v28
s_nop 4
s_cbranch_vccnz LV34
s_branch LW35
LV36:
s_sub_u32 s4, s4, 1
s_cbranch_scc1 L_end
s_sleep 2
s_add_u32 s98, s47, 4096
buffer_load_dwordx4 v[176:179], v18, s[28:31], s98 offen offset:0 sc1
s_nop 0
buffer_load_dwordx4 v[180:183], v18, s[28:31], s98 offen offset:1024 sc1
buffer_load_dwordx4 v[184:187], v18, s[28:31], s98 offen offset:2048 sc1
buffer_load_dwordx4 v[188:191], v18, s[28:31], s98 offen offset:3072 sc1
s_add_u32 s98, s47, 0
s_lshr_b32 s98, s98, 3
s_add_u32 s98, s98, 33554432
buffer_load_dwordx2 v[28:29], v18, s[28:31], s98 offen sc1
s_waitcnt vmcnt(0)
v_add3_u32 v20, v176, v177, v0
s_nop 0
v_add3_u32 v20, v20, v178, v179
v_add3_u32 v20, v20, v180, v181
v_add3_u32 v20, v20, v182, v183
v_add3_u32 v20, v20, v184, v185
v_add3_u32 v20, v20, v186, v187
v_add3_u32 v20, v20, v188, v189
v_add3_u32 v20, v20, v190, v191
v_cmp_ne_u32 vcc, v20, v29
s_nop 4
s_cbranch_vccnz LV36
s_branch LW37
LX38:
v_max_f32 v17, 0, v15
v_sub_f32 v18, 0, v17
v_exp_f32 v18, v18
v_sub_f32 v96, v96, v17
v_sub_f32 v97, v97, v17
v_sub_f32 v98, v98, v17
v_sub_f32 v99, v99, v17
v_sub_f32 v100, v100, v17
v_sub_f32 v101, v101, v17
v_sub_f32 v102, v102, v17
v_sub_f32 v103, v103, v17
v_sub_f32 v104, v104, v17
v_sub_f32 v105, v105, v17
v_sub_f32 v106, v106, v17
v_sub_f32 v107, v107, v17
v_sub_f32 v108, v108, v17
v_sub_f32 v109, v109, v17
v_sub_f32 v110, v110, v17
v_sub_f32 v111, v111, v17
v_sub_f32 v112, v112, v17
v_sub_f32 v113, v113, v17
v_sub_f32 v114, v114, v17
v_sub_f32 v115, v115, v17
v_sub_f32 v116, v116, v17
v_sub_f32 v117, v117, v17
v_sub_f32 v118, v118, v17
v_sub_f32 v119, v119, v17
v_sub_f32 v120, v120, v17
v_sub_f32 v121, v121, v17
v_sub_f32 v122, v122, v17
v_sub_f32 v123, v123, v17
v_sub_f32 v124, v124, v17
v_sub_f32 v125, v125, v17
v_sub_f32 v126, v126, v17
v_sub_f32 v127, v127, v17
v_sub_f32 v240, v240, v17
v_sub_f32 v241, v241, v17
v_sub_f32 v242, v242, v17
v_sub_f32 v243, v243, v17
v_sub_f32 v244, v244, v17
v_sub_f32 v245, v245, v17
v_sub_f32 v246, v246, v17
v_sub_f32 v247, v247, v17
v_sub_f32 v248, v248, v17
v_sub_f32 v249, v249, v17
v_sub_f32 v250, v250, v17
v_sub_f32 v251, v251, v17
v_sub_f32 v252, v252, v17
v_sub_f32 v253, v253, v17
v_sub_f32 v254, v254, v17
v_sub_f32 v255, v255, v17
v_mul_f32 v14, v14, v18
v_mul_f32 v128, v128, v18
v_mul_f32 v129, v129, v18
v_mul_f32 v130, v130, v18
v_mul_f32 v131, v131, v18
v_mul_f32 v132, v132, v18
v_mul_f32 v133, v133, v18
v_mul_f32 v134, v134, v18
v_mul_f32 v135, v135, v18
v_mul_f32 v136, v136, v18
v_mul_f32 v137, v137, v18
v_mul_f32 v138, v138, v18
v_mul_f32 v139, v139, v18
v_mul_f32 v140, v140, v18
v_mul_f32 v141, v141, v18
v_mul_f32 v142, v142, v18
v_mul_f32 v143, v143, v18
v_mul_f32 v144, v144, v18
v_mul_f32 v145, v145, v18
v_mul_f32 v146, v146, v18
v_mul_f32 v147, v147, v18
v_mul_f32 v148, v148, v18
v_mul_f32 v149, v149, v18
v_mul_f32 v150, v150, v18
v_mul_f32 v151, v151, v18
v_mul_f32 v152, v152, v18
v_mul_f32 v153, v153, v18
v_mul_f32 v154, v154, v18
v_mul_f32 v155, v155, v18
v_mul_f32 v156, v156, v18
v_mul_f32 v157, v157, v18
v_mul_f32 v158, v158, v18
v_mul_f32 v159, v159, v18
v_mul_f32 v160, v160, v18
v_mul_f32 v161, v161, v18
v_mul_f32 v162, v162, v18
v_mul_f32 v163, v163, v18
v_mul_f32 v164, v164, v18
v_mul_f32 v165, v165, v18
v_mul_f32 v166, v166, v18
v_mul_f32 v167, v167, v18
v_mul_f32 v168, v168, v18
v_mul_f32 v169, v169, v18
v_mul_f32 v170, v170, v18
v_mul_f32 v171, v171, v18
v_mul_f32 v172, v172, v18
v_mul_f32 v173, v173, v18
v_mul_f32 v174, v174, v18
v_mul_f32 v175, v175, v18
v_mul_f32 v176, v176, v18
v_mul_f32 v177, v177, v18
v_mul_f32 v178, v178, v18
v_mul_f32 v179, v179, v18
v_mul_f32 v180, v180, v18
v_mul_f32 v181, v181, v18
v_mul_f32 v182, v182, v18
v_mul_f32 v183, v183, v18
v_mul_f32 v184, v184, v18
v_mul_f32 v185, v185, v18
v_mul_f32 v186, v186, v18
v_mul_f32 v187, v187, v18
v_mul_f32 v188, v188, v18
v_mul_f32 v189, v189, v18
v_mul_f32 v190, v190, v18
v_mul_f32 v191, v191, v18
s_nop 3
s_branch LB39
LV40:
s_sub_u32 s4, s4, 1
s_cbranch_scc1 L_end
s_sleep 2
s_add_u32 s98, s48, 0
buffer_load_dwordx4 v[192:195], v18, s[28:31], s98 offen offset:0 sc1
buffer_load_dwordx4 v[196:199], v18, s[28:31], s98 offen offset:1024 sc1
buffer_load_dwordx4 v[200:203], v18, s[28:31], s98 offen offset:2048 sc1
buffer_load_dwordx4 v[204:207], v18, s[28:31], s98 offen offset:3072 sc1
s_add_u32 s98, s48, 0
s_lshr_b32 s98, s98, 3
s_add_u32 s98, s98, 33554432
buffer_load_dwordx2 v[30:31], v18, s[28:31], s98 offen sc1
s_waitcnt vmcnt(0)
v_add3_u32 v20, v192, v193, v0
v_add3_u32 v20, v20, v194, v195
s_nop 0
v_add3_u32 v20, v20, v196, v197
v_add3_u32 v20, v20, v198, v199
v_add3_u32 v20, v20, v200, v201
v_add3_u32 v20, v20, v202, v203
v_add3_u32 v20, v20, v204, v205
v_add3_u32 v20, v20, v206, v207
v_cmp_ne_u32 vcc, v20, v30
s_nop 4
s_cbranch_vccnz LV40
s_branch LW41
LV42:
s_sub_u32 s4, s4, 1
s_cbranch_scc1 L_end
s_sleep 2
s_add_u32 s98, s48, 4096
buffer_load_dwordx4 v[208:211], v18, s[28:31], s98 offen offset:0 sc1
buffer_load_dwordx4 v[212:215], v18, s[28:31], s98 offen offset:1024 sc1
buffer_load_dwordx4 v[216:219], v18, s[28:31], s98 offen offset:2048 sc1
buffer_load_dwordx4 v[220:223], v18, s[28:31], s98 offen offset:3072 sc1
s_add_u32 s98, s48, 0
s_lshr_b32 s98, s98, 3
s_nop 0
s_add_u32 s98, s98, 33554432
buffer_load_dwordx2 v[30:31], v18, s[28:31], s98 offen sc1
s_waitcnt vmcnt(0)
v_add3_u32 v20, v208, v209, v0
v_add3_u32 v20, v20, v210, v211
v_add3_u32 v20, v20, v212, v213
v_add3_u32 v20, v20, v214, v215
v_add3_u32 v20, v20, v216, v217
s_nop 0
v_add3_u32 v20, v20, v218, v219
v_add3_u32 v20, v20, v220, v221
v_add3_u32 v20, v20, v222, v223
v_cmp_ne_u32 vcc, v20, v31
s_nop 4
s_cbranch_vccnz LV42
s_branch LW43
LX44:
v_max_f32 v17, 0, v15
v_sub_f32 v18, 0, v17
v_exp_f32 v18, v18
v_sub_f32 v64, v64, v17
v_sub_f32 v65, v65, v17
v_sub_f32 v66, v66, v17
v_sub_f32 v67, v67, v17
v_sub_f32 v68, v68, v17
v_sub_f32 v69, v69, v17
v_sub_f32 v70, v70, v17
v_sub_f32 v71, v71, v17
v_sub_f32 v72, v72, v17
v_sub_f32 v73, v73, v17
v_sub_f32 v74, v74, v17
v_sub_f32 v75, v75, v17
v_sub_f32 v76, v76, v17
v_sub_f32 v77, v77, v17
v_sub_f32 v78, v78, v17
v_sub_f32 v79, v79, v17
v_sub_f32 v80, v80, v17
v_sub_f32 v81, v81, v17
v_sub_f32 v82, v82, v17
v_sub_f32 v83, v83, v17
v_sub_f32 v84, v84, v17
v_sub_f32 v85, v85, v17
v_sub_f32 v86, v86, v17
v_sub_f32 v87, v87, v17
v_sub_f32 v88, v88, v17
v_sub_f32 v89, v89, v17
v_sub_f32 v90, v90, v17
v_sub_f32 v91, v91, v17
v_sub_f32 v92, v92, v17
v_sub_f32 v93, v93, v17
v_sub_f32 v94, v94, v17
v_sub_f32 v95, v95, v17
v_sub_f32 v240, v240, v17
v_sub_f32 v241, v241, v17
v_sub_f32 v242, v242, v17
v_sub_f32 v243, v243, v17
v_sub_f32 v244, v244, v17
v_sub_f32 v245, v245, v17
v_sub_f32 v246, v246, v17
v_sub_f32 v247, v247, v17
v_sub_f32 v248, v248, v17
v_sub_f32 v249, v249, v17
v_sub_f32 v250, v250, v17
v_sub_f32 v251, v251, v17
v_sub_f32 v252, v252, v17
v_sub_f32 v253, v253, v17
v_sub_f32 v254, v254, v17
v_sub_f32 v255, v255, v17
v_mul_f32 v14, v14, v18
v_mul_f32 v128, v128, v18
v_mul_f32 v129, v129, v18
v_mul_f32 v130, v130, v18
v_mul_f32 v131, v131, v18
v_mul_f32 v132, v132, v18
v_mul_f32 v133, v133, v18
v_mul_f32 v134, v134, v18
v_mul_f32 v135, v135, v18
v_mul_f32 v136, v136, v18
v_mul_f32 v137, v137, v18
v_mul_f32 v138, v138, v18
v_mul_f32 v139, v139, v18
v_mul_f32 v140, v140, v18
v_mul_f32 v141, v141, v18
v_mul_f32 v142, v142, v18
v_mul_f32 v143, v143, v18
v_mul_f32 v144, v144, v18
v_mul_f32 v145, v145, v18
v_mul_f32 v146, v146, v18
v_mul_f32 v147, v147, v18
v_mul_f32 v148, v148, v18
v_mul_f32 v149, v149, v18
v_mul_f32 v150, v150, v18
v_mul_f32 v151, v151, v18
v_mul_f32 v152, v152, v18
v_mul_f32 v153, v153, v18
v_mul_f32 v154, v154, v18
v_mul_f32 v155, v155, v18
v_mul_f32 v156, v156, v18
v_mul_f32 v157, v157, v18
v_mul_f32 v158, v158, v18
v_mul_f32 v159, v159, v18
v_mul_f32 v160, v160, v18
v_mul_f32 v161, v161, v18
v_mul_f32 v162, v162, v18
v_mul_f32 v163, v163, v18
v_mul_f32 v164, v164, v18
v_mul_f32 v165, v165, v18
v_mul_f32 v166, v166, v18
v_mul_f32 v167, v167, v18
v_mul_f32 v168, v168, v18
v_mul_f32 v169, v169, v18
v_mul_f32 v170, v170, v18
v_mul_f32 v171, v171, v18
v_mul_f32 v172, v172, v18
v_mul_f32 v173, v173, v18
v_mul_f32 v174, v174, v18
v_mul_f32 v175, v175, v18
v_mul_f32 v176, v176, v18
v_mul_f32 v177, v177, v18
v_mul_f32 v178, v178, v18
v_mul_f32 v179, v179, v18
v_mul_f32 v180, v180, v18
v_mul_f32 v181, v181, v18
v_mul_f32 v182, v182, v18
v_mul_f32 v183, v183, v18
v_mul_f32 v184, v184, v18
v_mul_f32 v185, v185, v18
v_mul_f32 v186, v186, v18
v_mul_f32 v187, v187, v18
v_mul_f32 v188, v188, v18
v_mul_f32 v189, v189, v18
v_mul_f32 v190, v190, v18
v_mul_f32 v191, v191, v18
s_nop 3
s_branch LB45
LX46:
v_max_f32 v17, 0, v15
v_sub_f32 v18, 0, v17
v_exp_f32 v18, v18
v_sub_f32 v96, v96, v17
v_sub_f32 v97, v97, v17
v_sub_f32 v98, v98, v17
v_sub_f32 v99, v99, v17
v_sub_f32 v100, v100, v17
v_sub_f32 v101, v101, v17
v_sub_f32 v102, v102, v17
v_sub_f32 v103, v103, v17
v_sub_f32 v104, v104, v17
v_sub_f32 v105, v105, v17
v_sub_f32 v106, v106, v17
v_sub_f32 v107, v107, v17
v_sub_f32 v108, v108, v17
v_sub_f32 v109, v109, v17
v_sub_f32 v110, v110, v17
v_sub_f32 v111, v111, v17
v_sub_f32 v112, v112, v17
v_sub_f32 v113, v113, v17
v_sub_f32 v114, v114, v17
v_sub_f32 v115, v115, v17
v_sub_f32 v116, v116, v17
v_sub_f32 v117, v117, v17
v_sub_f32 v118, v118, v17
v_sub_f32 v119, v119, v17
v_sub_f32 v120, v120, v17
v_sub_f32 v121, v121, v17
v_sub_f32 v122, v122, v17
v_sub_f32 v123, v123, v17
v_sub_f32 v124, v124, v17
v_sub_f32 v125, v125, v17
v_sub_f32 v126, v126, v17
v_sub_f32 v127, v127, v17
v_sub_f32 v240, v240, v17
v_sub_f32 v241, v241, v17
v_sub_f32 v242, v242, v17
v_sub_f32 v243, v243, v17
v_sub_f32 v244, v244, v17
v_sub_f32 v245, v245, v17
v_sub_f32 v246, v246, v17
v_sub_f32 v247, v247, v17
v_sub_f32 v248, v248, v17
v_sub_f32 v249, v249, v17
v_sub_f32 v250, v250, v17
v_sub_f32 v251, v251, v17
v_sub_f32 v252, v252, v17
v_sub_f32 v253, v253, v17
v_sub_f32 v254, v254, v17
v_sub_f32 v255, v255, v17
v_mul_f32 v14, v14, v18
v_mul_f32 v128, v128, v18
v_mul_f32 v129, v129, v18
v_mul_f32 v130, v130, v18
v_mul_f32 v131, v131, v18
v_mul_f32 v132, v132, v18
v_mul_f32 v133, v133, v18
v_mul_f32 v134, v134, v18
v_mul_f32 v135, v135, v18
v_mul_f32 v136, v136, v18
v_mul_f32 v137, v137, v18
v_mul_f32 v138, v138, v18
v_mul_f32 v139, v139, v18
v_mul_f32 v140, v140, v18
v_mul_f32 v141, v141, v18
v_mul_f32 v142, v142, v18
v_mul_f32 v143, v143, v18
v_mul_f32 v144, v144, v18
v_mul_f32 v145, v145, v18
v_mul_f32 v146, v146, v18
v_mul_f32 v147, v147, v18
v_mul_f32 v148, v148, v18
v_mul_f32 v149, v149, v18
v_mul_f32 v150, v150, v18
v_mul_f32 v151, v151, v18
v_mul_f32 v152, v152, v18
v_mul_f32 v153, v153, v18
v_mul_f32 v154, v154, v18
v_mul_f32 v155, v155, v18
v_mul_f32 v156, v156, v18
v_mul_f32 v157, v157, v18
v_mul_f32 v158, v158, v18
v_mul_f32 v159, v159, v18
v_mul_f32 v160, v160, v18
v_mul_f32 v161, v161, v18
v_mul_f32 v162, v162, v18
v_mul_f32 v163, v163, v18
v_mul_f32 v164, v164, v18
v_mul_f32 v165, v165, v18
v_mul_f32 v166, v166, v18
v_mul_f32 v167, v167, v18
v_mul_f32 v168, v168, v18
v_mul_f32 v169, v169, v18
v_mul_f32 v170, v170, v18
v_mul_f32 v171, v171, v18
v_mul_f32 v172, v172, v18
v_mul_f32 v173, v173, v18
v_mul_f32 v174, v174, v18
v_mul_f32 v175, v175, v18
v_mul_f32 v176, v176, v18
v_mul_f32 v177, v177, v18
v_mul_f32 v178, v178, v18
v_mul_f32 v179, v179, v18
v_mul_f32 v180, v180, v18
v_mul_f32 v181, v181, v18
v_mul_f32 v182, v182, v18
v_mul_f32 v183, v183, v18
v_mul_f32 v184, v184, v18
v_mul_f32 v185, v185, v18
v_mul_f32 v186, v186, v18
v_mul_f32 v187, v187, v18
v_mul_f32 v188, v188, v18
v_mul_f32 v189, v189, v18
v_mul_f32 v190, v190, v18
v_mul_f32 v191, v191, v18
s_nop 3
s_branch LB47
LF48:
v_pk_mul_f32 v[128:129], v[128:129], v[24:25]
v_pk_mul_f32 v[130:131], v[130:131], v[24:25]
v_pk_mul_f32 v[132:133], v[132:133], v[24:25]
v_pk_mul_f32 v[134:135], v[134:135], v[24:25]
v_cvt_pk_bf16_f32 v128, v128, v129
v_cvt_pk_bf16_f32 v129, v130, v131
v_cvt_pk_bf16_f32 v130, v132, v133
v_cvt_pk_bf16_f32 v131, v134, v135
buffer_store_dwordx4 v[128:131], v19, s[28:31], s51 offen offset:0 sc1
v_add3_u32 v28, v128, v129, s62
v_add3_u32 v28, v28, v130, v131
ds_write_b128 v20, v[128:131] offset:0
v_pk_mul_f32 v[136:137], v[136:137], v[24:25]
v_pk_mul_f32 v[138:139], v[138:139], v[24:25]
v_pk_mul_f32 v[140:141], v[140:141], v[24:25]
v_pk_mul_f32 v[142:143], v[142:143], v[24:25]
v_cvt_pk_bf16_f32 v136, v136, v137
v_cvt_pk_bf16_f32 v137, v138, v139
v_cvt_pk_bf16_f32 v138, v140, v141
v_cvt_pk_bf16_f32 v139, v142, v143
buffer_store_dwordx4 v[136:139], v19, s[28:31], s51 offen offset:1024 sc1
v_add3_u32 v28, v28, v136, v137
v_add3_u32 v28, v28, v138, v139
ds_write_b128 v20, v[136:139] offset:1024
v_pk_mul_f32 v[144:145], v[144:145], v[24:25]
v_pk_mul_f32 v[146:147], v[146:147], v[24:25]
v_pk_mul_f32 v[148:149], v[148:149], v[24:25]
v_pk_mul_f32 v[150:151], v[150:151], v[24:25]
v_cvt_pk_bf16_f32 v144, v144, v145
v_cvt_pk_bf16_f32 v145, v146, v147
v_cvt_pk_bf16_f32 v146, v148, v149
v_cvt_pk_bf16_f32 v147, v150, v151
buffer_store_dwordx4 v[144:147], v19, s[28:31], s51 offen offset:2048 sc1
v_add3_u32 v28, v28, v144, v145
v_add3_u32 v28, v28, v146, v147
ds_write_b128 v20, v[144:147] offset:2048
v_pk_mul_f32 v[152:153], v[152:153], v[24:25]
v_pk_mul_f32 v[154:155], v[154:155], v[24:25]
v_pk_mul_f32 v[156:157], v[156:157], v[24:25]
v_pk_mul_f32 v[158:159], v[158:159], v[24:25]
v_cvt_pk_bf16_f32 v152, v152, v153
v_cvt_pk_bf16_f32 v153, v154, v155
v_cvt_pk_bf16_f32 v154, v156, v157
v_cvt_pk_bf16_f32 v155, v158, v159
buffer_store_dwordx4 v[152:155], v19, s[28:31], s51 offen offset:3072 sc1
v_add3_u32 v28, v28, v152, v153
v_add3_u32 v28, v28, v154, v155
ds_write_b128 v20, v[152:155] offset:3072
v_pk_mul_f32 v[160:161], v[160:161], v[24:25]
v_pk_mul_f32 v[162:163], v[162:163], v[24:25]
v_pk_mul_f32 v[164:165], v[164:165], v[24:25]
v_pk_mul_f32 v[166:167], v[166:167], v[24:25]
v_cvt_pk_bf16_f32 v160, v160, v161
v_cvt_pk_bf16_f32 v161, v162, v163
v_cvt_pk_bf16_f32 v162, v164, v165
v_cvt_pk_bf16_f32 v163, v166, v167
buffer_store_dwordx4 v[160:163], v19, s[28:31], s52 offen offset:0 sc1
v_add3_u32 v29, v160, v161, s62
v_add3_u32 v29, v29, v162, v163
ds_write_b128 v20, v[160:163] offset:4096
v_pk_mul_f32 v[168:169], v[168:169], v[24:25]
v_pk_mul_f32 v[170:171], v[170:171], v[24:25]
v_pk_mul_f32 v[172:173], v[172:173], v[24:25]
v_pk_mul_f32 v[174:175], v[174:175], v[24:25]
v_cvt_pk_bf16_f32 v168, v168, v169
v_cvt_pk_bf16_f32 v169, v170, v171
v_cvt_pk_bf16_f32 v170, v172, v173
v_cvt_pk_bf16_f32 v171, v174, v175
buffer_store_dwordx4 v[168:171], v19, s[28:31], s52 offen offset:1024 sc1
v_add3_u32 v29, v29, v168, v169
v_add3_u32 v29, v29, v170, v171
ds_write_b128 v20, v[168:171] offset:5120
v_pk_mul_f32 v[176:177], v[176:177], v[24:25]
v_pk_mul_f32 v[178:179], v[178:179], v[24:25]
v_pk_mul_f32 v[180:181], v[180:181], v[24:25]
v_pk_mul_f32 v[182:183], v[182:183], v[24:25]
v_cvt_pk_bf16_f32 v176, v176, v177
v_cvt_pk_bf16_f32 v177, v178, v179
v_cvt_pk_bf16_f32 v178, v180, v181
v_cvt_pk_bf16_f32 v179, v182, v183
buffer_store_dwordx4 v[176:179], v19, s[28:31], s52 offen offset:2048 sc1
v_add3_u32 v29, v29, v176, v177
v_add3_u32 v29, v29, v178, v179
ds_write_b128 v20, v[176:179] offset:6144
v_pk_mul_f32 v[184:185], v[184:185], v[24:25]
v_pk_mul_f32 v[186:187], v[186:187], v[24:25]
v_pk_mul_f32 v[188:189], v[188:189], v[24:25]
v_pk_mul_f32 v[190:191], v[190:191], v[24:25]
v_cvt_pk_bf16_f32 v184, v184, v185
v_cvt_pk_bf16_f32 v185, v186, v187
v_cvt_pk_bf16_f32 v186, v188, v189
v_cvt_pk_bf16_f32 v187, v190, v191
buffer_store_dwordx4 v[184:187], v19, s[28:31], s52 offen offset:3072 sc1
v_add3_u32 v29, v29, v184, v185
v_add3_u32 v29, v29, v186, v187
buffer_store_dwordx4 v[28:31], v19, s[28:31], s53 offen sc1
s_branch LJ49
LV50:
s_sub_u32 s4, s4, 1
s_cbranch_scc1 L_end
s_sleep 1
s_add_u32 s98, s46, 131072
buffer_load_dwordx4 v[128:131], v18, s[28:31], s98 offen offset:0 sc1
buffer_load_dwordx4 v[132:135], v18, s[28:31], s98 offen offset:1024 sc1
buffer_load_dwordx4 v[136:139], v18, s[28:31], s98 offen offset:2048 sc1
buffer_load_dwordx4 v[140:143], v18, s[28:31], s98 offen offset:3072 sc1
s_add_u32 s98, s46, 131072
s_lshr_b32 s98, s98, 3
s_add_u32 s98, s98, 33554432
buffer_load_dwordx2 v[26:27], v18, s[28:31], s98 offen sc1
s_waitcnt vmcnt(0)
v_add3_u32 v20, v128, v129, v0
v_add3_u32 v20, v20, v130, v131
v_add3_u32 v20, v20, v132, v133
v_add3_u32 v20, v20, v134, v135
v_add3_u32 v20, v20, v136, v137
v_add3_u32 v20, v20, v138, v139
v_add3_u32 v20, v20, v140, v141
v_add3_u32 v20, v20, v142, v143
v_cmp_ne_u32 vcc, v20, v26
s_nop 4
s_cbranch_vccnz LV50
s_branch LW51
LV52:
s_sub_u32 s4, s4, 1
s_cbranch_scc1 L_end
s_sleep 1
s_add_u32 s98, s46, 135168
buffer_load_dwordx4 v[144:147], v18, s[28:31], s98 offen offset:0 sc1
buffer_load_dwordx4 v[148:151], v18, s[28:31], s98 offen offset:1024 sc1
buffer_load_dwordx4 v[152:155], v18, s[28:31], s98 offen offset:2048 sc1
buffer_load_dwordx4 v[156:159], v18, s[28:31], s98 offen offset:3072 sc1
s_add_u32 s98, s46, 131072
s_lshr_b32 s98, s98, 3
s_add_u32 s98, s98, 33554432
buffer_load_dwordx2 v[26:27], v18, s[28:31], s98 offen sc1
s_waitcnt vmcnt(0)
v_add3_u32 v20, v144, v145, v0
v_add3_u32 v20, v20, v146, v147
v_add3_u32 v20, v20, v148, v149
v_add3_u32 v20, v20, v150, v151
v_add3_u32 v20, v20, v152, v153
s_nop 0
v_add3_u32 v20, v20, v154, v155
v_add3_u32 v20, v20, v156, v157
v_add3_u32 v20, v20, v158, v159
v_cmp_ne_u32 vcc, v20, v27
s_nop 4
s_cbranch_vccnz LV52
s_branch LW53
LV54:
s_sub_u32 s4, s4, 1
s_cbranch_scc1 L_end
s_sleep 1
s_add_u32 s98, s47, 131072
s_nop 0
buffer_load_dwordx4 v[160:163], v18, s[28:31], s98 offen offset:0 sc1
buffer_load_dwordx4 v[164:167], v18, s[28:31], s98 offen offset:1024 sc1
buffer_load_dwordx4 v[168:171], v18, s[28:31], s98 offen offset:2048 sc1
buffer_load_dwordx4 v[172:175], v18, s[28:31], s98 offen offset:3072 sc1
s_add_u32 s98, s47, 131072
s_lshr_b32 s98, s98, 3
s_add_u32 s98, s98, 33554432
buffer_load_dwordx2 v[28:29], v18, s[28:31], s98 offen sc1
s_waitcnt vmcnt(0)
v_add3_u32 v20, v160, v161, v0
v_add3_u32 v20, v20, v162, v163
v_add3_u32 v20, v20, v164, v165
v_add3_u32 v20, v20, v166, v167
v_add3_u32 v20, v20, v168, v169
v_add3_u32 v20, v20, v170, v171
v_add3_u32 v20, v20, v172, v173
v_add3_u32 v20, v20, v174, v175
v_cmp_ne_u32 vcc, v20, v28
s_nop 4
s_cbranch_vccnz LV54
s_branch LW55
LV56:
s_sub_u32 s4, s4, 1
s_cbranch_scc1 L_end
s_sleep 1
s_add_u32 s98, s47, 135168
buffer_load_dwordx4 v[176:179], v18, s[28:31], s98 offen offset:0 sc1
buffer_load_dwordx4 v[180:183], v18, s[28:31], s98 offen offset:1024 sc1
buffer_load_dwordx4 v[184:187], v18, s[28:31], s98 offen offset:2048 sc1
s_nop 0
buffer_load_dwordx4 v[188:191], v18, s[28:31], s98 offen offset:3072 sc1
s_add_u32 s98, s47, 131072
s_lshr_b32 s98, s98, 3
s_add_u32 s98, s98, 33554432
buffer_load_dwordx2 v[28:29], v18, s[28:31], s98 offen sc1
s_waitcnt vmcnt(0)
v_add3_u32 v20, v176, v177, v0
v_add3_u32 v20, v20, v178, v179
v_add3_u32 v20, v20, v180, v181
v_add3_u32 v20, v20, v182, v183
v_add3_u32 v20, v20, v184, v185
v_add3_u32 v20, v20, v186, v187
v_add3_u32 v20, v20, v188, v189
v_add3_u32 v20, v20, v190, v191
v_cmp_ne_u32 vcc, v20, v29
s_nop 4
s_cbranch_vccnz LV56
s_branch LW57
LV58:
s_sub_u32 s4, s4, 1
s_cbranch_scc1 L_end
s_sleep 1
s_add_u32 s98, s48, 131072
buffer_load_dwordx4 v[192:195], v18, s[28:31], s98 offen offset:0 sc1
buffer_load_dwordx4 v[196:199], v18, s[28:31], s98 offen offset:1024 sc1
buffer_load_dwordx4 v[200:203], v18, s[28:31], s98 offen offset:2048 sc1
buffer_load_dwordx4 v[204:207], v18, s[28:31], s98 offen offset:3072 sc1
s_add_u32 s98, s48, 131072
s_lshr_b32 s98, s98, 3
s_add_u32 s98, s98, 33554432
buffer_load_dwordx2 v[30:31], v18, s[28:31], s98 offen sc1
s_waitcnt vmcnt(0)
v_add3_u32 v20, v192, v193, v0
v_add3_u32 v20, v20, v194, v195
v_add3_u32 v20, v20, v196, v197
v_add3_u32 v20, v20, v198, v199
v_add3_u32 v20, v20, v200, v201
v_add3_u32 v20, v20, v202, v203
s_nop 0
v_add3_u32 v20, v20, v204, v205
v_add3_u32 v20, v20, v206, v207
v_cmp_ne_u32 vcc, v20, v30
s_nop 4
s_cbranch_vccnz LV58
s_branch LW59
LV60:
s_sub_u32 s4, s4, 1
s_cbranch_scc1 L_end
s_sleep 1
s_add_u32 s98, s48, 135168
buffer_load_dwordx4 v[208:211], v18, s[28:31], s98 offen offset:0 sc1
s_nop 0
buffer_load_dwordx4 v[212:215], v18, s[28:31], s98 offen offset:1024 sc1
buffer_load_dwordx4 v[216:219], v18, s[28:31], s98 offen offset:2048 sc1
buffer_load_dwordx4 v[220:223], v18, s[28:31], s98 offen offset:3072 sc1
s_add_u32 s98, s48, 131072
s_lshr_b32 s98, s98, 3
s_add_u32 s98, s98, 33554432
buffer_load_dwordx2 v[30:31], v18, s[28:31], s98 offen sc1
s_waitcnt vmcnt(0)
v_add3_u32 v20, v208, v209, v0
v_add3_u32 v20, v20, v210, v211
v_add3_u32 v20, v20, v212, v213
v_add3_u32 v20, v20, v214, v215
v_add3_u32 v20, v20, v216, v217
v_add3_u32 v20, v20, v218, v219
v_add3_u32 v20, v20, v220, v221
v_add3_u32 v20, v20, v222, v223
v_cmp_ne_u32 vcc, v20, v31
s_nop 4
s_cbranch_vccnz LV60
s_branch LW61
L_end:
s_endpgm
.section .rodata,"a"
.p2align 6
.amdhsa_kernel concat_heads__mha_block_cached__mha_block_cached__near_ridge_kernel
  .amdhsa_next_free_vgpr 256
  .amdhsa_next_free_sgpr 102
  .amdhsa_accum_offset 256
  .amdhsa_group_segment_fixed_size 0
  .amdhsa_kernarg_size 104
  .amdhsa_user_sgpr_count 2
  .amdhsa_user_sgpr_kernarg_segment_ptr 1
  .amdhsa_system_sgpr_workgroup_id_x 1
.end_amdhsa_kernel
```
